```python
import torch

def _softmax(x, axis=-1):
    return torch.softmax(x, dim=axis)
def _gelu(x):
    return torch.nn.functional.gelu(x, approximate="tanh")
def _silu(x):
    return torch.nn.functional.silu(x)
def _sigmoid(x):
    return torch.sigmoid(x)
def _layernorm(x, axis=-1, eps=1e-5):
    m = x.mean(dim=axis, keepdim=True)
    v = x.var(dim=axis, keepdim=True, unbiased=False)
    return (x - m) / torch.sqrt(v + eps)
def _scatter_add(tgt, idx, src, axis=0):
    return tgt.clone().index_add_(axis, idx, src)
def _segment_sum(src, seg, n):
    out = torch.zeros((n,) + src.shape[1:], dtype=src.dtype)
    return out.index_add_(0, seg, src)
def _pad(x, pw):
    flat = tuple(v for pair in reversed(pw) for v in pair)
    return torch.nn.functional.pad(x, flat)

kernel_name = 'standalone__gqa_softmax__near_ridge'

def setup_inputs():

    _w = (lambda a: (lambda t: t.to(torch.bfloat16) if t.is_floating_point() else t)(torch.as_tensor(a)))
    B, Hq, Hkv, Sq, Sk, D = 8, 16, 8, 368, 512, 256
    return {
        "q": _w((lambda *s: torch.randn(*s, dtype=torch.bfloat16) * 0.8)(B, Hq, Sq, D)),
        "k": _w((lambda *s: torch.randn(*s, dtype=torch.bfloat16) * 0.8)(B, Hkv, Sk, D)),
        "v": _w((lambda *s: torch.randn(*s, dtype=torch.bfloat16) * 0.05)(B, Hkv, Sk, D)),
    }

def reference(q, k, v):
    B, Hq, Sq, D = q.shape
    Hkv = k.shape[1]
    rep = Hq // Hkv
    k = (lambda x, n, axis: torch.repeat_interleave(x, n, dim=axis))(k, rep, axis=1)
    v = (lambda x, n, axis: torch.repeat_interleave(x, n, dim=axis))(v, rep, axis=1)
    scale = D ** -0.5
    scores = torch.einsum("bhqd,bhkd->bhqk", q, k) * scale
    p = _softmax(scores, axis=-1)
    return torch.einsum("bhqk,bhkd->bhqd", p, v)
```

```asm
; @launch grid=(256,1,1) block=(256,1,1) lds=163840
.amdgcn_target "amdgcn-amd-amdhsa--gfx950"
.text
.globl standalone__gqa_softmax__near_ridge_kernel
.p2align 12
.p2align 8
.type standalone__gqa_softmax__near_ridge_kernel,@function
standalone__gqa_softmax__near_ridge_kernel:
    s_cmp_ge_u32 s2, 256
    s_cbranch_scc1 L_end
    s_load_dwordx4 s[4:7], s[0:1], 0
    s_load_dwordx4 s[8:11], s[0:1], 16
    s_getpc_b64 s[42:43]
L_pfbase:
    v_lshlrev_b32 v42, 7, v0
    global_load_dword v44, v42, s[42:43]
    v_lshrrev_b32 v33, 6, v0
    v_and_b32 v32, 63, v0
    v_readfirstlane_b32 s36, v33
    s_and_b32 s32, s2, 7
    s_lshr_b32 s33, s2, 5
    s_lshl3_add_u32 s32, s33, s32
    s_bfe_u32 s33, s2, 0x20003
    s_lshl2_add_u32 s34, s32, s33
    s_mul_i32 s34, s34, 94208
    s_lshl_b32 s32, s32, 18
    v_bfe_u32 v38, v32, 2, 2
    v_lshrrev_b32 v37, 4, v32
    v_lshlrev_b32 v34, 9, v38
    v_lshl_add_u32 v34, v37, 6, v34
    v_and_b32 v35, 3, v32
    s_lshl_b32 s33, s36, 1
    s_lshr_b32 s33, 0x78, s33
    s_and_b32 s33, s33, 3
    s_lshl_b32 s28, s36, 10
    s_lshl_b32 s38, s36, 13
    v_xor_b32 v36, s33, v35
    v_lshl_add_u32 v39, v33, 11, v34
    v_lshl_add_u32 v10, v36, 4, v39
    v_add_u32 v11, 8192, v10
    s_mov_b32 s35, 24576
    v_mad_u32_u24 v116, v33, s35, v34
    v_xor_b32 v117, 0, v35
    v_lshl_add_u32 v104, v117, 4, v116
    v_xor_b32 v117, 2, v35
    v_lshl_add_u32 v105, v117, 4, v116
    v_add_u32 v105, 2048, v105
    v_xor_b32 v117, 3, v35
    v_lshl_add_u32 v106, v117, 4, v116
    v_add_u32 v106, 4096, v106
    v_xor_b32 v117, 1, v35
    v_lshl_add_u32 v107, v117, 4, v116
    v_add_u32 v107, 6144, v107
    s_waitcnt lgkmcnt(0)
    s_add_u32 s16, s6, s32
    s_addc_u32 s17, s7, 0
    s_mov_b32 s18, 262144
    s_mov_b32 s19, 0x00020000
    s_add_u32 s12, s4, s34
    s_addc_u32 s13, s5, 0
    s_mov_b32 s14, 94208
    s_mov_b32 s15, 0x00020000
    s_add_u32 m0, s38, 65536
    s_nop 0
    buffer_load_dwordx4 v104, s[12:15], 0 offen nt lds
    s_add_u32 m0, s38, 66560
    s_nop 0
    buffer_load_dwordx4 v105, s[12:15], 0 offen nt lds
    s_add_u32 m0, s38, 67584
    s_nop 0
    buffer_load_dwordx4 v106, s[12:15], 0 offen nt lds
    s_add_u32 m0, s38, 68608
    s_nop 0
    buffer_load_dwordx4 v107, s[12:15], 0 offen nt lds
    s_mov_b32 s30, 0
    s_add_u32 m0, s28, 0
    s_nop 0
    buffer_load_dwordx4 v10, s[16:19], s30 offen nt lds
    s_add_u32 m0, s28, 3840
    s_nop 0
    buffer_load_dwordx4 v10, s[16:19], s30 offen offset:256 nt lds
    s_add_u32 m0, s28, 8192
    s_nop 0
    buffer_load_dwordx4 v11, s[16:19], s30 offen nt lds
    s_add_u32 m0, s28, 12032
    s_nop 0
    buffer_load_dwordx4 v11, s[16:19], s30 offen offset:256 nt lds
    v_add_u32 v42, 32768, v42
    v_min_u32 v42, L_mainend - L_pfbase, v42
    global_load_dword v45, v42, s[42:43]
    s_add_u32 m0, s38, 69376
    s_nop 0
    buffer_load_dwordx4 v104, s[12:15], 0 offen offset:256 nt lds
    s_add_u32 m0, s38, 70400
    s_nop 0
    buffer_load_dwordx4 v105, s[12:15], 0 offen offset:256 nt lds
    s_add_u32 m0, s38, 71424
    s_nop 0
    buffer_load_dwordx4 v106, s[12:15], 0 offen offset:256 nt lds
    s_add_u32 m0, s38, 72448
    s_nop 0
    buffer_load_dwordx4 v107, s[12:15], 0 offen offset:256 nt lds
    s_add_u32 s20, s8, s32
    s_addc_u32 s21, s9, 0
    s_mov_b32 s22, 262144
    s_mov_b32 s23, 0x00020000
    s_add_u32 s24, s10, s34
    s_addc_u32 s25, s11, 0
    s_mov_b32 s26, 94208
    s_mov_b32 s27, 0x00020000
    buffer_load_dword v46, off, s[20:23], 0 nt
    v_and_b32 v41, 1, v33
    v_lshlrev_b32 v41, 1, v41
    v_xor_b32 v41, v41, v35
    v_lshl_add_u32 v12, v41, 4, v39
    v_add_u32 v13, 8192, v12
    v_add_u32 v14, 16384, v12
    v_add_u32 v15, 24576, v12
    v_lshlrev_b32 v42, 1, v38
    v_mov_b32 v43, 0x78
    v_lshrrev_b32 v42, v42, v43
    v_and_b32 v42, 3, v42
    v_xor_b32 v42, v42, v37
    v_lshlrev_b32 v42, 4, v42
    v_lshl_add_u32 v42, v38, 10, v42
    v_lshl_add_u32 v1, v35, 6, v42
    v_add_u32 v2, 0x10000, v1
    v_add_u32 v3, 0x20000, v1
    v_lshlrev_b32 v42, 10, v37
    v_lshl_add_u32 v42, v38, 6, v42
    v_lshl_add_u32 v42, v35, 3, v42
    v_and_b32 v43, 1, v37
    v_lshl_add_u32 v4, v43, 5, v42
    v_xor_b32 v7, 32, v4
    v_add_u32 v5, 65536, v4
    v_add_u32 v6, 131072, v4
    v_add_u32 v8, 65536, v7
    v_add_u32 v9, 131072, v7
    v_and_b32 v43, 15, v32
    v_lshrrev_b32 v119, 3, v32
    v_and_b32 v120, 7, v32
    v_mad_u32_u24 v42, v33, 48, v119
    v_lshlrev_b32 v42, 9, v42
    v_lshl_add_u32 v19, v120, 4, v42
    s_mul_i32 s35, s36, 4096
    s_add_u32 s35, s35, 0
    v_xor_b32 v42, v120, v119
    v_lshlrev_b32 v42, 4, v42
    v_lshl_add_u32 v42, v119, 7, v42
    v_add_u32 v21, s35, v42
    v_lshrrev_b32 v119, 1, v37
    v_xor_b32 v118, v120, v119
    v_lshlrev_b32 v118, 4, v118
    v_lshl_add_u32 v118, v43, 7, v118
    v_and_b32 v119, 1, v37
    v_lshl_add_u32 v118, v119, 3, v118
    v_add_u32 v118, s35, v118
    v_xor_b32 v23, 0, v118
    v_xor_b32 v25, 32, v118
    v_xor_b32 v26, 64, v118
    v_xor_b32 v27, 96, v118
    v_add_u32 v31, s38, v2
    s_mov_b32 s29, 0x3db8aa3b
    s_mov_b32 s37, 0x5f800000
    s_mov_b64 s[40:41], 0
    v_mov_b32 v16, 0
    v_mov_b32 v17, 0
    v_mov_b32 v18, 0
    v_add_u32 v108, 8192, v104
    v_add_u32 v109, 8192, v105
    v_add_u32 v110, 8192, v106
    v_add_u32 v111, 8192, v107
    v_add_u32 v112, 16384, v104
    v_add_u32 v113, 16384, v105
    v_add_u32 v114, 16384, v106
    v_add_u32 v115, 16384, v107
    s_mov_b64 exec, 0
    s_cmp_eq_u32 s36, 0
    s_cbranch_scc1 L_pg0
    s_cmp_eq_u32 s36, 1
    s_cbranch_scc1 L_pg1
    s_cmp_eq_u32 s36, 2
    s_cbranch_scc1 L_pg2
    s_cmp_eq_u32 s36, 3
    s_cbranch_scc1 L_pg3
    s_branch L_wdone
L_wr0:
    s_branch L_pg4
L_wr1:
    s_branch L_pg5
L_wr2:
    s_branch L_pg6
L_wr3:
    s_branch L_pg7
L_wr4:
    s_branch L_wdone
L_wr5:
    s_branch L_wdone
L_wr6:
    s_branch L_wdone
L_wr7:
    s_branch L_wdone
L_wdone:
    s_mov_b64 exec, -1
    s_mov_b32 s30, 16384
    s_add_u32 m0, s28, 16384
    s_nop 0
    buffer_load_dwordx4 v10, s[16:19], s30 offen nt lds
    s_add_u32 m0, s28, 20224
    s_nop 0
    buffer_load_dwordx4 v10, s[16:19], s30 offen offset:256 nt lds
    s_add_u32 m0, s28, 24576
    s_nop 0
    buffer_load_dwordx4 v11, s[16:19], s30 offen nt lds
    s_add_u32 m0, s28, 28416
    s_nop 0
    buffer_load_dwordx4 v11, s[16:19], s30 offen offset:256 nt lds
    s_mov_b32 s30, 32768
    s_add_u32 m0, s28, 32768
    s_nop 0
    buffer_load_dwordx4 v10, s[16:19], s30 offen nt lds
    s_add_u32 m0, s28, 36608
    s_nop 0
    buffer_load_dwordx4 v10, s[16:19], s30 offen offset:256 nt lds
    s_add_u32 m0, s28, 40960
    s_nop 0
    buffer_load_dwordx4 v11, s[16:19], s30 offen nt lds
    s_add_u32 m0, s28, 44800
    s_nop 0
    buffer_load_dwordx4 v11, s[16:19], s30 offen offset:256 nt lds
    s_waitcnt vmcnt(14)
    s_barrier
    ds_read_b128 a[64:67], v31 offset:0
    ds_read_b128 v[128:131], v1 offset:0
    ds_read_b128 a[68:71], v31 offset:256
    ds_read_b128 v[132:135], v1 offset:256
    ds_read_b128 a[72:75], v31 offset:512
    ds_read_b128 v[136:139], v1 offset:512
    ds_read_b128 a[76:79], v31 offset:768
    ds_read_b128 v[140:143], v1 offset:768
    ds_read_b128 v[160:163], v1 offset:8192
    ds_read_b128 v[164:167], v1 offset:8448
    ds_read_b128 v[168:171], v1 offset:8704
    ds_read_b128 v[172:175], v1 offset:8960
    s_waitcnt lgkmcnt(10)
    v_mfma_f32_16x16x32_bf16 v[32:35], v[128:131], a[64:67], 0
    s_waitcnt lgkmcnt(8)
    ds_read_b128 v[144:147], v1 offset:4096
    v_mfma_f32_16x16x32_bf16 v[32:35], v[132:135], a[68:71], v[32:35]
    s_waitcnt lgkmcnt(7)
    ds_read_b128 v[148:151], v1 offset:4352
    v_mfma_f32_16x16x32_bf16 v[32:35], v[136:139], a[72:75], v[32:35]
    s_waitcnt lgkmcnt(6)
    ds_read_b128 v[152:155], v1 offset:4608
    v_mfma_f32_16x16x32_bf16 v[32:35], v[140:143], a[76:79], v[32:35]
    s_waitcnt lgkmcnt(6)
    ds_read_b128 v[156:159], v1 offset:4864
    v_mfma_f32_16x16x32_bf16 v[36:39], v[160:163], a[64:67], 0
    s_waitcnt lgkmcnt(6)
    ds_read_b128 v[176:179], v1 offset:12288
    v_mfma_f32_16x16x32_bf16 v[36:39], v[164:167], a[68:71], v[36:39]
    s_waitcnt lgkmcnt(6)
    ds_read_b128 v[180:183], v1 offset:12544
    v_mfma_f32_16x16x32_bf16 v[36:39], v[168:171], a[72:75], v[36:39]
    s_waitcnt lgkmcnt(6)
    ds_read_b128 v[184:187], v1 offset:12800
    v_mfma_f32_16x16x32_bf16 v[36:39], v[172:175], a[76:79], v[36:39]
    ds_read_b128 v[188:191], v1 offset:13056
    s_add_u32 m0, s38, 98304
    s_nop 0
    buffer_load_dwordx4 v108, s[12:15], 0 offen nt lds
    s_add_u32 m0, s38, 99328
    s_nop 0
    buffer_load_dwordx4 v109, s[12:15], 0 offen nt lds
    s_add_u32 m0, s38, 100352
    s_nop 0
    buffer_load_dwordx4 v110, s[12:15], 0 offen nt lds
    s_add_u32 m0, s38, 101376
    s_nop 0
    buffer_load_dwordx4 v111, s[12:15], 0 offen nt lds
    s_waitcnt vmcnt(13)
    ds_read_b128 a[80:83], v31 offset:4096
    ds_read_b128 a[84:87], v31 offset:4352
    ds_read_b128 a[88:91], v31 offset:4608
    ds_read_b128 a[92:95], v31 offset:4864
    s_waitcnt lgkmcnt(3)
    v_mfma_f32_16x16x32_bf16 v[32:35], v[144:147], a[80:83], v[32:35]
    s_waitcnt lgkmcnt(2)
    v_mfma_f32_16x16x32_bf16 v[32:35], v[148:151], a[84:87], v[32:35]
    s_waitcnt lgkmcnt(1)
    v_mfma_f32_16x16x32_bf16 v[32:35], v[152:155], a[88:91], v[32:35]
    s_waitcnt lgkmcnt(0)
    v_mfma_f32_16x16x32_bf16 v[32:35], v[156:159], a[92:95], v[32:35]
    v_mfma_f32_16x16x32_bf16 v[36:39], v[176:179], a[80:83], v[36:39]
    v_mfma_f32_16x16x32_bf16 v[36:39], v[180:183], a[84:87], v[36:39]
    v_mfma_f32_16x16x32_bf16 v[36:39], v[184:187], a[88:91], v[36:39]
    v_mfma_f32_16x16x32_bf16 v[36:39], v[188:191], a[92:95], v[36:39]
    s_nop 3
    v_max3_f32 v20, v32, v33, v34
    s_nop 2
    v_max3_f32 v28, v35, v36, v37
    v_max3_f32 v20, v20, v38, v39
    v_max_f32 v20, v20, v28
    v_mov_b32 v28, v20
    s_nop 1
    v_permlane32_swap_b32 v20, v28
    v_max_f32 v20, v20, v28
    v_mov_b32 v28, v20
    s_nop 1
    v_permlane16_swap_b32 v20, v28
    v_max_f32 v20, v20, v28
    v_mul_f32 v20, 0xbdb8aa3b, v20
    v_fma_f32 v32, v32, s29, v20
    v_fma_f32 v33, v33, s29, v20
    v_exp_f32 v32, v32
    v_fma_f32 v34, v34, s29, v20
    v_exp_f32 v33, v33
    v_fma_f32 v35, v35, s29, v20
    v_add_f32 v16, v16, v32
    v_exp_f32 v34, v34
    v_add_f32 v16, v16, v33
    v_cvt_pk_bf16_f32 v56, v32, v33
    v_exp_f32 v35, v35
    v_add_f32 v16, v16, v34
    v_add_f32 v16, v16, v35
    v_cvt_pk_bf16_f32 v57, v34, v35
    v_fma_f32 v36, v36, s29, v20
    v_fma_f32 v37, v37, s29, v20
    v_exp_f32 v36, v36
    v_fma_f32 v38, v38, s29, v20
    v_exp_f32 v37, v37
    v_fma_f32 v39, v39, s29, v20
    v_add_f32 v16, v16, v36
    v_exp_f32 v38, v38
    v_add_f32 v16, v16, v37
    v_cvt_pk_bf16_f32 v58, v36, v37
    v_exp_f32 v39, v39
    v_add_f32 v16, v16, v38
    v_add_f32 v16, v16, v39
    v_cvt_pk_bf16_f32 v59, v38, v39
    s_mov_b32 s30, 49152
    s_add_u32 m0, s28, 49152
    s_nop 0
    buffer_load_dwordx4 v10, s[16:19], s30 offen nt lds
    s_add_u32 m0, s28, 52992
    s_nop 0
    buffer_load_dwordx4 v10, s[16:19], s30 offen offset:256 nt lds
    s_add_u32 m0, s28, 57344
    s_nop 0
    buffer_load_dwordx4 v11, s[16:19], s30 offen nt lds
    s_add_u32 m0, s28, 61184
    s_nop 0
    buffer_load_dwordx4 v11, s[16:19], s30 offen offset:256 nt lds
    s_waitcnt vmcnt(12)
    s_barrier
    ds_read_b128 v[192:195], v1 offset:16384
    ds_read_b128 v[196:199], v1 offset:16640
    ds_read_b128 v[200:203], v1 offset:16896
    ds_read_b128 v[204:207], v1 offset:17152
    ds_read_b128 v[208:211], v1 offset:20480
    ds_read_b128 v[212:215], v1 offset:20736
    ds_read_b128 v[216:219], v1 offset:20992
    ds_read_b128 v[220:223], v1 offset:21248
    s_waitcnt lgkmcnt(7)
    v_mfma_f32_16x16x32_bf16 v[40:43], v[192:195], a[64:67], 0
    s_waitcnt lgkmcnt(6)
    ds_read_b128 v[224:227], v1 offset:24576
    v_mfma_f32_16x16x32_bf16 v[40:43], v[196:199], a[68:71], v[40:43]
    s_waitcnt lgkmcnt(6)
    ds_read_b128 v[228:231], v1 offset:24832
    v_mfma_f32_16x16x32_bf16 v[40:43], v[200:203], a[72:75], v[40:43]
    s_waitcnt lgkmcnt(6)
    s_add_u32 m0, s38, 102144
    ds_read_b128 v[232:235], v1 offset:25088
    v_mfma_f32_16x16x32_bf16 v[40:43], v[204:207], a[76:79], v[40:43]
    s_waitcnt lgkmcnt(6)
    ds_read_b128 v[236:239], v1 offset:25344
    buffer_load_dwordx4 v108, s[12:15], 0 offen offset:256 nt lds
    v_mfma_f32_16x16x32_bf16 v[40:43], v[208:211], a[80:83], v[40:43]
    s_waitcnt lgkmcnt(6)
    ds_read_b128 v[240:243], v1 offset:28672
    v_mfma_f32_16x16x32_bf16 v[40:43], v[212:215], a[84:87], v[40:43]
    s_waitcnt lgkmcnt(6)
    ds_read_b128 v[244:247], v1 offset:28928
    v_mfma_f32_16x16x32_bf16 v[40:43], v[216:219], a[88:91], v[40:43]
    s_waitcnt lgkmcnt(6)
    ds_read_b128 v[248:251], v1 offset:29184
    v_mfma_f32_16x16x32_bf16 v[40:43], v[220:223], a[92:95], v[40:43]
    s_waitcnt lgkmcnt(6)
    ds_read_b128 v[252:255], v1 offset:29440
    s_waitcnt vmcnt(9)
    s_barrier
    v_mfma_f32_16x16x32_bf16 v[44:47], v[224:227], a[64:67], 0
    s_waitcnt lgkmcnt(6)
    s_add_u32 m0, s38, 103168
    ds_read_b128 a[0:3], v1 offset:32768
    v_mfma_f32_16x16x32_bf16 v[44:47], v[228:231], a[68:71], v[44:47]
    s_waitcnt lgkmcnt(6)
    ds_read_b128 a[4:7], v1 offset:33024
    buffer_load_dwordx4 v109, s[12:15], 0 offen offset:256 nt lds
    v_mfma_f32_16x16x32_bf16 v[44:47], v[232:235], a[72:75], v[44:47]
    s_add_u32 m0, s38, 104192
    s_waitcnt lgkmcnt(6)
    ds_read_b128 a[8:11], v1 offset:33280
    v_mfma_f32_16x16x32_bf16 v[44:47], v[236:239], a[76:79], v[44:47]
    s_waitcnt lgkmcnt(6)
    ds_read_b128 a[12:15], v1 offset:33536
    v_fma_f32 v40, v40, s29, v20
    v_fma_f32 v41, v41, s29, v20
    v_mfma_f32_16x16x32_bf16 v[44:47], v[240:243], a[80:83], v[44:47]
    s_waitcnt lgkmcnt(6)
    ds_read_b128 a[16:19], v1 offset:36864
    v_exp_f32 v40, v40
    v_fma_f32 v42, v42, s29, v20
    v_mfma_f32_16x16x32_bf16 v[44:47], v[244:247], a[84:87], v[44:47]
    s_waitcnt lgkmcnt(6)
    ds_read_b128 a[20:23], v1 offset:37120
    v_exp_f32 v41, v41
    v_fma_f32 v43, v43, s29, v20
    v_mfma_f32_16x16x32_bf16 v[44:47], v[248:251], a[88:91], v[44:47]
    s_waitcnt lgkmcnt(6)
    ds_read_b128 a[24:27], v1 offset:37376
    v_exp_f32 v42, v42
    v_add_f32 v16, v16, v40
    v_mfma_f32_16x16x32_bf16 v[44:47], v[252:255], a[92:95], v[44:47]
    s_waitcnt lgkmcnt(6)
    ds_read_b128 a[28:31], v1 offset:37632
    buffer_load_dwordx4 v110, s[12:15], 0 offen offset:256 nt lds
    v_exp_f32 v43, v43
    v_add_f32 v16, v16, v41
    v_mfma_f32_16x16x32_bf16 v[48:51], a[0:3], a[64:67], 0
    s_waitcnt lgkmcnt(6)
    ds_read_b128 a[32:35], v1 offset:40960
    v_cvt_pk_bf16_f32 v60, v40, v41
    v_add_f32 v16, v16, v42
    v_mfma_f32_16x16x32_bf16 v[48:51], a[4:7], a[68:71], v[48:51]
    s_waitcnt lgkmcnt(6)
    ds_read_b128 a[36:39], v1 offset:41216
    v_add_f32 v16, v16, v43
    v_cvt_pk_bf16_f32 v61, v42, v43
    v_mfma_f32_16x16x32_bf16 v[48:51], a[8:11], a[72:75], v[48:51]
    s_add_u32 m0, s38, 105216
    s_waitcnt lgkmcnt(6)
    ds_read_b128 a[40:43], v1 offset:41472
    v_mfma_f32_16x16x32_bf16 v[48:51], a[12:15], a[76:79], v[48:51]
    s_waitcnt lgkmcnt(6)
    ds_read_b128 a[44:47], v1 offset:41728
    v_fma_f32 v44, v44, s29, v20
    v_fma_f32 v45, v45, s29, v20
    v_mfma_f32_16x16x32_bf16 v[48:51], a[16:19], a[80:83], v[48:51]
    s_waitcnt lgkmcnt(6)
    ds_read_b128 a[48:51], v1 offset:45056
    v_exp_f32 v44, v44
    v_fma_f32 v46, v46, s29, v20
    v_mfma_f32_16x16x32_bf16 v[48:51], a[20:23], a[84:87], v[48:51]
    s_waitcnt lgkmcnt(6)
    ds_read_b128 a[52:55], v1 offset:45312
    buffer_load_dwordx4 v111, s[12:15], 0 offen offset:256 nt lds
    v_exp_f32 v45, v45
    v_fma_f32 v47, v47, s29, v20
    v_mfma_f32_16x16x32_bf16 v[48:51], a[24:27], a[88:91], v[48:51]
    s_waitcnt lgkmcnt(6)
    ds_read_b128 a[56:59], v1 offset:45568
    v_exp_f32 v46, v46
    v_add_f32 v16, v16, v44
    v_mfma_f32_16x16x32_bf16 v[48:51], a[28:31], a[92:95], v[48:51]
    s_waitcnt lgkmcnt(6)
    ds_read_b128 a[60:63], v1 offset:45824
    v_exp_f32 v47, v47
    v_add_f32 v16, v16, v45
    v_mfma_f32_16x16x32_bf16 v[52:55], a[32:35], a[64:67], 0
    s_waitcnt lgkmcnt(6)
    v_cvt_pk_bf16_f32 v62, v44, v45
    v_add_f32 v16, v16, v46
    v_add_f32 v16, v16, v47
    v_mfma_f32_16x16x32_bf16 v[52:55], a[36:39], a[68:71], v[52:55]
    s_waitcnt lgkmcnt(5)
    v_cvt_pk_bf16_f32 v63, v46, v47
    v_mfma_f32_16x16x32_bf16 v[52:55], a[40:43], a[72:75], v[52:55]
    s_waitcnt lgkmcnt(4)
    v_mfma_f32_16x16x32_bf16 v[52:55], a[44:47], a[76:79], v[52:55]
    s_waitcnt lgkmcnt(3)
    v_fma_f32 v48, v48, s29, v20
    v_fma_f32 v49, v49, s29, v20
    v_fma_f32 v50, v50, s29, v20
    v_mfma_f32_16x16x32_bf16 v[52:55], a[48:51], a[80:83], v[52:55]
    s_waitcnt lgkmcnt(2)
    v_exp_f32 v48, v48
    v_fma_f32 v51, v51, s29, v20
    v_mfma_f32_16x16x32_bf16 v[52:55], a[52:55], a[84:87], v[52:55]
    s_waitcnt lgkmcnt(1)
    v_exp_f32 v49, v49
    v_add_f32 v16, v16, v48
    v_mfma_f32_16x16x32_bf16 v[52:55], a[56:59], a[88:91], v[52:55]
    s_waitcnt lgkmcnt(0)
    v_exp_f32 v50, v50
    v_add_f32 v16, v16, v49
    v_mfma_f32_16x16x32_bf16 v[52:55], a[60:63], a[92:95], v[52:55]
    v_exp_f32 v51, v51
    v_cvt_pk_bf16_f32 v80, v48, v49
    s_add_u32 m0, s38, 131072
    s_nop 0
    buffer_load_dwordx4 v112, s[12:15], 0 offen nt lds
    s_add_u32 m0, s38, 132096
    s_nop 0
    buffer_load_dwordx4 v113, s[12:15], 0 offen nt lds
    s_add_u32 m0, s38, 133120
    s_nop 0
    buffer_load_dwordx4 v114, s[12:15], 0 offen nt lds
    s_add_u32 m0, s38, 134144
    s_nop 0
    buffer_load_dwordx4 v115, s[12:15], 0 offen nt lds
    s_waitcnt vmcnt(12)
    ds_read_b128 a[96:99], v31 offset:32768
    ds_read_b128 a[100:103], v31 offset:33024
    ds_read_b128 a[104:107], v31 offset:33280
    ds_read_b128 a[108:111], v31 offset:33536
    s_waitcnt lgkmcnt(3)
    v_mfma_f32_16x16x32_bf16 v[72:75], v[128:131], a[96:99], 0
    s_waitcnt lgkmcnt(2)
    v_add_f32 v16, v16, v50
    v_add_f32 v16, v16, v51
    v_cvt_pk_bf16_f32 v81, v50, v51
    v_mfma_f32_16x16x32_bf16 v[72:75], v[132:135], a[100:103], v[72:75]
    s_waitcnt lgkmcnt(1)
    v_mfma_f32_16x16x32_bf16 v[72:75], v[136:139], a[104:107], v[72:75]
    s_waitcnt lgkmcnt(0)
    v_mfma_f32_16x16x32_bf16 v[72:75], v[140:143], a[108:111], v[72:75]
    v_fma_f32 v52, v52, s29, v20
    v_fma_f32 v53, v53, s29, v20
    v_fma_f32 v54, v54, s29, v20
    v_mfma_f32_16x16x32_bf16 v[76:79], v[160:163], a[96:99], 0
    v_exp_f32 v52, v52
    v_fma_f32 v55, v55, s29, v20
    v_mfma_f32_16x16x32_bf16 v[76:79], v[164:167], a[100:103], v[76:79]
    v_exp_f32 v53, v53
    v_add_f32 v16, v16, v52
    v_mfma_f32_16x16x32_bf16 v[76:79], v[168:171], a[104:107], v[76:79]
    v_exp_f32 v54, v54
    v_add_f32 v16, v16, v53
    v_mfma_f32_16x16x32_bf16 v[76:79], v[172:175], a[108:111], v[76:79]
    v_exp_f32 v55, v55
    v_cvt_pk_bf16_f32 v82, v52, v53
    v_mfma_f32_16x16x32_bf16 v[96:99], v[192:195], a[96:99], 0
    v_add_f32 v16, v16, v54
    v_add_f32 v16, v16, v55
    v_cvt_pk_bf16_f32 v83, v54, v55
    v_mfma_f32_16x16x32_bf16 v[96:99], v[196:199], a[100:103], v[96:99]
    v_mfma_f32_16x16x32_bf16 v[96:99], v[200:203], a[104:107], v[96:99]
    v_mfma_f32_16x16x32_bf16 v[96:99], v[204:207], a[108:111], v[96:99]
    v_mfma_f32_16x16x32_bf16 v[100:103], v[224:227], a[96:99], 0
L_pg0:
    s_cbranch_execz L_wr0
    v_mfma_f32_16x16x32_bf16 v[100:103], v[228:231], a[100:103], v[100:103]
    v_mfma_f32_16x16x32_bf16 v[100:103], v[232:235], a[104:107], v[100:103]
    v_mfma_f32_16x16x32_bf16 v[100:103], v[236:239], a[108:111], v[100:103]
    v_mfma_f32_16x16x32_bf16 v[116:119], a[0:3], a[96:99], 0
    v_mfma_f32_16x16x32_bf16 v[116:119], a[4:7], a[100:103], v[116:119]
    v_mfma_f32_16x16x32_bf16 v[116:119], a[8:11], a[104:107], v[116:119]
    v_mfma_f32_16x16x32_bf16 v[116:119], a[12:15], a[108:111], v[116:119]
    v_mfma_f32_16x16x32_bf16 v[120:123], a[32:35], a[96:99], 0
    v_mfma_f32_16x16x32_bf16 v[120:123], a[36:39], a[100:103], v[120:123]
    v_mfma_f32_16x16x32_bf16 v[120:123], a[40:43], a[104:107], v[120:123]
    v_mfma_f32_16x16x32_bf16 v[120:123], a[44:47], a[108:111], v[120:123]
    s_add_u32 m0, s38, 134912
    s_nop 0
    buffer_load_dwordx4 v112, s[12:15], 0 offen offset:256 nt lds
    s_add_u32 m0, s38, 135936
    s_nop 0
    buffer_load_dwordx4 v113, s[12:15], 0 offen offset:256 nt lds
    s_add_u32 m0, s38, 136960
    s_nop 0
    buffer_load_dwordx4 v114, s[12:15], 0 offen offset:256 nt lds
    s_add_u32 m0, s38, 137984
    s_nop 0
    buffer_load_dwordx4 v115, s[12:15], 0 offen offset:256 nt lds
    s_waitcnt vmcnt(12)
    s_barrier
    ds_read_b128 a[192:195], v1 offset:49152
    ds_read_b128 a[196:199], v1 offset:49408
    ds_read_b128 a[200:203], v1 offset:49664
    ds_read_b128 a[204:207], v1 offset:49920
    ds_read_b128 a[208:211], v1 offset:53248
    ds_read_b128 a[212:215], v1 offset:53504
    ds_read_b128 a[216:219], v1 offset:53760
    ds_read_b128 a[220:223], v1 offset:54016
    s_waitcnt lgkmcnt(7)
    v_mfma_f32_16x16x32_bf16 v[124:127], a[192:195], a[64:67], 0
    s_waitcnt lgkmcnt(6)
    ds_read_b128 a[224:227], v1 offset:57344
    v_mfma_f32_16x16x32_bf16 v[124:127], a[196:199], a[68:71], v[124:127]
    s_waitcnt lgkmcnt(6)
    ds_read_b128 a[228:231], v1 offset:57600
    v_mfma_f32_16x16x32_bf16 v[124:127], a[200:203], a[72:75], v[124:127]
    s_waitcnt lgkmcnt(6)
    ds_read_b128 a[232:235], v1 offset:57856
    v_mfma_f32_16x16x32_bf16 v[124:127], a[204:207], a[76:79], v[124:127]
    s_waitcnt lgkmcnt(6)
    ds_read_b128 a[236:239], v1 offset:58112
    v_mfma_f32_16x16x32_bf16 v[124:127], a[208:211], a[80:83], v[124:127]
    s_waitcnt lgkmcnt(6)
    ds_read_b128 a[240:243], v1 offset:61440
    v_mfma_f32_16x16x32_bf16 v[124:127], a[212:215], a[84:87], v[124:127]
    s_waitcnt lgkmcnt(6)
    ds_read_b128 a[244:247], v1 offset:61696
    v_mfma_f32_16x16x32_bf16 v[124:127], a[216:219], a[88:91], v[124:127]
    s_waitcnt lgkmcnt(6)
    ds_read_b128 a[248:251], v1 offset:61952
    v_mfma_f32_16x16x32_bf16 v[124:127], a[220:223], a[92:95], v[124:127]
    s_waitcnt lgkmcnt(6)
    ds_read_b128 a[252:255], v1 offset:62208
    v_mfma_f32_16x16x32_bf16 v[104:107], a[224:227], a[64:67], 0
    s_waitcnt lgkmcnt(6)
    v_mfma_f32_16x16x32_bf16 v[104:107], a[228:231], a[68:71], v[104:107]
    s_waitcnt lgkmcnt(5)
    v_mfma_f32_16x16x32_bf16 v[104:107], a[232:235], a[72:75], v[104:107]
    s_waitcnt lgkmcnt(4)
    v_mfma_f32_16x16x32_bf16 v[104:107], a[236:239], a[76:79], v[104:107]
    s_waitcnt lgkmcnt(3)
    v_fma_f32 v124, v124, s29, v20
    v_fma_f32 v125, v125, s29, v20
    v_fma_f32 v126, v126, s29, v20
    v_mfma_f32_16x16x32_bf16 v[104:107], a[240:243], a[80:83], v[104:107]
    s_waitcnt lgkmcnt(2)
    v_exp_f32 v124, v124
    v_fma_f32 v127, v127, s29, v20
    v_mfma_f32_16x16x32_bf16 v[104:107], a[244:247], a[84:87], v[104:107]
    s_waitcnt lgkmcnt(1)
    v_exp_f32 v125, v125
    v_add_f32 v16, v16, v124
    v_mfma_f32_16x16x32_bf16 v[104:107], a[248:251], a[88:91], v[104:107]
    s_waitcnt lgkmcnt(0)
    v_exp_f32 v126, v126
    v_add_f32 v16, v16, v125
    v_mfma_f32_16x16x32_bf16 v[104:107], a[252:255], a[92:95], v[104:107]
    v_exp_f32 v127, v127
    v_cvt_pk_bf16_f32 v84, v124, v125
    v_mfma_f32_16x16x32_bf16 v[108:111], a[192:195], a[96:99], 0
    v_add_f32 v16, v16, v126
    v_add_f32 v16, v16, v127
    v_cvt_pk_bf16_f32 v85, v126, v127
    v_mfma_f32_16x16x32_bf16 v[108:111], a[196:199], a[100:103], v[108:111]
    v_mfma_f32_16x16x32_bf16 v[108:111], a[200:203], a[104:107], v[108:111]
    v_mfma_f32_16x16x32_bf16 v[108:111], a[204:207], a[108:111], v[108:111]
    v_fma_f32 v104, v104, s29, v20
    v_fma_f32 v105, v105, s29, v20
    v_fma_f32 v106, v106, s29, v20
    v_mfma_f32_16x16x32_bf16 v[112:115], a[224:227], a[96:99], 0
    v_exp_f32 v104, v104
    v_fma_f32 v107, v107, s29, v20
    v_mfma_f32_16x16x32_bf16 v[112:115], a[228:231], a[100:103], v[112:115]
    v_exp_f32 v105, v105
    v_add_f32 v16, v16, v104
    v_mfma_f32_16x16x32_bf16 v[112:115], a[232:235], a[104:107], v[112:115]
    v_exp_f32 v106, v106
    v_add_f32 v16, v16, v105
    v_mfma_f32_16x16x32_bf16 v[112:115], a[236:239], a[108:111], v[112:115]
    v_exp_f32 v107, v107
    v_cvt_pk_bf16_f32 v86, v104, v105
    v_add_f32 v16, v16, v106
    v_add_f32 v16, v16, v107
    v_cvt_pk_bf16_f32 v87, v106, v107
    s_mov_b32 s30, 65536
    s_add_u32 m0, s28, 65536
    s_nop 0
    buffer_load_dwordx4 v10, s[16:19], s30 offen nt lds
    s_add_u32 m0, s28, 69376
    s_nop 0
    buffer_load_dwordx4 v10, s[16:19], s30 offen offset:256 nt lds
    s_add_u32 m0, s28, 73728
    s_nop 0
    buffer_load_dwordx4 v11, s[16:19], s30 offen nt lds
    s_add_u32 m0, s28, 77568
    s_nop 0
    buffer_load_dwordx4 v11, s[16:19], s30 offen offset:256 nt lds
    s_waitcnt vmcnt(12)
    ds_read_b128 a[112:115], v31 offset:36864
    ds_read_b128 a[116:119], v31 offset:37120
    ds_read_b128 a[120:123], v31 offset:37376
    ds_read_b128 a[124:127], v31 offset:37632
    s_waitcnt lgkmcnt(0)
    s_barrier
    v_mfma_f32_16x16x32_bf16 v[72:75], v[144:147], a[112:115], v[72:75]
    v_mfma_f32_16x16x32_bf16 v[72:75], v[148:151], a[116:119], v[72:75]
    v_mfma_f32_16x16x32_bf16 v[72:75], v[152:155], a[120:123], v[72:75]
    v_mfma_f32_16x16x32_bf16 v[72:75], v[156:159], a[124:127], v[72:75]
    v_mfma_f32_16x16x32_bf16 v[76:79], v[176:179], a[112:115], v[76:79]
    v_mfma_f32_16x16x32_bf16 v[76:79], v[180:183], a[116:119], v[76:79]
    v_mfma_f32_16x16x32_bf16 v[76:79], v[184:187], a[120:123], v[76:79]
    v_mfma_f32_16x16x32_bf16 v[76:79], v[188:191], a[124:127], v[76:79]
    v_mfma_f32_16x16x32_bf16 v[96:99], v[208:211], a[112:115], v[96:99]
    v_mfma_f32_16x16x32_bf16 v[96:99], v[212:215], a[116:119], v[96:99]
    v_mfma_f32_16x16x32_bf16 v[96:99], v[216:219], a[120:123], v[96:99]
    v_mfma_f32_16x16x32_bf16 v[96:99], v[220:223], a[124:127], v[96:99]
    v_max3_f32 v22, v72, v73, v74
    s_nop 2
    v_max3_f32 v29, v75, v76, v77
    v_max3_f32 v22, v22, v78, v79
    v_mfma_f32_16x16x32_bf16 v[100:103], v[240:243], a[112:115], v[100:103]
    v_max_f32 v22, v22, v29
    v_mov_b32 v29, v22
    v_mfma_f32_16x16x32_bf16 v[100:103], v[244:247], a[116:119], v[100:103]
    s_nop 0
    v_permlane32_swap_b32 v22, v29
    v_max_f32 v22, v22, v29
    v_mov_b32 v29, v22
    v_mfma_f32_16x16x32_bf16 v[100:103], v[248:251], a[120:123], v[100:103]
    s_nop 0
    v_permlane16_swap_b32 v22, v29
    v_max_f32 v22, v22, v29
    v_mul_f32 v22, 0xbdb8aa3b, v22
    v_mfma_f32_16x16x32_bf16 v[100:103], v[252:255], a[124:127], v[100:103]
    v_fma_f32 v72, v72, s29, v22
    v_fma_f32 v73, v73, s29, v22
    v_fma_f32 v74, v74, s29, v22
    v_mfma_f32_16x16x32_bf16 v[108:111], a[208:211], a[112:115], v[108:111]
    v_exp_f32 v72, v72
    v_fma_f32 v75, v75, s29, v22
    v_mfma_f32_16x16x32_bf16 v[108:111], a[212:215], a[116:119], v[108:111]
    v_exp_f32 v73, v73
    v_add_f32 v17, v17, v72
    v_mfma_f32_16x16x32_bf16 v[108:111], a[216:219], a[120:123], v[108:111]
    v_exp_f32 v74, v74
    v_add_f32 v17, v17, v73
    v_mfma_f32_16x16x32_bf16 v[108:111], a[220:223], a[124:127], v[108:111]
    v_exp_f32 v75, v75
    v_cvt_pk_bf16_f32 v64, v72, v73
    v_mfma_f32_16x16x32_bf16 v[112:115], a[240:243], a[112:115], v[112:115]
    v_add_f32 v17, v17, v74
    v_add_f32 v17, v17, v75
    v_cvt_pk_bf16_f32 v65, v74, v75
    v_mfma_f32_16x16x32_bf16 v[112:115], a[244:247], a[116:119], v[112:115]
    v_fma_f32 v76, v76, s29, v22
    v_fma_f32 v77, v77, s29, v22
    v_fma_f32 v78, v78, s29, v22
    v_mfma_f32_16x16x32_bf16 v[112:115], a[248:251], a[120:123], v[112:115]
    v_exp_f32 v76, v76
    v_fma_f32 v79, v79, s29, v22
    v_mfma_f32_16x16x32_bf16 v[112:115], a[252:255], a[124:127], v[112:115]
    v_exp_f32 v77, v77
    v_add_f32 v17, v17, v76
    v_mfma_f32_16x16x32_bf16 v[116:119], a[16:19], a[112:115], v[116:119]
    v_exp_f32 v78, v78
    v_add_f32 v17, v17, v77
    v_mfma_f32_16x16x32_bf16 v[116:119], a[20:23], a[116:119], v[116:119]
    v_exp_f32 v79, v79
    v_cvt_pk_bf16_f32 v66, v76, v77
    v_mfma_f32_16x16x32_bf16 v[116:119], a[24:27], a[120:123], v[116:119]
    v_add_f32 v17, v17, v78
    v_add_f32 v17, v17, v79
    v_cvt_pk_bf16_f32 v67, v78, v79
    v_mfma_f32_16x16x32_bf16 v[116:119], a[28:31], a[124:127], v[116:119]
    v_fma_f32 v96, v96, s29, v22
    v_fma_f32 v97, v97, s29, v22
    v_fma_f32 v98, v98, s29, v22
    v_mfma_f32_16x16x32_bf16 v[120:123], a[48:51], a[112:115], v[120:123]
    v_exp_f32 v96, v96
    v_fma_f32 v99, v99, s29, v22
    v_mfma_f32_16x16x32_bf16 v[120:123], a[52:55], a[116:119], v[120:123]
    v_exp_f32 v97, v97
    v_add_f32 v17, v17, v96
    v_mfma_f32_16x16x32_bf16 v[120:123], a[56:59], a[120:123], v[120:123]
    v_exp_f32 v98, v98
    v_add_f32 v17, v17, v97
    v_mfma_f32_16x16x32_bf16 v[120:123], a[60:63], a[124:127], v[120:123]
    v_exp_f32 v99, v99
    v_cvt_pk_bf16_f32 v68, v96, v97
    s_mov_b32 s31, 0
    s_add_u32 m0, s28, 81920
    s_nop 0
    buffer_load_dwordx4 v12, s[20:23], s31 offen nt lds
    s_add_u32 m0, s28, 86016
    s_nop 0
    buffer_load_dwordx4 v13, s[20:23], s31 offen nt lds
    s_add_u32 m0, s28, 90112
    s_nop 0
    buffer_load_dwordx4 v14, s[20:23], s31 offen nt lds
    s_add_u32 m0, s28, 94208
    s_nop 0
    buffer_load_dwordx4 v15, s[20:23], s31 offen nt lds
    v_add_u32 v30, 0x10000, v31
    s_waitcnt vmcnt(12)
    ds_read_b128 a[128:131], v30 offset:0
    ds_read_b128 a[132:135], v30 offset:256
    ds_read_b128 a[136:139], v30 offset:512
    ds_read_b128 a[140:143], v30 offset:768
    s_waitcnt lgkmcnt(3)
    v_mfma_f32_16x16x32_bf16 v[32:35], v[128:131], a[128:131], 0
    s_waitcnt lgkmcnt(2)
    v_add_f32 v17, v17, v98
    v_add_f32 v17, v17, v99
    v_cvt_pk_bf16_f32 v69, v98, v99
    v_mfma_f32_16x16x32_bf16 v[32:35], v[132:135], a[132:135], v[32:35]
    s_waitcnt lgkmcnt(1)
    v_fma_f32 v100, v100, s29, v22
    v_fma_f32 v101, v101, s29, v22
    v_fma_f32 v102, v102, s29, v22
    v_mfma_f32_16x16x32_bf16 v[32:35], v[136:139], a[136:139], v[32:35]
    s_waitcnt lgkmcnt(0)
    v_exp_f32 v100, v100
    v_fma_f32 v103, v103, s29, v22
    v_mfma_f32_16x16x32_bf16 v[32:35], v[140:143], a[140:143], v[32:35]
    v_exp_f32 v101, v101
    v_add_f32 v17, v17, v100
    v_mfma_f32_16x16x32_bf16 v[36:39], v[160:163], a[128:131], 0
    v_exp_f32 v102, v102
    v_add_f32 v17, v17, v101
    v_mfma_f32_16x16x32_bf16 v[36:39], v[164:167], a[132:135], v[36:39]
    v_exp_f32 v103, v103
    v_cvt_pk_bf16_f32 v70, v100, v101
    v_mfma_f32_16x16x32_bf16 v[36:39], v[168:171], a[136:139], v[36:39]
    v_add_f32 v17, v17, v102
    v_add_f32 v17, v17, v103
    v_cvt_pk_bf16_f32 v71, v102, v103
    v_mfma_f32_16x16x32_bf16 v[36:39], v[172:175], a[140:143], v[36:39]
    v_fma_f32 v108, v108, s29, v22
    v_fma_f32 v109, v109, s29, v22
    v_fma_f32 v110, v110, s29, v22
    v_mfma_f32_16x16x32_bf16 v[40:43], v[192:195], a[128:131], 0
    v_exp_f32 v108, v108
    v_fma_f32 v111, v111, s29, v22
    v_mfma_f32_16x16x32_bf16 v[40:43], v[196:199], a[132:135], v[40:43]
    v_exp_f32 v109, v109
    v_add_f32 v17, v17, v108
    v_mfma_f32_16x16x32_bf16 v[40:43], v[200:203], a[136:139], v[40:43]
    v_exp_f32 v110, v110
    v_add_f32 v17, v17, v109
    v_mfma_f32_16x16x32_bf16 v[40:43], v[204:207], a[140:143], v[40:43]
    v_exp_f32 v111, v111
    v_cvt_pk_bf16_f32 v92, v108, v109
    v_mfma_f32_16x16x32_bf16 v[44:47], v[224:227], a[128:131], 0
    v_add_f32 v17, v17, v110
    v_add_f32 v17, v17, v111
    v_cvt_pk_bf16_f32 v93, v110, v111
    v_mfma_f32_16x16x32_bf16 v[44:47], v[228:231], a[132:135], v[44:47]
    v_fma_f32 v112, v112, s29, v22
    v_fma_f32 v113, v113, s29, v22
    v_fma_f32 v114, v114, s29, v22
    v_mfma_f32_16x16x32_bf16 v[44:47], v[232:235], a[136:139], v[44:47]
    v_exp_f32 v112, v112
    v_fma_f32 v115, v115, s29, v22
    v_mfma_f32_16x16x32_bf16 v[44:47], v[236:239], a[140:143], v[44:47]
    v_exp_f32 v113, v113
    v_add_f32 v17, v17, v112
    v_mfma_f32_16x16x32_bf16 v[48:51], a[192:195], a[128:131], 0
    v_exp_f32 v114, v114
    v_add_f32 v17, v17, v113
    v_mfma_f32_16x16x32_bf16 v[48:51], a[196:199], a[132:135], v[48:51]
    v_exp_f32 v115, v115
    v_cvt_pk_bf16_f32 v94, v112, v113
    v_mfma_f32_16x16x32_bf16 v[48:51], a[200:203], a[136:139], v[48:51]
    v_add_f32 v17, v17, v114
    v_add_f32 v17, v17, v115
    v_cvt_pk_bf16_f32 v95, v114, v115
    v_mfma_f32_16x16x32_bf16 v[48:51], a[204:207], a[140:143], v[48:51]
    v_fma_f32 v116, v116, s29, v22
    v_fma_f32 v117, v117, s29, v22
    v_fma_f32 v118, v118, s29, v22
    v_mfma_f32_16x16x32_bf16 v[52:55], a[224:227], a[128:131], 0
    v_exp_f32 v116, v116
    v_fma_f32 v119, v119, s29, v22
    v_mfma_f32_16x16x32_bf16 v[52:55], a[228:231], a[132:135], v[52:55]
    v_exp_f32 v117, v117
    v_add_f32 v17, v17, v116
    v_mfma_f32_16x16x32_bf16 v[52:55], a[232:235], a[136:139], v[52:55]
    v_exp_f32 v118, v118
    v_add_f32 v17, v17, v117
    v_mfma_f32_16x16x32_bf16 v[52:55], a[236:239], a[140:143], v[52:55]
    v_exp_f32 v119, v119
    v_cvt_pk_bf16_f32 v88, v116, v117
    v_add_f32 v17, v17, v118
    v_add_f32 v17, v17, v119
    v_cvt_pk_bf16_f32 v89, v118, v119
    v_mfma_f32_16x16x32_bf16 v[116:119], a[0:3], a[128:131], 0
    v_fma_f32 v120, v120, s29, v22
    v_fma_f32 v121, v121, s29, v22
    v_fma_f32 v122, v122, s29, v22
    v_mfma_f32_16x16x32_bf16 v[116:119], a[4:7], a[132:135], v[116:119]
    v_exp_f32 v120, v120
    v_fma_f32 v123, v123, s29, v22
    v_mfma_f32_16x16x32_bf16 v[116:119], a[8:11], a[136:139], v[116:119]
    v_exp_f32 v121, v121
    v_add_f32 v17, v17, v120
    v_mfma_f32_16x16x32_bf16 v[116:119], a[12:15], a[140:143], v[116:119]
    v_exp_f32 v122, v122
    v_add_f32 v17, v17, v121
    v_add_f32 v17, v17, v122
    v_exp_f32 v123, v123
    s_nop 0
    v_add_f32 v17, v17, v123
    v_cvt_pk_bf16_f32 v90, v120, v121
    v_cvt_pk_bf16_f32 v91, v122, v123
    v_mfma_f32_16x16x32_bf16 v[120:123], a[32:35], a[128:131], 0
    v_mfma_f32_16x16x32_bf16 v[120:123], a[36:39], a[132:135], v[120:123]
    v_mfma_f32_16x16x32_bf16 v[120:123], a[40:43], a[136:139], v[120:123]
    v_mfma_f32_16x16x32_bf16 v[120:123], a[44:47], a[140:143], v[120:123]
    s_mov_b32 s30, 81920
    s_waitcnt vmcnt(8)
    ds_read_b128 a[144:147], v30 offset:4096
    ds_read_b128 a[148:151], v30 offset:4352
    ds_read_b128 a[152:155], v30 offset:4608
    ds_read_b128 a[156:159], v30 offset:4864
    s_waitcnt lgkmcnt(3)
    v_mfma_f32_16x16x32_bf16 v[32:35], v[144:147], a[144:147], v[32:35]
    s_waitcnt lgkmcnt(2)
    s_add_u32 m0, s28, 0
    v_mfma_f32_16x16x32_bf16 v[32:35], v[148:151], a[148:151], v[32:35]
    s_waitcnt lgkmcnt(1)
    buffer_load_dwordx4 v10, s[16:19], s30 offen nt lds
    v_mfma_f32_16x16x32_bf16 v[32:35], v[152:155], a[152:155], v[32:35]
    s_waitcnt lgkmcnt(0)
    v_mfma_f32_16x16x32_bf16 v[32:35], v[156:159], a[156:159], v[32:35]
    s_add_u32 m0, s28, 3840
    v_mfma_f32_16x16x32_bf16 v[36:39], v[176:179], a[144:147], v[36:39]
    buffer_load_dwordx4 v10, s[16:19], s30 offen offset:256 nt lds
    v_mfma_f32_16x16x32_bf16 v[36:39], v[180:183], a[148:151], v[36:39]
    v_mfma_f32_16x16x32_bf16 v[36:39], v[184:187], a[152:155], v[36:39]
    s_add_u32 m0, s28, 8192
    v_mfma_f32_16x16x32_bf16 v[36:39], v[188:191], a[156:159], v[36:39]
    buffer_load_dwordx4 v11, s[16:19], s30 offen nt lds
    v_mfma_f32_16x16x32_bf16 v[40:43], v[208:211], a[144:147], v[40:43]
    v_mfma_f32_16x16x32_bf16 v[40:43], v[212:215], a[148:151], v[40:43]
    s_add_u32 m0, s28, 12032
    v_mfma_f32_16x16x32_bf16 v[40:43], v[216:219], a[152:155], v[40:43]
    s_mov_b32 s31, 256
    buffer_load_dwordx4 v11, s[16:19], s30 offen offset:256 nt lds
    v_mfma_f32_16x16x32_bf16 v[40:43], v[220:223], a[156:159], v[40:43]
    s_waitcnt vmcnt(8)
    v_max3_f32 v24, v32, v33, v34
    v_max3_f32 v30, v35, v36, v37
    v_max3_f32 v24, v24, v38, v39
    v_mfma_f32_16x16x32_bf16 v[44:47], v[240:243], a[144:147], v[44:47]
    s_barrier
    v_max_f32 v24, v24, v30
    v_mov_b32 v30, v24
    v_mfma_f32_16x16x32_bf16 v[44:47], v[244:247], a[148:151], v[44:47]
    s_add_u32 m0, s28, 16384
    ds_read_b128 a[160:163], v2 offset:0
    v_permlane32_swap_b32 v24, v30
    v_mfma_f32_16x16x32_bf16 v[44:47], v[248:251], a[152:155], v[44:47]
    buffer_load_dwordx4 v12, s[20:23], s31 offen nt lds
    v_mfma_f32_16x16x32_bf16 v[44:47], v[252:255], a[156:159], v[44:47]
    ds_read_b128 a[164:167], v2 offset:256
    v_max_f32 v24, v24, v30
    v_mov_b32 v30, v24
    v_mfma_f32_16x16x32_bf16 v[48:51], a[208:211], a[144:147], v[48:51]
    s_nop 0
    v_permlane16_swap_b32 v24, v30
    v_max_f32 v24, v24, v30
    v_mul_f32 v24, 0xbdb8aa3b, v24
    v_mfma_f32_16x16x32_bf16 v[48:51], a[212:215], a[148:151], v[48:51]
    s_add_u32 m0, s28, 20480
    ds_read_b128 a[168:171], v2 offset:512
    v_fma_f32 v32, v32, s29, v24
    v_mfma_f32_16x16x32_bf16 v[48:51], a[216:219], a[152:155], v[48:51]
    buffer_load_dwordx4 v13, s[20:23], s31 offen nt lds
    v_mfma_f32_16x16x32_bf16 v[48:51], a[220:223], a[156:159], v[48:51]
    ds_read_b128 a[172:175], v2 offset:768
    v_fma_f32 v33, v33, s29, v24
    v_fma_f32 v34, v34, s29, v24
    v_mfma_f32_16x16x32_bf16 v[52:55], a[240:243], a[144:147], v[52:55]
    v_exp_f32 v32, v32
    v_fma_f32 v35, v35, s29, v24
    v_mfma_f32_16x16x32_bf16 v[52:55], a[244:247], a[148:151], v[52:55]
    s_add_u32 m0, s28, 24576
    ds_read_b128 a[176:179], v2 offset:4096
    v_add_f32 v18, v18, v32
    v_mfma_f32_16x16x32_bf16 v[52:55], a[248:251], a[152:155], v[52:55]
    buffer_load_dwordx4 v14, s[20:23], s31 offen nt lds
    v_mfma_f32_16x16x32_bf16 v[52:55], a[252:255], a[156:159], v[52:55]
    ds_read_b128 a[180:183], v2 offset:4352
    v_fma_f32 v36, v36, s29, v24
    v_fma_f32 v37, v37, s29, v24
    v_mfma_f32_16x16x32_bf16 v[116:119], a[16:19], a[144:147], v[116:119]
    v_exp_f32 v33, v33
    v_fma_f32 v38, v38, s29, v24
    v_mfma_f32_16x16x32_bf16 v[116:119], a[20:23], a[148:151], v[116:119]
    s_add_u32 m0, s28, 28672
    ds_read_b128 a[184:187], v2 offset:4608
    v_add_f32 v18, v18, v33
    v_mfma_f32_16x16x32_bf16 v[116:119], a[24:27], a[152:155], v[116:119]
    buffer_load_dwordx4 v15, s[20:23], s31 offen nt lds
    v_mfma_f32_16x16x32_bf16 v[116:119], a[28:31], a[156:159], v[116:119]
    s_waitcnt vmcnt(8)
    ds_read_b128 a[188:191], v2 offset:4864
    v_cvt_pk_bf16_f32 v72, v32, v33
    v_fma_f32 v39, v39, s29, v24
    v_mfma_f32_16x16x32_bf16 v[120:123], a[48:51], a[144:147], v[120:123]
    s_barrier
    v_exp_f32 v34, v34
    v_fma_f32 v40, v40, s29, v24
    v_mfma_f32_16x16x32_bf16 v[120:123], a[52:55], a[148:151], v[120:123]
    ds_read_b64_tr_b16 a[192:193], v5 offset:16384
    v_add_f32 v18, v18, v34
    v_fma_f32 v41, v41, s29, v24
    v_mfma_f32_16x16x32_bf16 v[120:123], a[56:59], a[152:155], v[120:123]
    v_exp_f32 v35, v35
    v_fma_f32 v42, v42, s29, v24
    v_mfma_f32_16x16x32_bf16 v[120:123], a[60:63], a[156:159], v[120:123]
    s_waitcnt lgkmcnt(2)
    ds_read_b64_tr_b16 a[194:195], v5 offset:20480
    v_add_f32 v18, v18, v35
    v_cvt_pk_bf16_f32 v73, v34, v35
    v_mfma_f32_16x16x32_bf16 v[32:35], a[160:163], a[64:67], 0
    v_exp_f32 v36, v36
    v_fma_f32 v43, v43, s29, v24
    v_mfma_f32_16x16x32_bf16 v[32:35], a[164:167], a[68:71], v[32:35]
    ds_read_b64_tr_b16 a[196:197], v5 offset:24576
    v_add_f32 v18, v18, v36
    v_fma_f32 v44, v44, s29, v24
    v_mfma_f32_16x16x32_bf16 v[32:35], a[168:171], a[72:75], v[32:35]
    v_exp_f32 v37, v37
    v_fma_f32 v45, v45, s29, v24
    v_mfma_f32_16x16x32_bf16 v[32:35], a[172:175], a[76:79], v[32:35]
    ds_read_b64_tr_b16 a[198:199], v5 offset:28672
    v_add_f32 v18, v18, v37
    v_cvt_pk_bf16_f32 v74, v36, v37
    v_mfma_f32_16x16x32_bf16 v[32:35], a[176:179], a[80:83], v[32:35]
    v_exp_f32 v38, v38
    v_fma_f32 v46, v46, s29, v24
    v_mfma_f32_16x16x32_bf16 v[32:35], a[180:183], a[84:87], v[32:35]
    ds_read_b64_tr_b16 a[200:201], v8 offset:16384
    v_add_f32 v18, v18, v38
    v_fma_f32 v47, v47, s29, v24
    v_mfma_f32_16x16x32_bf16 v[32:35], a[184:187], a[88:91], v[32:35]
    s_waitcnt lgkmcnt(2)
    v_exp_f32 v39, v39
    v_fma_f32 v48, v48, s29, v24
    v_mfma_f32_16x16x32_bf16 v[32:35], a[188:191], a[92:95], v[32:35]
    ds_read_b64_tr_b16 a[202:203], v8 offset:20480
    v_add_f32 v18, v18, v39
    v_cvt_pk_bf16_f32 v75, v38, v39
    v_mfma_f32_16x16x32_bf16 v[36:39], a[160:163], a[96:99], 0
    v_exp_f32 v40, v40
    v_fma_f32 v49, v49, s29, v24
    v_mfma_f32_16x16x32_bf16 v[36:39], a[164:167], a[100:103], v[36:39]
    ds_read_b64_tr_b16 a[204:205], v8 offset:24576
    v_add_f32 v18, v18, v40
    v_fma_f32 v50, v50, s29, v24
    v_mfma_f32_16x16x32_bf16 v[36:39], a[168:171], a[104:107], v[36:39]
    v_exp_f32 v41, v41
    v_fma_f32 v51, v51, s29, v24
    v_mfma_f32_16x16x32_bf16 v[36:39], a[172:175], a[108:111], v[36:39]
    ds_read_b64_tr_b16 a[206:207], v8 offset:28672
    v_add_f32 v18, v18, v41
    v_cvt_pk_bf16_f32 v76, v40, v41
    v_mfma_f32_16x16x32_bf16 v[36:39], a[176:179], a[112:115], v[36:39]
    v_exp_f32 v42, v42
    v_fma_f32 v52, v52, s29, v24
    v_mfma_f32_16x16x32_bf16 v[36:39], a[180:183], a[116:119], v[36:39]
    ds_read_b64_tr_b16 a[208:209], v5 offset:16640
    v_add_f32 v18, v18, v42
    v_fma_f32 v53, v53, s29, v24
    v_mfma_f32_16x16x32_bf16 v[36:39], a[184:187], a[120:123], v[36:39]
    v_exp_f32 v43, v43
    v_fma_f32 v54, v54, s29, v24
    v_mfma_f32_16x16x32_bf16 v[36:39], a[188:191], a[124:127], v[36:39]
    ds_read_b64_tr_b16 a[210:211], v5 offset:20736
    v_add_f32 v18, v18, v43
    v_cvt_pk_bf16_f32 v77, v42, v43
    v_mfma_f32_16x16x32_bf16 v[40:43], a[160:163], a[128:131], 0
    v_exp_f32 v44, v44
    v_fma_f32 v55, v55, s29, v24
    v_mfma_f32_16x16x32_bf16 v[40:43], a[164:167], a[132:135], v[40:43]
    ds_read_b64_tr_b16 a[212:213], v5 offset:24832
    v_add_f32 v18, v18, v44
    v_fma_f32 v116, v116, s29, v24
    v_mfma_f32_16x16x32_bf16 v[40:43], a[168:171], a[136:139], v[40:43]
    v_exp_f32 v45, v45
    v_fma_f32 v117, v117, s29, v24
    v_mfma_f32_16x16x32_bf16 v[40:43], a[172:175], a[140:143], v[40:43]
    ds_read_b64_tr_b16 a[214:215], v5 offset:28928
    v_add_f32 v18, v18, v45
    v_cvt_pk_bf16_f32 v78, v44, v45
    v_mfma_f32_16x16x32_bf16 v[40:43], a[176:179], a[144:147], v[40:43]
    v_exp_f32 v46, v46
    v_fma_f32 v118, v118, s29, v24
    v_mfma_f32_16x16x32_bf16 v[40:43], a[180:183], a[148:151], v[40:43]
    ds_read_b64_tr_b16 a[216:217], v8 offset:16640
    v_add_f32 v18, v18, v46
    v_fma_f32 v119, v119, s29, v24
    v_mfma_f32_16x16x32_bf16 v[40:43], a[184:187], a[152:155], v[40:43]
    v_exp_f32 v47, v47
    v_fma_f32 v120, v120, s29, v24
    v_mfma_f32_16x16x32_bf16 v[40:43], a[188:191], a[156:159], v[40:43]
    ds_read_b64_tr_b16 a[218:219], v8 offset:20736
    v_add_f32 v18, v18, v47
    v_cvt_pk_bf16_f32 v79, v46, v47
    v_mfma_f32_16x16x32_bf16 v[128:131], a[192:195], v[56:59], 0
    s_waitcnt lgkmcnt(2)
    v_exp_f32 v48, v48
    v_mfma_f32_16x16x32_bf16 v[128:131], a[196:199], v[60:63], v[128:131]
    ds_read_b64_tr_b16 a[220:221], v8 offset:24832
    v_add_f32 v18, v18, v48
    v_mfma_f32_16x16x32_bf16 v[192:195], a[192:195], v[64:67], 0
    v_exp_f32 v49, v49
    v_mfma_f32_16x16x32_bf16 v[192:195], a[196:199], v[68:71], v[192:195]
    ds_read_b64_tr_b16 a[222:223], v8 offset:28928
    v_add_f32 v18, v18, v49
    v_mfma_f32_16x16x32_bf16 a[0:3], a[192:195], v[72:75], 0
    v_exp_f32 v50, v50
    v_mfma_f32_16x16x32_bf16 a[0:3], a[196:199], v[76:79], a[0:3]
    ds_read_b128 a[160:163], v2 offset:8192
    v_cvt_pk_bf16_f32 v100, v48, v49
    v_mfma_f32_16x16x32_bf16 v[132:135], a[200:203], v[56:59], 0
    v_exp_f32 v51, v51
    v_mfma_f32_16x16x32_bf16 v[132:135], a[204:207], v[60:63], v[132:135]
    ds_read_b128 a[164:167], v2 offset:8448
    v_add_f32 v18, v18, v50
    v_mfma_f32_16x16x32_bf16 v[196:199], a[200:203], v[64:67], 0
    v_exp_f32 v52, v52
    v_mfma_f32_16x16x32_bf16 v[196:199], a[204:207], v[68:71], v[196:199]
    ds_read_b128 a[168:171], v2 offset:8704
    v_add_f32 v18, v18, v51
    v_mfma_f32_16x16x32_bf16 a[4:7], a[200:203], v[72:75], 0
    v_exp_f32 v53, v53
    v_mfma_f32_16x16x32_bf16 a[4:7], a[204:207], v[76:79], a[4:7]
    ds_read_b128 a[172:175], v2 offset:8960
    v_cvt_pk_bf16_f32 v101, v50, v51
    v_mfma_f32_16x16x32_bf16 v[136:139], a[208:211], v[56:59], 0
    v_exp_f32 v54, v54
    v_mfma_f32_16x16x32_bf16 v[136:139], a[212:215], v[60:63], v[136:139]
    ds_read_b128 a[176:179], v2 offset:12288
    v_add_f32 v18, v18, v52
    v_mfma_f32_16x16x32_bf16 v[200:203], a[208:211], v[64:67], 0
    v_exp_f32 v55, v55
    v_mfma_f32_16x16x32_bf16 v[200:203], a[212:215], v[68:71], v[200:203]
    ds_read_b128 a[180:183], v2 offset:12544
    v_add_f32 v18, v18, v53
    v_mfma_f32_16x16x32_bf16 a[8:11], a[208:211], v[72:75], 0
    v_exp_f32 v116, v116
    v_mfma_f32_16x16x32_bf16 a[8:11], a[212:215], v[76:79], a[8:11]
    s_waitcnt lgkmcnt(2)
    ds_read_b128 a[184:187], v2 offset:12800
    v_cvt_pk_bf16_f32 v102, v52, v53
    v_mfma_f32_16x16x32_bf16 v[140:143], a[216:219], v[56:59], 0
    s_mov_b32 s30, 98304
    v_exp_f32 v117, v117
    v_mfma_f32_16x16x32_bf16 v[140:143], a[220:223], v[60:63], v[140:143]
    s_add_u32 m0, s28, 32768
    ds_read_b128 a[188:191], v2 offset:13056
    v_mfma_f32_16x16x32_bf16 v[204:207], a[216:219], v[64:67], 0
    buffer_load_dwordx4 v10, s[16:19], s30 offen nt lds
    v_mfma_f32_16x16x32_bf16 v[204:207], a[220:223], v[68:71], v[204:207]
    ds_read_b64_tr_b16 a[192:193], v5 offset:16896
    v_add_f32 v18, v18, v54
    v_mfma_f32_16x16x32_bf16 a[12:15], a[216:219], v[72:75], 0
    v_exp_f32 v118, v118
    v_mfma_f32_16x16x32_bf16 a[12:15], a[220:223], v[76:79], a[12:15]
    s_add_u32 m0, s28, 36608
    ds_read_b64_tr_b16 a[194:195], v5 offset:20992
    v_mfma_f32_16x16x32_bf16 v[44:47], a[160:163], a[64:67], 0
    buffer_load_dwordx4 v10, s[16:19], s30 offen offset:256 nt lds
    v_mfma_f32_16x16x32_bf16 v[44:47], a[164:167], a[68:71], v[44:47]
    ds_read_b64_tr_b16 a[196:197], v5 offset:25088
    v_add_f32 v18, v18, v55
    v_mfma_f32_16x16x32_bf16 v[44:47], a[168:171], a[72:75], v[44:47]
    v_exp_f32 v119, v119
    v_mfma_f32_16x16x32_bf16 v[44:47], a[172:175], a[76:79], v[44:47]
    s_waitcnt lgkmcnt(2)
    s_add_u32 m0, s28, 40960
    ds_read_b64_tr_b16 a[198:199], v5 offset:29184
    v_mfma_f32_16x16x32_bf16 v[44:47], a[176:179], a[80:83], v[44:47]
    buffer_load_dwordx4 v11, s[16:19], s30 offen nt lds
    v_mfma_f32_16x16x32_bf16 v[44:47], a[180:183], a[84:87], v[44:47]
    ds_read_b64_tr_b16 a[200:201], v8 offset:16896
    v_cvt_pk_bf16_f32 v103, v54, v55
    v_mfma_f32_16x16x32_bf16 v[44:47], a[184:187], a[88:91], v[44:47]
L_pg1:
    s_cbranch_execz L_wr1
    v_exp_f32 v120, v120
    v_mfma_f32_16x16x32_bf16 v[44:47], a[188:191], a[92:95], v[44:47]
    s_waitcnt lgkmcnt(2)
    s_add_u32 m0, s28, 44800
    ds_read_b64_tr_b16 a[202:203], v8 offset:20992
    v_mfma_f32_16x16x32_bf16 v[144:147], a[192:195], v[56:59], 0
    s_waitcnt lgkmcnt(2)
    buffer_load_dwordx4 v11, s[16:19], s30 offen offset:256 nt lds
    v_mfma_f32_16x16x32_bf16 v[144:147], a[196:199], v[60:63], v[144:147]
    ds_read_b64_tr_b16 a[204:205], v8 offset:25088
    v_add_f32 v18, v18, v116
    v_mfma_f32_16x16x32_bf16 v[208:211], a[192:195], v[64:67], 0
    v_add_f32 v18, v18, v117
    v_cvt_pk_bf16_f32 v96, v116, v117
    v_mfma_f32_16x16x32_bf16 v[208:211], a[196:199], v[68:71], v[208:211]
    ds_read_b64_tr_b16 a[206:207], v8 offset:29184
    v_add_f32 v18, v18, v118
    v_mfma_f32_16x16x32_bf16 a[16:19], a[192:195], v[72:75], 0
    v_add_f32 v18, v18, v119
    v_cvt_pk_bf16_f32 v97, v118, v119
    v_mfma_f32_16x16x32_bf16 a[16:19], a[196:199], v[76:79], a[16:19]
    ds_read_b64_tr_b16 a[208:209], v5 offset:17152
    v_fma_f32 v121, v121, s29, v24
    v_mfma_f32_16x16x32_bf16 v[48:51], a[160:163], a[96:99], 0
    v_exp_f32 v121, v121
    v_mfma_f32_16x16x32_bf16 v[48:51], a[164:167], a[100:103], v[48:51]
    ds_read_b64_tr_b16 a[210:211], v5 offset:21248
    v_fma_f32 v122, v122, s29, v24
    v_mfma_f32_16x16x32_bf16 v[48:51], a[168:171], a[104:107], v[48:51]
    s_mov_b32 s31, 32768
    v_exp_f32 v122, v122
    v_mfma_f32_16x16x32_bf16 v[48:51], a[172:175], a[108:111], v[48:51]
    s_add_u32 m0, s28, 49152
    ds_read_b64_tr_b16 a[212:213], v5 offset:25344
    v_mfma_f32_16x16x32_bf16 v[48:51], a[176:179], a[112:115], v[48:51]
    buffer_load_dwordx4 v12, s[20:23], s31 offen nt lds
    v_mfma_f32_16x16x32_bf16 v[48:51], a[180:183], a[116:119], v[48:51]
    ds_read_b64_tr_b16 a[214:215], v5 offset:29440
    v_fma_f32 v123, v123, s29, v24
    v_mfma_f32_16x16x32_bf16 v[48:51], a[184:187], a[120:123], v[48:51]
    v_exp_f32 v123, v123
    v_mfma_f32_16x16x32_bf16 v[48:51], a[188:191], a[124:127], v[48:51]
    s_waitcnt lgkmcnt(2)
    s_add_u32 m0, s28, 53248
    ds_read_b64_tr_b16 a[216:217], v8 offset:17152
    v_mfma_f32_16x16x32_bf16 v[148:151], a[200:203], v[56:59], 0
    buffer_load_dwordx4 v13, s[20:23], s31 offen nt lds
    v_mfma_f32_16x16x32_bf16 v[148:151], a[204:207], v[60:63], v[148:151]
    ds_read_b64_tr_b16 a[218:219], v8 offset:21248
    v_add_f32 v18, v18, v120
    v_mfma_f32_16x16x32_bf16 v[212:215], a[200:203], v[64:67], 0
    v_add_f32 v18, v18, v121
    v_cvt_pk_bf16_f32 v98, v120, v121
    v_mfma_f32_16x16x32_bf16 v[212:215], a[204:207], v[68:71], v[212:215]
    s_add_u32 m0, s28, 57344
    ds_read_b64_tr_b16 a[220:221], v8 offset:25344
    v_mfma_f32_16x16x32_bf16 a[20:23], a[200:203], v[72:75], 0
    buffer_load_dwordx4 v14, s[20:23], s31 offen nt lds
    v_mfma_f32_16x16x32_bf16 a[20:23], a[204:207], v[76:79], a[20:23]
    s_waitcnt vmcnt(7)
    ds_read_b64_tr_b16 a[222:223], v8 offset:29440
    v_add_f32 v18, v18, v122
    v_mfma_f32_16x16x32_bf16 v[52:55], a[160:163], a[128:131], 0
    s_barrier
    v_add_f32 v18, v18, v123
    v_cvt_pk_bf16_f32 v99, v122, v123
    v_mfma_f32_16x16x32_bf16 v[52:55], a[164:167], a[132:135], v[52:55]
    s_add_u32 m0, s28, 61440
    ds_read_b128 a[160:163], v1 offset:0
    v_mfma_f32_16x16x32_bf16 v[52:55], a[168:171], a[136:139], v[52:55]
    buffer_load_dwordx4 v15, s[20:23], s31 offen nt lds
    v_mfma_f32_16x16x32_bf16 v[52:55], a[172:175], a[140:143], v[52:55]
    ds_read_b128 a[164:167], v1 offset:256
    v_fma_f32 v32, v32, s29, v20
    v_mfma_f32_16x16x32_bf16 v[52:55], a[176:179], a[144:147], v[52:55]
    s_mov_b32 s30, 114688
    v_exp_f32 v32, v32
    v_mfma_f32_16x16x32_bf16 v[52:55], a[180:183], a[148:151], v[52:55]
    s_add_u32 m0, s28, 98304
    ds_read_b128 a[168:171], v1 offset:512
    v_mfma_f32_16x16x32_bf16 v[52:55], a[184:187], a[152:155], v[52:55]
    buffer_load_dwordx4 v10, s[16:19], s30 offen nt lds
    v_mfma_f32_16x16x32_bf16 v[52:55], a[188:191], a[156:159], v[52:55]
    ds_read_b128 a[172:175], v1 offset:768
    v_fma_f32 v33, v33, s29, v20
    v_mfma_f32_16x16x32_bf16 v[152:155], a[208:211], v[56:59], 0
    s_waitcnt lgkmcnt(2)
    v_exp_f32 v33, v33
    v_mfma_f32_16x16x32_bf16 v[152:155], a[212:215], v[60:63], v[152:155]
    s_add_u32 m0, s28, 102144
    ds_read_b128 a[176:179], v1 offset:4096
    v_mfma_f32_16x16x32_bf16 v[216:219], a[208:211], v[64:67], 0
    buffer_load_dwordx4 v10, s[16:19], s30 offen offset:256 nt lds
    v_mfma_f32_16x16x32_bf16 v[216:219], a[212:215], v[68:71], v[216:219]
    ds_read_b128 a[180:183], v1 offset:4352
    v_fma_f32 v34, v34, s29, v20
    v_mfma_f32_16x16x32_bf16 a[24:27], a[208:211], v[72:75], 0
    v_exp_f32 v34, v34
    v_mfma_f32_16x16x32_bf16 a[24:27], a[212:215], v[76:79], a[24:27]
    s_add_u32 m0, s28, 106496
    ds_read_b128 a[184:187], v1 offset:4608
    v_mfma_f32_16x16x32_bf16 v[156:159], a[216:219], v[56:59], 0
    buffer_load_dwordx4 v11, s[16:19], s30 offen nt lds
    v_mfma_f32_16x16x32_bf16 v[156:159], a[220:223], v[60:63], v[156:159]
    ds_read_b128 a[188:191], v1 offset:4864
    v_fma_f32 v35, v35, s29, v20
    v_mfma_f32_16x16x32_bf16 v[220:223], a[216:219], v[64:67], 0
    v_exp_f32 v35, v35
    v_mfma_f32_16x16x32_bf16 v[220:223], a[220:223], v[68:71], v[220:223]
    s_add_u32 m0, s28, 110336
    ds_read_b64_tr_b16 a[192:193], v4 offset:16384
    v_mfma_f32_16x16x32_bf16 a[28:31], a[216:219], v[72:75], 0
    buffer_load_dwordx4 v11, s[16:19], s30 offen offset:256 nt lds
    v_mfma_f32_16x16x32_bf16 a[28:31], a[220:223], v[76:79], a[28:31]
    ds_read_b64_tr_b16 a[194:195], v4 offset:20480
    v_add_f32 v16, v16, v32
    v_add_f32 v16, v16, v33
    v_add_f32 v16, v16, v34
    v_add_f32 v16, v16, v35
    v_cvt_pk_bf16_f32 v104, v32, v33
    v_cvt_pk_bf16_f32 v105, v34, v35
    v_mfma_f32_16x16x32_bf16 v[32:35], a[160:163], a[64:67], 0
    v_fma_f32 v36, v36, s29, v22
    v_fma_f32 v37, v37, s29, v22
    v_mfma_f32_16x16x32_bf16 v[32:35], a[164:167], a[68:71], v[32:35]
    s_waitcnt lgkmcnt(2)
    ds_read_b64_tr_b16 a[196:197], v4 offset:24576
    v_fma_f32 v38, v38, s29, v22
    v_mfma_f32_16x16x32_bf16 v[32:35], a[168:171], a[72:75], v[32:35]
    v_exp_f32 v36, v36
    v_mfma_f32_16x16x32_bf16 v[32:35], a[172:175], a[76:79], v[32:35]
    ds_read_b64_tr_b16 a[198:199], v4 offset:28672
    v_fma_f32 v39, v39, s29, v22
    v_mfma_f32_16x16x32_bf16 v[32:35], a[176:179], a[80:83], v[32:35]
    v_exp_f32 v37, v37
    v_mfma_f32_16x16x32_bf16 v[32:35], a[180:183], a[84:87], v[32:35]
    ds_read_b64_tr_b16 a[200:201], v7 offset:16384
    v_add_f32 v17, v17, v36
    v_mfma_f32_16x16x32_bf16 v[32:35], a[184:187], a[88:91], v[32:35]
    v_exp_f32 v38, v38
    v_mfma_f32_16x16x32_bf16 v[32:35], a[188:191], a[92:95], v[32:35]
    s_waitcnt lgkmcnt(2)
    ds_read_b64_tr_b16 a[202:203], v7 offset:20480
    v_add_f32 v17, v17, v37
    v_mfma_f32_16x16x32_bf16 v[160:163], a[192:195], v[56:59], 0
    s_waitcnt lgkmcnt(2)
    v_exp_f32 v39, v39
    v_mfma_f32_16x16x32_bf16 v[160:163], a[196:199], v[60:63], v[160:163]
    ds_read_b64_tr_b16 a[204:205], v7 offset:24576
    v_cvt_pk_bf16_f32 v112, v36, v37
    v_mfma_f32_16x16x32_bf16 v[224:227], a[192:195], v[64:67], 0
    v_add_f32 v17, v17, v38
    v_add_f32 v17, v17, v39
    v_mfma_f32_16x16x32_bf16 v[224:227], a[196:199], v[68:71], v[224:227]
    ds_read_b64_tr_b16 a[206:207], v7 offset:28672
    v_cvt_pk_bf16_f32 v113, v38, v39
    v_mfma_f32_16x16x32_bf16 a[32:35], a[192:195], v[72:75], 0
    v_fma_f32 v40, v40, s29, v24
    v_fma_f32 v41, v41, s29, v24
    v_mfma_f32_16x16x32_bf16 a[32:35], a[196:199], v[76:79], a[32:35]
    ds_read_b64_tr_b16 a[208:209], v4 offset:16640
    v_fma_f32 v42, v42, s29, v24
    v_mfma_f32_16x16x32_bf16 v[36:39], a[160:163], a[96:99], 0
    v_exp_f32 v40, v40
    v_mfma_f32_16x16x32_bf16 v[36:39], a[164:167], a[100:103], v[36:39]
    ds_read_b64_tr_b16 a[210:211], v4 offset:20736
    v_fma_f32 v43, v43, s29, v24
    v_mfma_f32_16x16x32_bf16 v[36:39], a[168:171], a[104:107], v[36:39]
    v_exp_f32 v41, v41
    v_mfma_f32_16x16x32_bf16 v[36:39], a[172:175], a[108:111], v[36:39]
    ds_read_b64_tr_b16 a[212:213], v4 offset:24832
    v_add_f32 v18, v18, v40
    v_mfma_f32_16x16x32_bf16 v[36:39], a[176:179], a[112:115], v[36:39]
    v_exp_f32 v42, v42
    v_mfma_f32_16x16x32_bf16 v[36:39], a[180:183], a[116:119], v[36:39]
    ds_read_b64_tr_b16 a[214:215], v4 offset:28928
    v_add_f32 v18, v18, v41
    v_mfma_f32_16x16x32_bf16 v[36:39], a[184:187], a[120:123], v[36:39]
    v_exp_f32 v43, v43
    v_mfma_f32_16x16x32_bf16 v[36:39], a[188:191], a[124:127], v[36:39]
    s_waitcnt lgkmcnt(2)
    ds_read_b64_tr_b16 a[216:217], v7 offset:16640
    v_cvt_pk_bf16_f32 v120, v40, v41
    v_mfma_f32_16x16x32_bf16 v[164:167], a[200:203], v[56:59], 0
    v_add_f32 v18, v18, v42
    v_add_f32 v18, v18, v43
    v_mfma_f32_16x16x32_bf16 v[164:167], a[204:207], v[60:63], v[164:167]
    ds_read_b64_tr_b16 a[218:219], v7 offset:20736
    v_cvt_pk_bf16_f32 v121, v42, v43
    v_mfma_f32_16x16x32_bf16 v[228:231], a[200:203], v[64:67], 0
    v_fma_f32 v44, v44, s29, v20
    v_fma_f32 v45, v45, s29, v20
    v_mfma_f32_16x16x32_bf16 v[228:231], a[204:207], v[68:71], v[228:231]
    ds_read_b64_tr_b16 a[220:221], v7 offset:24832
    v_fma_f32 v46, v46, s29, v20
    v_mfma_f32_16x16x32_bf16 a[36:39], a[200:203], v[72:75], 0
    v_exp_f32 v44, v44
    v_mfma_f32_16x16x32_bf16 a[36:39], a[204:207], v[76:79], a[36:39]
    ds_read_b64_tr_b16 a[222:223], v7 offset:28928
    v_fma_f32 v47, v47, s29, v20
    v_mfma_f32_16x16x32_bf16 v[40:43], a[160:163], a[128:131], 0
    v_exp_f32 v45, v45
    v_mfma_f32_16x16x32_bf16 v[40:43], a[164:167], a[132:135], v[40:43]
    ds_read_b128 a[160:163], v1 offset:8192
    v_add_f32 v16, v16, v44
    v_mfma_f32_16x16x32_bf16 v[40:43], a[168:171], a[136:139], v[40:43]
    v_exp_f32 v46, v46
    v_mfma_f32_16x16x32_bf16 v[40:43], a[172:175], a[140:143], v[40:43]
    ds_read_b128 a[164:167], v1 offset:8448
    v_add_f32 v16, v16, v45
    v_mfma_f32_16x16x32_bf16 v[40:43], a[176:179], a[144:147], v[40:43]
    v_exp_f32 v47, v47
    v_mfma_f32_16x16x32_bf16 v[40:43], a[180:183], a[148:151], v[40:43]
    ds_read_b128 a[168:171], v1 offset:8704
    v_cvt_pk_bf16_f32 v106, v44, v45
    v_mfma_f32_16x16x32_bf16 v[40:43], a[184:187], a[152:155], v[40:43]
    v_add_f32 v16, v16, v46
    v_add_f32 v16, v16, v47
    v_mfma_f32_16x16x32_bf16 v[40:43], a[188:191], a[156:159], v[40:43]
    ds_read_b128 a[172:175], v1 offset:8960
    v_cvt_pk_bf16_f32 v107, v46, v47
    v_mfma_f32_16x16x32_bf16 v[168:171], a[208:211], v[56:59], 0
    s_waitcnt lgkmcnt(2)
    v_fma_f32 v48, v48, s29, v22
    v_fma_f32 v49, v49, s29, v22
    v_mfma_f32_16x16x32_bf16 v[168:171], a[212:215], v[60:63], v[168:171]
    ds_read_b128 a[176:179], v1 offset:12288
    v_fma_f32 v50, v50, s29, v22
    v_mfma_f32_16x16x32_bf16 v[232:235], a[208:211], v[64:67], 0
    v_exp_f32 v48, v48
    v_mfma_f32_16x16x32_bf16 v[232:235], a[212:215], v[68:71], v[232:235]
    ds_read_b128 a[180:183], v1 offset:12544
    v_fma_f32 v51, v51, s29, v22
    v_mfma_f32_16x16x32_bf16 a[40:43], a[208:211], v[72:75], 0
    v_exp_f32 v49, v49
    v_mfma_f32_16x16x32_bf16 a[40:43], a[212:215], v[76:79], a[40:43]
    ds_read_b128 a[184:187], v1 offset:12800
    v_add_f32 v17, v17, v48
    v_mfma_f32_16x16x32_bf16 v[172:175], a[216:219], v[56:59], 0
    s_mov_b32 s31, 33024
    v_exp_f32 v50, v50
    v_mfma_f32_16x16x32_bf16 v[172:175], a[220:223], v[60:63], v[172:175]
    s_add_u32 m0, s28, 114688
    ds_read_b128 a[188:191], v1 offset:13056
    v_mfma_f32_16x16x32_bf16 v[236:239], a[216:219], v[64:67], 0
    buffer_load_dwordx4 v12, s[20:23], s31 offen nt lds
    v_mfma_f32_16x16x32_bf16 v[236:239], a[220:223], v[68:71], v[236:239]
    ds_read_b64_tr_b16 a[192:193], v4 offset:16896
    v_add_f32 v17, v17, v49
    v_mfma_f32_16x16x32_bf16 a[44:47], a[216:219], v[72:75], 0
    v_exp_f32 v51, v51
    v_mfma_f32_16x16x32_bf16 a[44:47], a[220:223], v[76:79], a[44:47]
    ds_read_b64_tr_b16 a[194:195], v4 offset:20992
    v_cvt_pk_bf16_f32 v114, v48, v49
    v_mfma_f32_16x16x32_bf16 v[44:47], a[160:163], a[64:67], 0
    v_add_f32 v17, v17, v50
    v_add_f32 v17, v17, v51
    v_mfma_f32_16x16x32_bf16 v[44:47], a[164:167], a[68:71], v[44:47]
    s_waitcnt lgkmcnt(2)
    s_add_u32 m0, s28, 118784
    ds_read_b64_tr_b16 a[196:197], v4 offset:25088
    v_mfma_f32_16x16x32_bf16 v[44:47], a[168:171], a[72:75], v[44:47]
    buffer_load_dwordx4 v13, s[20:23], s31 offen nt lds
    v_mfma_f32_16x16x32_bf16 v[44:47], a[172:175], a[76:79], v[44:47]
    ds_read_b64_tr_b16 a[198:199], v4 offset:29184
    v_cvt_pk_bf16_f32 v115, v50, v51
    v_mfma_f32_16x16x32_bf16 v[44:47], a[176:179], a[80:83], v[44:47]
    v_fma_f32 v52, v52, s29, v24
    v_fma_f32 v53, v53, s29, v24
    v_mfma_f32_16x16x32_bf16 v[44:47], a[180:183], a[84:87], v[44:47]
    ds_read_b64_tr_b16 a[200:201], v7 offset:16896
    v_fma_f32 v54, v54, s29, v24
    v_mfma_f32_16x16x32_bf16 v[44:47], a[184:187], a[88:91], v[44:47]
    v_exp_f32 v52, v52
    v_mfma_f32_16x16x32_bf16 v[44:47], a[188:191], a[92:95], v[44:47]
    s_waitcnt lgkmcnt(2)
    s_add_u32 m0, s28, 122880
    ds_read_b64_tr_b16 a[202:203], v7 offset:20992
    v_mfma_f32_16x16x32_bf16 v[176:179], a[192:195], v[56:59], 0
    s_waitcnt lgkmcnt(2)
    buffer_load_dwordx4 v14, s[20:23], s31 offen nt lds
    v_mfma_f32_16x16x32_bf16 v[176:179], a[196:199], v[60:63], v[176:179]
    ds_read_b64_tr_b16 a[204:205], v7 offset:25088
    v_fma_f32 v55, v55, s29, v24
    v_mfma_f32_16x16x32_bf16 v[240:243], a[192:195], v[64:67], 0
    v_exp_f32 v53, v53
    v_mfma_f32_16x16x32_bf16 v[240:243], a[196:199], v[68:71], v[240:243]
    ds_read_b64_tr_b16 a[206:207], v7 offset:29184
    v_add_f32 v18, v18, v52
    v_mfma_f32_16x16x32_bf16 a[48:51], a[192:195], v[72:75], 0
    v_exp_f32 v54, v54
    v_mfma_f32_16x16x32_bf16 a[48:51], a[196:199], v[76:79], a[48:51]
    s_add_u32 m0, s28, 126976
    ds_read_b64_tr_b16 a[208:209], v4 offset:17152
    v_mfma_f32_16x16x32_bf16 v[48:51], a[160:163], a[96:99], 0
    buffer_load_dwordx4 v15, s[20:23], s31 offen nt lds
    v_mfma_f32_16x16x32_bf16 v[48:51], a[164:167], a[100:103], v[48:51]
    ds_read_b64_tr_b16 a[210:211], v4 offset:21248
    v_add_f32 v18, v18, v53
    v_mfma_f32_16x16x32_bf16 v[48:51], a[168:171], a[104:107], v[48:51]
    v_exp_f32 v55, v55
    v_mfma_f32_16x16x32_bf16 v[48:51], a[172:175], a[108:111], v[48:51]
    ds_read_b64_tr_b16 a[212:213], v4 offset:25344
    v_cvt_pk_bf16_f32 v122, v52, v53
    v_mfma_f32_16x16x32_bf16 v[48:51], a[176:179], a[112:115], v[48:51]
    s_mov_b32 s30, 131072
    v_add_f32 v18, v18, v54
    v_add_f32 v18, v18, v55
    v_mfma_f32_16x16x32_bf16 v[48:51], a[180:183], a[116:119], v[48:51]
    s_add_u32 m0, s28, 131072
    ds_read_b64_tr_b16 a[214:215], v4 offset:29440
    v_mfma_f32_16x16x32_bf16 v[48:51], a[184:187], a[120:123], v[48:51]
    buffer_load_dwordx4 v10, s[16:19], s30 offen nt lds
    v_mfma_f32_16x16x32_bf16 v[48:51], a[188:191], a[124:127], v[48:51]
    s_waitcnt lgkmcnt(2)
    ds_read_b64_tr_b16 a[216:217], v7 offset:17152
    v_cvt_pk_bf16_f32 v123, v54, v55
    v_mfma_f32_16x16x32_bf16 v[180:183], a[200:203], v[56:59], 0
    v_fma_f32 v32, v32, s29, v20
    v_fma_f32 v33, v33, s29, v20
    v_mfma_f32_16x16x32_bf16 v[180:183], a[204:207], v[60:63], v[180:183]
    ds_read_b64_tr_b16 a[218:219], v7 offset:21248
    v_fma_f32 v34, v34, s29, v20
    v_mfma_f32_16x16x32_bf16 v[244:247], a[200:203], v[64:67], 0
    v_exp_f32 v32, v32
    v_mfma_f32_16x16x32_bf16 v[244:247], a[204:207], v[68:71], v[244:247]
    s_add_u32 m0, s28, 134912
    ds_read_b64_tr_b16 a[220:221], v7 offset:25344
    v_mfma_f32_16x16x32_bf16 a[52:55], a[200:203], v[72:75], 0
    buffer_load_dwordx4 v10, s[16:19], s30 offen offset:256 nt lds
    v_mfma_f32_16x16x32_bf16 a[52:55], a[204:207], v[76:79], a[52:55]
    s_waitcnt vmcnt(10)
    ds_read_b64_tr_b16 a[222:223], v7 offset:29440
    v_fma_f32 v35, v35, s29, v20
    v_mfma_f32_16x16x32_bf16 v[52:55], a[160:163], a[128:131], 0
    s_barrier
    v_exp_f32 v33, v33
    v_mfma_f32_16x16x32_bf16 v[52:55], a[164:167], a[132:135], v[52:55]
    ds_read_b128 a[160:163], v1 offset:32768
    v_add_f32 v16, v16, v32
    v_mfma_f32_16x16x32_bf16 v[52:55], a[168:171], a[136:139], v[52:55]
    v_exp_f32 v34, v34
    v_mfma_f32_16x16x32_bf16 v[52:55], a[172:175], a[140:143], v[52:55]
    s_add_u32 m0, s28, 139264
    ds_read_b128 a[164:167], v1 offset:33024
    v_mfma_f32_16x16x32_bf16 v[52:55], a[176:179], a[144:147], v[52:55]
    buffer_load_dwordx4 v11, s[16:19], s30 offen nt lds
    v_mfma_f32_16x16x32_bf16 v[52:55], a[180:183], a[148:151], v[52:55]
    ds_read_b128 a[168:171], v1 offset:33280
    v_add_f32 v16, v16, v33
    v_mfma_f32_16x16x32_bf16 v[52:55], a[184:187], a[152:155], v[52:55]
    v_exp_f32 v35, v35
    v_mfma_f32_16x16x32_bf16 v[52:55], a[188:191], a[156:159], v[52:55]
    ds_read_b128 a[172:175], v1 offset:33536
    v_cvt_pk_bf16_f32 v108, v32, v33
    v_mfma_f32_16x16x32_bf16 v[184:187], a[208:211], v[56:59], 0
    s_waitcnt lgkmcnt(2)
    v_add_f32 v16, v16, v34
    v_add_f32 v16, v16, v35
    v_mfma_f32_16x16x32_bf16 v[184:187], a[212:215], v[60:63], v[184:187]
    s_add_u32 m0, s28, 143104
    ds_read_b128 a[176:179], v1 offset:36864
    v_mfma_f32_16x16x32_bf16 v[248:251], a[208:211], v[64:67], 0
    buffer_load_dwordx4 v11, s[16:19], s30 offen offset:256 nt lds
    v_mfma_f32_16x16x32_bf16 v[248:251], a[212:215], v[68:71], v[248:251]
    ds_read_b128 a[180:183], v1 offset:37120
    v_cvt_pk_bf16_f32 v109, v34, v35
    v_mfma_f32_16x16x32_bf16 a[56:59], a[208:211], v[72:75], 0
    v_fma_f32 v36, v36, s29, v22
    v_fma_f32 v37, v37, s29, v22
    v_mfma_f32_16x16x32_bf16 a[56:59], a[212:215], v[76:79], a[56:59]
    ds_read_b128 a[184:187], v1 offset:37376
    v_fma_f32 v38, v38, s29, v22
    v_mfma_f32_16x16x32_bf16 v[188:191], a[216:219], v[56:59], 0
    s_mov_b32 s31, 65536
    v_exp_f32 v36, v36
    v_mfma_f32_16x16x32_bf16 v[188:191], a[220:223], v[60:63], v[188:191]
    s_add_u32 m0, s28, 147456
    ds_read_b128 a[188:191], v1 offset:37632
    v_mfma_f32_16x16x32_bf16 v[252:255], a[216:219], v[64:67], 0
    buffer_load_dwordx4 v12, s[20:23], s31 offen nt lds
    v_mfma_f32_16x16x32_bf16 v[252:255], a[220:223], v[68:71], v[252:255]
    ds_read_b64_tr_b16 a[192:193], v4 offset:49152
    v_fma_f32 v39, v39, s29, v22
    v_mfma_f32_16x16x32_bf16 a[60:63], a[216:219], v[72:75], 0
    v_exp_f32 v37, v37
    v_mfma_f32_16x16x32_bf16 a[60:63], a[220:223], v[76:79], a[60:63]
    ds_read_b64_tr_b16 a[194:195], v4 offset:53248
    v_add_f32 v17, v17, v36
    v_mfma_f32_16x16x32_bf16 v[32:35], a[160:163], a[64:67], 0
    v_exp_f32 v38, v38
    v_mfma_f32_16x16x32_bf16 v[32:35], a[164:167], a[68:71], v[32:35]
    s_waitcnt lgkmcnt(2)
    s_add_u32 m0, s28, 151552
    ds_read_b64_tr_b16 a[196:197], v4 offset:57344
    v_mfma_f32_16x16x32_bf16 v[32:35], a[168:171], a[72:75], v[32:35]
    buffer_load_dwordx4 v13, s[20:23], s31 offen nt lds
    v_mfma_f32_16x16x32_bf16 v[32:35], a[172:175], a[76:79], v[32:35]
    ds_read_b64_tr_b16 a[198:199], v4 offset:61440
    v_add_f32 v17, v17, v37
    v_mfma_f32_16x16x32_bf16 v[32:35], a[176:179], a[80:83], v[32:35]
    v_exp_f32 v39, v39
    v_mfma_f32_16x16x32_bf16 v[32:35], a[180:183], a[84:87], v[32:35]
    ds_read_b64_tr_b16 a[200:201], v7 offset:49152
    v_cvt_pk_bf16_f32 v116, v36, v37
    v_mfma_f32_16x16x32_bf16 v[32:35], a[184:187], a[88:91], v[32:35]
    v_add_f32 v17, v17, v38
    v_add_f32 v17, v17, v39
    v_mfma_f32_16x16x32_bf16 v[32:35], a[188:191], a[92:95], v[32:35]
    s_waitcnt lgkmcnt(2)
    s_add_u32 m0, s28, 155648
    ds_read_b64_tr_b16 a[202:203], v7 offset:53248
    v_mfma_f32_16x16x32_bf16 v[128:131], a[192:195], v[80:83], v[128:131]
    s_waitcnt lgkmcnt(2)
    buffer_load_dwordx4 v14, s[20:23], s31 offen nt lds
    v_mfma_f32_16x16x32_bf16 v[128:131], a[196:199], v[84:87], v[128:131]
    ds_read_b64_tr_b16 a[204:205], v7 offset:57344
    v_cvt_pk_bf16_f32 v117, v38, v39
    v_mfma_f32_16x16x32_bf16 v[192:195], a[192:195], v[88:91], v[192:195]
    v_fma_f32 v40, v40, s29, v24
    v_fma_f32 v41, v41, s29, v24
    v_mfma_f32_16x16x32_bf16 v[192:195], a[196:199], v[92:95], v[192:195]
    ds_read_b64_tr_b16 a[206:207], v7 offset:61440
    v_fma_f32 v42, v42, s29, v24
    v_mfma_f32_16x16x32_bf16 a[0:3], a[192:195], v[96:99], a[0:3]
    v_exp_f32 v40, v40
    v_mfma_f32_16x16x32_bf16 a[0:3], a[196:199], v[100:103], a[0:3]
    s_add_u32 m0, s28, 159744
    ds_read_b64_tr_b16 a[208:209], v4 offset:49408
    v_mfma_f32_16x16x32_bf16 v[36:39], a[160:163], a[96:99], 0
    buffer_load_dwordx4 v15, s[20:23], s31 offen nt lds
    v_mfma_f32_16x16x32_bf16 v[36:39], a[164:167], a[100:103], v[36:39]
    ds_read_b64_tr_b16 a[210:211], v4 offset:53504
    v_fma_f32 v43, v43, s29, v24
    v_mfma_f32_16x16x32_bf16 v[36:39], a[168:171], a[104:107], v[36:39]
    v_exp_f32 v41, v41
    v_mfma_f32_16x16x32_bf16 v[36:39], a[172:175], a[108:111], v[36:39]
    ds_read_b64_tr_b16 a[212:213], v4 offset:57600
    v_add_f32 v18, v18, v40
    v_mfma_f32_16x16x32_bf16 v[36:39], a[176:179], a[112:115], v[36:39]
    v_exp_f32 v42, v42
    v_mfma_f32_16x16x32_bf16 v[36:39], a[180:183], a[116:119], v[36:39]
    ds_read_b64_tr_b16 a[214:215], v4 offset:61696
    v_add_f32 v18, v18, v41
    v_mfma_f32_16x16x32_bf16 v[36:39], a[184:187], a[120:123], v[36:39]
    v_exp_f32 v43, v43
    v_mfma_f32_16x16x32_bf16 v[36:39], a[188:191], a[124:127], v[36:39]
    s_waitcnt lgkmcnt(2)
    ds_read_b64_tr_b16 a[216:217], v7 offset:49408
    v_cvt_pk_bf16_f32 v124, v40, v41
    v_mfma_f32_16x16x32_bf16 v[132:135], a[200:203], v[80:83], v[132:135]
    v_add_f32 v18, v18, v42
    v_add_f32 v18, v18, v43
    v_mfma_f32_16x16x32_bf16 v[132:135], a[204:207], v[84:87], v[132:135]
    ds_read_b64_tr_b16 a[218:219], v7 offset:53504
    v_cvt_pk_bf16_f32 v125, v42, v43
    v_mfma_f32_16x16x32_bf16 v[196:199], a[200:203], v[88:91], v[196:199]
    v_fma_f32 v44, v44, s29, v20
    v_fma_f32 v45, v45, s29, v20
    v_mfma_f32_16x16x32_bf16 v[196:199], a[204:207], v[92:95], v[196:199]
    ds_read_b64_tr_b16 a[220:221], v7 offset:57600
    v_fma_f32 v46, v46, s29, v20
    v_mfma_f32_16x16x32_bf16 a[4:7], a[200:203], v[96:99], a[4:7]
    v_exp_f32 v44, v44
    v_mfma_f32_16x16x32_bf16 a[4:7], a[204:207], v[100:103], a[4:7]
    ds_read_b64_tr_b16 a[222:223], v7 offset:61696
    v_fma_f32 v47, v47, s29, v20
    v_mfma_f32_16x16x32_bf16 v[40:43], a[160:163], a[128:131], 0
    v_exp_f32 v45, v45
    v_mfma_f32_16x16x32_bf16 v[40:43], a[164:167], a[132:135], v[40:43]
    ds_read_b128 a[160:163], v1 offset:40960
    v_add_f32 v16, v16, v44
    v_mfma_f32_16x16x32_bf16 v[40:43], a[168:171], a[136:139], v[40:43]
    v_exp_f32 v46, v46
    v_mfma_f32_16x16x32_bf16 v[40:43], a[172:175], a[140:143], v[40:43]
    ds_read_b128 a[164:167], v1 offset:41216
    v_add_f32 v16, v16, v45
    v_mfma_f32_16x16x32_bf16 v[40:43], a[176:179], a[144:147], v[40:43]
    v_exp_f32 v47, v47
    v_mfma_f32_16x16x32_bf16 v[40:43], a[180:183], a[148:151], v[40:43]
    ds_read_b128 a[168:171], v1 offset:41472
    v_cvt_pk_bf16_f32 v110, v44, v45
    v_mfma_f32_16x16x32_bf16 v[40:43], a[184:187], a[152:155], v[40:43]
    v_add_f32 v16, v16, v46
    v_add_f32 v16, v16, v47
    v_mfma_f32_16x16x32_bf16 v[40:43], a[188:191], a[156:159], v[40:43]
    ds_read_b128 a[172:175], v1 offset:41728
    v_cvt_pk_bf16_f32 v111, v46, v47
    v_mfma_f32_16x16x32_bf16 v[136:139], a[208:211], v[80:83], v[136:139]
    s_waitcnt lgkmcnt(2)
    v_fma_f32 v48, v48, s29, v22
    v_fma_f32 v49, v49, s29, v22
    v_mfma_f32_16x16x32_bf16 v[136:139], a[212:215], v[84:87], v[136:139]
    ds_read_b128 a[176:179], v1 offset:45056
    v_fma_f32 v50, v50, s29, v22
    v_mfma_f32_16x16x32_bf16 v[200:203], a[208:211], v[88:91], v[200:203]
    v_exp_f32 v48, v48
    v_mfma_f32_16x16x32_bf16 v[200:203], a[212:215], v[92:95], v[200:203]
    ds_read_b128 a[180:183], v1 offset:45312
    v_fma_f32 v51, v51, s29, v22
    v_mfma_f32_16x16x32_bf16 a[8:11], a[208:211], v[96:99], a[8:11]
    v_exp_f32 v49, v49
    v_mfma_f32_16x16x32_bf16 a[8:11], a[212:215], v[100:103], a[8:11]
    ds_read_b128 a[184:187], v1 offset:45568
    v_add_f32 v17, v17, v48
    v_mfma_f32_16x16x32_bf16 v[140:143], a[216:219], v[80:83], v[140:143]
    s_mov_b32 s30, 147456
    v_exp_f32 v50, v50
    v_mfma_f32_16x16x32_bf16 v[140:143], a[220:223], v[84:87], v[140:143]
    s_add_u32 m0, s28, 65536
    ds_read_b128 a[188:191], v1 offset:45824
    v_mfma_f32_16x16x32_bf16 v[204:207], a[216:219], v[88:91], v[204:207]
    buffer_load_dwordx4 v10, s[16:19], s30 offen nt lds
    v_mfma_f32_16x16x32_bf16 v[204:207], a[220:223], v[92:95], v[204:207]
    ds_read_b64_tr_b16 a[192:193], v4 offset:49664
    v_add_f32 v17, v17, v49
    v_mfma_f32_16x16x32_bf16 a[12:15], a[216:219], v[96:99], a[12:15]
    v_exp_f32 v51, v51
    v_mfma_f32_16x16x32_bf16 a[12:15], a[220:223], v[100:103], a[12:15]
    ds_read_b64_tr_b16 a[194:195], v4 offset:53760
    v_cvt_pk_bf16_f32 v118, v48, v49
    v_mfma_f32_16x16x32_bf16 v[44:47], a[160:163], a[64:67], 0
    v_add_f32 v17, v17, v50
    v_add_f32 v17, v17, v51
    v_mfma_f32_16x16x32_bf16 v[44:47], a[164:167], a[68:71], v[44:47]
    s_waitcnt lgkmcnt(2)
    s_add_u32 m0, s28, 69376
    ds_read_b64_tr_b16 a[196:197], v4 offset:57856
    v_mfma_f32_16x16x32_bf16 v[44:47], a[168:171], a[72:75], v[44:47]
    buffer_load_dwordx4 v10, s[16:19], s30 offen offset:256 nt lds
    v_mfma_f32_16x16x32_bf16 v[44:47], a[172:175], a[76:79], v[44:47]
    ds_read_b64_tr_b16 a[198:199], v4 offset:61952
    v_cvt_pk_bf16_f32 v119, v50, v51
    v_mfma_f32_16x16x32_bf16 v[44:47], a[176:179], a[80:83], v[44:47]
    v_fma_f32 v52, v52, s29, v24
    v_fma_f32 v53, v53, s29, v24
    v_mfma_f32_16x16x32_bf16 v[44:47], a[180:183], a[84:87], v[44:47]
    ds_read_b64_tr_b16 a[200:201], v7 offset:49664
    v_fma_f32 v54, v54, s29, v24
    v_mfma_f32_16x16x32_bf16 v[44:47], a[184:187], a[88:91], v[44:47]
    v_exp_f32 v52, v52
    v_mfma_f32_16x16x32_bf16 v[44:47], a[188:191], a[92:95], v[44:47]
    s_waitcnt lgkmcnt(2)
    s_add_u32 m0, s28, 73728
    ds_read_b64_tr_b16 a[202:203], v7 offset:53760
    v_mfma_f32_16x16x32_bf16 v[144:147], a[192:195], v[80:83], v[144:147]
    s_waitcnt lgkmcnt(2)
    buffer_load_dwordx4 v11, s[16:19], s30 offen nt lds
    v_mfma_f32_16x16x32_bf16 v[144:147], a[196:199], v[84:87], v[144:147]
    ds_read_b64_tr_b16 a[204:205], v7 offset:57856
    v_fma_f32 v55, v55, s29, v24
    v_mfma_f32_16x16x32_bf16 v[208:211], a[192:195], v[88:91], v[208:211]
    v_exp_f32 v53, v53
    v_mfma_f32_16x16x32_bf16 v[208:211], a[196:199], v[92:95], v[208:211]
    ds_read_b64_tr_b16 a[206:207], v7 offset:61952
    v_add_f32 v18, v18, v52
    v_mfma_f32_16x16x32_bf16 a[16:19], a[192:195], v[96:99], a[16:19]
    v_exp_f32 v54, v54
    v_mfma_f32_16x16x32_bf16 a[16:19], a[196:199], v[100:103], a[16:19]
    s_add_u32 m0, s28, 77568
    ds_read_b64_tr_b16 a[208:209], v4 offset:49920
    v_mfma_f32_16x16x32_bf16 v[48:51], a[160:163], a[96:99], 0
    buffer_load_dwordx4 v11, s[16:19], s30 offen offset:256 nt lds
    v_mfma_f32_16x16x32_bf16 v[48:51], a[164:167], a[100:103], v[48:51]
    ds_read_b64_tr_b16 a[210:211], v4 offset:54016
    v_add_f32 v18, v18, v53
    v_mfma_f32_16x16x32_bf16 v[48:51], a[168:171], a[104:107], v[48:51]
    v_exp_f32 v55, v55
    v_mfma_f32_16x16x32_bf16 v[48:51], a[172:175], a[108:111], v[48:51]
    ds_read_b64_tr_b16 a[212:213], v4 offset:58112
    v_cvt_pk_bf16_f32 v126, v52, v53
    v_mfma_f32_16x16x32_bf16 v[48:51], a[176:179], a[112:115], v[48:51]
    s_mov_b32 s31, 65792
    v_add_f32 v18, v18, v54
    v_add_f32 v18, v18, v55
    v_mfma_f32_16x16x32_bf16 v[48:51], a[180:183], a[116:119], v[48:51]
    s_add_u32 m0, s28, 0
    ds_read_b64_tr_b16 a[214:215], v4 offset:62208
    v_mfma_f32_16x16x32_bf16 v[48:51], a[184:187], a[120:123], v[48:51]
L_pg2:
    s_cbranch_execz L_wr2
    buffer_load_dwordx4 v12, s[20:23], s31 offen nt lds
    v_mfma_f32_16x16x32_bf16 v[48:51], a[188:191], a[124:127], v[48:51]
    s_waitcnt lgkmcnt(2)
    ds_read_b64_tr_b16 a[216:217], v7 offset:49920
    v_cvt_pk_bf16_f32 v127, v54, v55
    v_mfma_f32_16x16x32_bf16 v[148:151], a[200:203], v[80:83], v[148:151]
    v_fma_f32 v32, v32, s29, v20
    v_fma_f32 v33, v33, s29, v20
    v_mfma_f32_16x16x32_bf16 v[148:151], a[204:207], v[84:87], v[148:151]
    ds_read_b64_tr_b16 a[218:219], v7 offset:54016
    v_fma_f32 v34, v34, s29, v20
    v_mfma_f32_16x16x32_bf16 v[212:215], a[200:203], v[88:91], v[212:215]
    v_exp_f32 v32, v32
    v_mfma_f32_16x16x32_bf16 v[212:215], a[204:207], v[92:95], v[212:215]
    s_add_u32 m0, s28, 4096
    ds_read_b64_tr_b16 a[220:221], v7 offset:58112
    v_mfma_f32_16x16x32_bf16 a[20:23], a[200:203], v[96:99], a[20:23]
    buffer_load_dwordx4 v13, s[20:23], s31 offen nt lds
    v_mfma_f32_16x16x32_bf16 a[20:23], a[204:207], v[100:103], a[20:23]
    s_waitcnt vmcnt(14)
    ds_read_b64_tr_b16 a[222:223], v7 offset:62208
    v_fma_f32 v35, v35, s29, v20
    v_mfma_f32_16x16x32_bf16 v[52:55], a[160:163], a[128:131], 0
    s_barrier
    v_exp_f32 v33, v33
    v_mfma_f32_16x16x32_bf16 v[52:55], a[164:167], a[132:135], v[52:55]
    ds_read_b128 a[160:163], v2 offset:32768
    v_add_f32 v16, v16, v32
    v_mfma_f32_16x16x32_bf16 v[52:55], a[168:171], a[136:139], v[52:55]
    v_exp_f32 v34, v34
    v_mfma_f32_16x16x32_bf16 v[52:55], a[172:175], a[140:143], v[52:55]
    s_add_u32 m0, s28, 8192
    ds_read_b128 a[164:167], v2 offset:33024
    v_mfma_f32_16x16x32_bf16 v[52:55], a[176:179], a[144:147], v[52:55]
    buffer_load_dwordx4 v14, s[20:23], s31 offen nt lds
    v_mfma_f32_16x16x32_bf16 v[52:55], a[180:183], a[148:151], v[52:55]
    ds_read_b128 a[168:171], v2 offset:33280
    v_add_f32 v16, v16, v33
    v_mfma_f32_16x16x32_bf16 v[52:55], a[184:187], a[152:155], v[52:55]
    v_exp_f32 v35, v35
    v_mfma_f32_16x16x32_bf16 v[52:55], a[188:191], a[156:159], v[52:55]
    ds_read_b128 a[172:175], v2 offset:33536
    v_cvt_pk_bf16_f32 v56, v32, v33
    v_mfma_f32_16x16x32_bf16 v[152:155], a[208:211], v[80:83], v[152:155]
    s_waitcnt lgkmcnt(2)
    v_add_f32 v16, v16, v34
    v_add_f32 v16, v16, v35
    v_mfma_f32_16x16x32_bf16 v[152:155], a[212:215], v[84:87], v[152:155]
    s_add_u32 m0, s28, 12288
    ds_read_b128 a[176:179], v2 offset:36864
    v_mfma_f32_16x16x32_bf16 v[216:219], a[208:211], v[88:91], v[216:219]
    buffer_load_dwordx4 v15, s[20:23], s31 offen nt lds
    v_mfma_f32_16x16x32_bf16 v[216:219], a[212:215], v[92:95], v[216:219]
    ds_read_b128 a[180:183], v2 offset:37120
    v_cvt_pk_bf16_f32 v57, v34, v35
    v_mfma_f32_16x16x32_bf16 a[24:27], a[208:211], v[96:99], a[24:27]
    v_fma_f32 v36, v36, s29, v22
    v_fma_f32 v37, v37, s29, v22
    v_mfma_f32_16x16x32_bf16 a[24:27], a[212:215], v[100:103], a[24:27]
    ds_read_b128 a[184:187], v2 offset:37376
    v_fma_f32 v38, v38, s29, v22
    v_mfma_f32_16x16x32_bf16 v[156:159], a[216:219], v[80:83], v[156:159]
    s_mov_b32 s30, 163840
    v_exp_f32 v36, v36
    v_mfma_f32_16x16x32_bf16 v[156:159], a[220:223], v[84:87], v[156:159]
    s_add_u32 m0, s28, 81920
    ds_read_b128 a[188:191], v2 offset:37632
    v_mfma_f32_16x16x32_bf16 v[220:223], a[216:219], v[88:91], v[220:223]
    buffer_load_dwordx4 v10, s[16:19], s30 offen nt lds
    v_mfma_f32_16x16x32_bf16 v[220:223], a[220:223], v[92:95], v[220:223]
    ds_read_b64_tr_b16 a[192:193], v5 offset:49152
    v_fma_f32 v39, v39, s29, v22
    v_mfma_f32_16x16x32_bf16 a[28:31], a[216:219], v[96:99], a[28:31]
    v_exp_f32 v37, v37
    v_mfma_f32_16x16x32_bf16 a[28:31], a[220:223], v[100:103], a[28:31]
    ds_read_b64_tr_b16 a[194:195], v5 offset:53248
    v_add_f32 v17, v17, v36
    v_mfma_f32_16x16x32_bf16 v[32:35], a[160:163], a[64:67], 0
    v_exp_f32 v38, v38
    v_mfma_f32_16x16x32_bf16 v[32:35], a[164:167], a[68:71], v[32:35]
    s_waitcnt lgkmcnt(2)
    s_add_u32 m0, s28, 85760
    ds_read_b64_tr_b16 a[196:197], v5 offset:57344
    v_mfma_f32_16x16x32_bf16 v[32:35], a[168:171], a[72:75], v[32:35]
    buffer_load_dwordx4 v10, s[16:19], s30 offen offset:256 nt lds
    v_mfma_f32_16x16x32_bf16 v[32:35], a[172:175], a[76:79], v[32:35]
    ds_read_b64_tr_b16 a[198:199], v5 offset:61440
    v_add_f32 v17, v17, v37
    v_mfma_f32_16x16x32_bf16 v[32:35], a[176:179], a[80:83], v[32:35]
    v_exp_f32 v39, v39
    v_mfma_f32_16x16x32_bf16 v[32:35], a[180:183], a[84:87], v[32:35]
    ds_read_b64_tr_b16 a[200:201], v8 offset:49152
    v_cvt_pk_bf16_f32 v64, v36, v37
    v_mfma_f32_16x16x32_bf16 v[32:35], a[184:187], a[88:91], v[32:35]
    v_add_f32 v17, v17, v38
    v_add_f32 v17, v17, v39
    v_mfma_f32_16x16x32_bf16 v[32:35], a[188:191], a[92:95], v[32:35]
    s_waitcnt lgkmcnt(2)
    s_add_u32 m0, s28, 90112
    ds_read_b64_tr_b16 a[202:203], v8 offset:53248
    v_mfma_f32_16x16x32_bf16 v[160:163], a[192:195], v[80:83], v[160:163]
    s_waitcnt lgkmcnt(2)
    buffer_load_dwordx4 v11, s[16:19], s30 offen nt lds
    v_mfma_f32_16x16x32_bf16 v[160:163], a[196:199], v[84:87], v[160:163]
    ds_read_b64_tr_b16 a[204:205], v8 offset:57344
    v_cvt_pk_bf16_f32 v65, v38, v39
    v_mfma_f32_16x16x32_bf16 v[224:227], a[192:195], v[88:91], v[224:227]
    v_fma_f32 v40, v40, s29, v24
    v_fma_f32 v41, v41, s29, v24
    v_mfma_f32_16x16x32_bf16 v[224:227], a[196:199], v[92:95], v[224:227]
    ds_read_b64_tr_b16 a[206:207], v8 offset:61440
    v_fma_f32 v42, v42, s29, v24
    v_mfma_f32_16x16x32_bf16 a[32:35], a[192:195], v[96:99], a[32:35]
    v_exp_f32 v40, v40
    v_mfma_f32_16x16x32_bf16 a[32:35], a[196:199], v[100:103], a[32:35]
    s_add_u32 m0, s28, 93952
    ds_read_b64_tr_b16 a[208:209], v5 offset:49408
    v_mfma_f32_16x16x32_bf16 v[36:39], a[160:163], a[96:99], 0
    buffer_load_dwordx4 v11, s[16:19], s30 offen offset:256 nt lds
    v_mfma_f32_16x16x32_bf16 v[36:39], a[164:167], a[100:103], v[36:39]
    ds_read_b64_tr_b16 a[210:211], v5 offset:53504
    v_fma_f32 v43, v43, s29, v24
    v_mfma_f32_16x16x32_bf16 v[36:39], a[168:171], a[104:107], v[36:39]
    v_exp_f32 v41, v41
    v_mfma_f32_16x16x32_bf16 v[36:39], a[172:175], a[108:111], v[36:39]
    ds_read_b64_tr_b16 a[212:213], v5 offset:57600
    v_add_f32 v18, v18, v40
    v_mfma_f32_16x16x32_bf16 v[36:39], a[176:179], a[112:115], v[36:39]
    v_exp_f32 v42, v42
    v_mfma_f32_16x16x32_bf16 v[36:39], a[180:183], a[116:119], v[36:39]
    ds_read_b64_tr_b16 a[214:215], v5 offset:61696
    v_add_f32 v18, v18, v41
    v_mfma_f32_16x16x32_bf16 v[36:39], a[184:187], a[120:123], v[36:39]
    v_exp_f32 v43, v43
    v_mfma_f32_16x16x32_bf16 v[36:39], a[188:191], a[124:127], v[36:39]
    s_waitcnt lgkmcnt(2)
    ds_read_b64_tr_b16 a[216:217], v8 offset:49408
    v_cvt_pk_bf16_f32 v72, v40, v41
    v_mfma_f32_16x16x32_bf16 v[164:167], a[200:203], v[80:83], v[164:167]
    v_add_f32 v18, v18, v42
    v_add_f32 v18, v18, v43
    v_mfma_f32_16x16x32_bf16 v[164:167], a[204:207], v[84:87], v[164:167]
    ds_read_b64_tr_b16 a[218:219], v8 offset:53504
    v_cvt_pk_bf16_f32 v73, v42, v43
    v_mfma_f32_16x16x32_bf16 v[228:231], a[200:203], v[88:91], v[228:231]
    v_fma_f32 v44, v44, s29, v20
    v_fma_f32 v45, v45, s29, v20
    v_mfma_f32_16x16x32_bf16 v[228:231], a[204:207], v[92:95], v[228:231]
    ds_read_b64_tr_b16 a[220:221], v8 offset:57600
    v_fma_f32 v46, v46, s29, v20
    v_mfma_f32_16x16x32_bf16 a[36:39], a[200:203], v[96:99], a[36:39]
    v_exp_f32 v44, v44
    v_mfma_f32_16x16x32_bf16 a[36:39], a[204:207], v[100:103], a[36:39]
    ds_read_b64_tr_b16 a[222:223], v8 offset:61696
    v_fma_f32 v47, v47, s29, v20
    v_mfma_f32_16x16x32_bf16 v[40:43], a[160:163], a[128:131], 0
    v_exp_f32 v45, v45
    v_mfma_f32_16x16x32_bf16 v[40:43], a[164:167], a[132:135], v[40:43]
    ds_read_b128 a[160:163], v2 offset:40960
    v_add_f32 v16, v16, v44
    v_mfma_f32_16x16x32_bf16 v[40:43], a[168:171], a[136:139], v[40:43]
    v_exp_f32 v46, v46
    v_mfma_f32_16x16x32_bf16 v[40:43], a[172:175], a[140:143], v[40:43]
    ds_read_b128 a[164:167], v2 offset:41216
    v_add_f32 v16, v16, v45
    v_mfma_f32_16x16x32_bf16 v[40:43], a[176:179], a[144:147], v[40:43]
    v_exp_f32 v47, v47
    v_mfma_f32_16x16x32_bf16 v[40:43], a[180:183], a[148:151], v[40:43]
    ds_read_b128 a[168:171], v2 offset:41472
    v_cvt_pk_bf16_f32 v58, v44, v45
    v_mfma_f32_16x16x32_bf16 v[40:43], a[184:187], a[152:155], v[40:43]
    v_add_f32 v16, v16, v46
    v_add_f32 v16, v16, v47
    v_mfma_f32_16x16x32_bf16 v[40:43], a[188:191], a[156:159], v[40:43]
    ds_read_b128 a[172:175], v2 offset:41728
    v_cvt_pk_bf16_f32 v59, v46, v47
    v_mfma_f32_16x16x32_bf16 v[168:171], a[208:211], v[80:83], v[168:171]
    s_waitcnt lgkmcnt(2)
    v_fma_f32 v48, v48, s29, v22
    v_fma_f32 v49, v49, s29, v22
    v_mfma_f32_16x16x32_bf16 v[168:171], a[212:215], v[84:87], v[168:171]
    ds_read_b128 a[176:179], v2 offset:45056
    v_fma_f32 v50, v50, s29, v22
    v_mfma_f32_16x16x32_bf16 v[232:235], a[208:211], v[88:91], v[232:235]
    v_exp_f32 v48, v48
    v_mfma_f32_16x16x32_bf16 v[232:235], a[212:215], v[92:95], v[232:235]
    ds_read_b128 a[180:183], v2 offset:45312
    v_fma_f32 v51, v51, s29, v22
    v_mfma_f32_16x16x32_bf16 a[40:43], a[208:211], v[96:99], a[40:43]
    v_exp_f32 v49, v49
    v_mfma_f32_16x16x32_bf16 a[40:43], a[212:215], v[100:103], a[40:43]
    ds_read_b128 a[184:187], v2 offset:45568
    v_add_f32 v17, v17, v48
    v_mfma_f32_16x16x32_bf16 v[172:175], a[216:219], v[80:83], v[172:175]
    s_mov_b32 s31, 98304
    v_exp_f32 v50, v50
    v_mfma_f32_16x16x32_bf16 v[172:175], a[220:223], v[84:87], v[172:175]
    s_add_u32 m0, s28, 16384
    ds_read_b128 a[188:191], v2 offset:45824
    v_mfma_f32_16x16x32_bf16 v[236:239], a[216:219], v[88:91], v[236:239]
    buffer_load_dwordx4 v12, s[20:23], s31 offen nt lds
    v_mfma_f32_16x16x32_bf16 v[236:239], a[220:223], v[92:95], v[236:239]
    ds_read_b64_tr_b16 a[192:193], v5 offset:49664
    v_add_f32 v17, v17, v49
    v_mfma_f32_16x16x32_bf16 a[44:47], a[216:219], v[96:99], a[44:47]
    v_exp_f32 v51, v51
    v_mfma_f32_16x16x32_bf16 a[44:47], a[220:223], v[100:103], a[44:47]
    ds_read_b64_tr_b16 a[194:195], v5 offset:53760
    v_cvt_pk_bf16_f32 v66, v48, v49
    v_mfma_f32_16x16x32_bf16 v[44:47], a[160:163], a[64:67], 0
    v_add_f32 v17, v17, v50
    v_add_f32 v17, v17, v51
    v_mfma_f32_16x16x32_bf16 v[44:47], a[164:167], a[68:71], v[44:47]
    s_waitcnt lgkmcnt(2)
    s_add_u32 m0, s28, 20480
    ds_read_b64_tr_b16 a[196:197], v5 offset:57856
    v_mfma_f32_16x16x32_bf16 v[44:47], a[168:171], a[72:75], v[44:47]
    buffer_load_dwordx4 v13, s[20:23], s31 offen nt lds
    v_mfma_f32_16x16x32_bf16 v[44:47], a[172:175], a[76:79], v[44:47]
    ds_read_b64_tr_b16 a[198:199], v5 offset:61952
    v_cvt_pk_bf16_f32 v67, v50, v51
    v_mfma_f32_16x16x32_bf16 v[44:47], a[176:179], a[80:83], v[44:47]
    v_fma_f32 v52, v52, s29, v24
    v_fma_f32 v53, v53, s29, v24
    v_mfma_f32_16x16x32_bf16 v[44:47], a[180:183], a[84:87], v[44:47]
    ds_read_b64_tr_b16 a[200:201], v8 offset:49664
    v_fma_f32 v54, v54, s29, v24
    v_mfma_f32_16x16x32_bf16 v[44:47], a[184:187], a[88:91], v[44:47]
    v_exp_f32 v52, v52
    v_mfma_f32_16x16x32_bf16 v[44:47], a[188:191], a[92:95], v[44:47]
    s_waitcnt lgkmcnt(2)
    s_add_u32 m0, s28, 24576
    ds_read_b64_tr_b16 a[202:203], v8 offset:53760
    v_mfma_f32_16x16x32_bf16 v[176:179], a[192:195], v[80:83], v[176:179]
    s_waitcnt lgkmcnt(2)
    buffer_load_dwordx4 v14, s[20:23], s31 offen nt lds
    v_mfma_f32_16x16x32_bf16 v[176:179], a[196:199], v[84:87], v[176:179]
    ds_read_b64_tr_b16 a[204:205], v8 offset:57856
    v_fma_f32 v55, v55, s29, v24
    v_mfma_f32_16x16x32_bf16 v[240:243], a[192:195], v[88:91], v[240:243]
    v_exp_f32 v53, v53
    v_mfma_f32_16x16x32_bf16 v[240:243], a[196:199], v[92:95], v[240:243]
    ds_read_b64_tr_b16 a[206:207], v8 offset:61952
    v_add_f32 v18, v18, v52
    v_mfma_f32_16x16x32_bf16 a[48:51], a[192:195], v[96:99], a[48:51]
    v_exp_f32 v54, v54
    v_mfma_f32_16x16x32_bf16 a[48:51], a[196:199], v[100:103], a[48:51]
    s_add_u32 m0, s28, 28672
    ds_read_b64_tr_b16 a[208:209], v5 offset:49920
    v_mfma_f32_16x16x32_bf16 v[48:51], a[160:163], a[96:99], 0
    buffer_load_dwordx4 v15, s[20:23], s31 offen nt lds
    v_mfma_f32_16x16x32_bf16 v[48:51], a[164:167], a[100:103], v[48:51]
    ds_read_b64_tr_b16 a[210:211], v5 offset:54016
    v_add_f32 v18, v18, v53
    v_mfma_f32_16x16x32_bf16 v[48:51], a[168:171], a[104:107], v[48:51]
    v_exp_f32 v55, v55
    v_mfma_f32_16x16x32_bf16 v[48:51], a[172:175], a[108:111], v[48:51]
    ds_read_b64_tr_b16 a[212:213], v5 offset:58112
    v_cvt_pk_bf16_f32 v74, v52, v53
    v_mfma_f32_16x16x32_bf16 v[48:51], a[176:179], a[112:115], v[48:51]
    s_mov_b32 s30, 180224
    v_add_f32 v18, v18, v54
    v_add_f32 v18, v18, v55
    v_mfma_f32_16x16x32_bf16 v[48:51], a[180:183], a[116:119], v[48:51]
    s_add_u32 m0, s28, 32768
    ds_read_b64_tr_b16 a[214:215], v5 offset:62208
    v_mfma_f32_16x16x32_bf16 v[48:51], a[184:187], a[120:123], v[48:51]
    buffer_load_dwordx4 v10, s[16:19], s30 offen nt lds
    v_mfma_f32_16x16x32_bf16 v[48:51], a[188:191], a[124:127], v[48:51]
    s_waitcnt lgkmcnt(2)
    ds_read_b64_tr_b16 a[216:217], v8 offset:49920
    v_cvt_pk_bf16_f32 v75, v54, v55
    v_mfma_f32_16x16x32_bf16 v[180:183], a[200:203], v[80:83], v[180:183]
    v_fma_f32 v32, v32, s29, v20
    v_fma_f32 v33, v33, s29, v20
    v_mfma_f32_16x16x32_bf16 v[180:183], a[204:207], v[84:87], v[180:183]
    ds_read_b64_tr_b16 a[218:219], v8 offset:54016
    v_fma_f32 v34, v34, s29, v20
    v_mfma_f32_16x16x32_bf16 v[244:247], a[200:203], v[88:91], v[244:247]
    v_exp_f32 v32, v32
    v_mfma_f32_16x16x32_bf16 v[244:247], a[204:207], v[92:95], v[244:247]
    s_add_u32 m0, s28, 36608
    ds_read_b64_tr_b16 a[220:221], v8 offset:58112
    v_mfma_f32_16x16x32_bf16 a[52:55], a[200:203], v[96:99], a[52:55]
    buffer_load_dwordx4 v10, s[16:19], s30 offen offset:256 nt lds
    v_mfma_f32_16x16x32_bf16 a[52:55], a[204:207], v[100:103], a[52:55]
    s_waitcnt vmcnt(18)
    ds_read_b64_tr_b16 a[222:223], v8 offset:62208
    v_fma_f32 v35, v35, s29, v20
    v_mfma_f32_16x16x32_bf16 v[52:55], a[160:163], a[128:131], 0
    s_barrier
    v_exp_f32 v33, v33
    v_mfma_f32_16x16x32_bf16 v[52:55], a[164:167], a[132:135], v[52:55]
    ds_read_b128 a[160:163], v3 offset:0
    v_add_f32 v16, v16, v32
    v_mfma_f32_16x16x32_bf16 v[52:55], a[168:171], a[136:139], v[52:55]
    v_exp_f32 v34, v34
    v_mfma_f32_16x16x32_bf16 v[52:55], a[172:175], a[140:143], v[52:55]
    s_add_u32 m0, s28, 40960
    ds_read_b128 a[164:167], v3 offset:256
    v_mfma_f32_16x16x32_bf16 v[52:55], a[176:179], a[144:147], v[52:55]
    buffer_load_dwordx4 v11, s[16:19], s30 offen nt lds
    v_mfma_f32_16x16x32_bf16 v[52:55], a[180:183], a[148:151], v[52:55]
    ds_read_b128 a[168:171], v3 offset:512
    v_add_f32 v16, v16, v33
    v_mfma_f32_16x16x32_bf16 v[52:55], a[184:187], a[152:155], v[52:55]
    v_exp_f32 v35, v35
    v_mfma_f32_16x16x32_bf16 v[52:55], a[188:191], a[156:159], v[52:55]
    ds_read_b128 a[172:175], v3 offset:768
    v_cvt_pk_bf16_f32 v60, v32, v33
    v_mfma_f32_16x16x32_bf16 v[184:187], a[208:211], v[80:83], v[184:187]
    s_waitcnt lgkmcnt(2)
    v_add_f32 v16, v16, v34
    v_add_f32 v16, v16, v35
    v_mfma_f32_16x16x32_bf16 v[184:187], a[212:215], v[84:87], v[184:187]
    s_add_u32 m0, s28, 44800
    ds_read_b128 a[176:179], v3 offset:4096
    v_mfma_f32_16x16x32_bf16 v[248:251], a[208:211], v[88:91], v[248:251]
    buffer_load_dwordx4 v11, s[16:19], s30 offen offset:256 nt lds
    v_mfma_f32_16x16x32_bf16 v[248:251], a[212:215], v[92:95], v[248:251]
    ds_read_b128 a[180:183], v3 offset:4352
    v_cvt_pk_bf16_f32 v61, v34, v35
    v_mfma_f32_16x16x32_bf16 a[56:59], a[208:211], v[96:99], a[56:59]
    v_fma_f32 v36, v36, s29, v22
    v_fma_f32 v37, v37, s29, v22
    v_mfma_f32_16x16x32_bf16 a[56:59], a[212:215], v[100:103], a[56:59]
    ds_read_b128 a[184:187], v3 offset:4608
    v_fma_f32 v38, v38, s29, v22
    v_mfma_f32_16x16x32_bf16 v[188:191], a[216:219], v[80:83], v[188:191]
    s_mov_b32 s31, 98560
    v_exp_f32 v36, v36
    v_mfma_f32_16x16x32_bf16 v[188:191], a[220:223], v[84:87], v[188:191]
    s_add_u32 m0, s28, 49152
    ds_read_b128 a[188:191], v3 offset:4864
    v_mfma_f32_16x16x32_bf16 v[252:255], a[216:219], v[88:91], v[252:255]
    buffer_load_dwordx4 v12, s[20:23], s31 offen nt lds
    v_mfma_f32_16x16x32_bf16 v[252:255], a[220:223], v[92:95], v[252:255]
    ds_read_b64_tr_b16 a[192:193], v6 offset:16384
    v_fma_f32 v39, v39, s29, v22
    v_mfma_f32_16x16x32_bf16 a[60:63], a[216:219], v[96:99], a[60:63]
    v_exp_f32 v37, v37
    v_mfma_f32_16x16x32_bf16 a[60:63], a[220:223], v[100:103], a[60:63]
    ds_read_b64_tr_b16 a[194:195], v6 offset:20480
    v_add_f32 v17, v17, v36
    v_mfma_f32_16x16x32_bf16 v[32:35], a[160:163], a[64:67], 0
    v_exp_f32 v38, v38
    v_mfma_f32_16x16x32_bf16 v[32:35], a[164:167], a[68:71], v[32:35]
    s_waitcnt lgkmcnt(2)
    s_add_u32 m0, s28, 53248
    ds_read_b64_tr_b16 a[196:197], v6 offset:24576
    v_mfma_f32_16x16x32_bf16 v[32:35], a[168:171], a[72:75], v[32:35]
    buffer_load_dwordx4 v13, s[20:23], s31 offen nt lds
    v_mfma_f32_16x16x32_bf16 v[32:35], a[172:175], a[76:79], v[32:35]
    ds_read_b64_tr_b16 a[198:199], v6 offset:28672
    v_add_f32 v17, v17, v37
    v_mfma_f32_16x16x32_bf16 v[32:35], a[176:179], a[80:83], v[32:35]
    v_exp_f32 v39, v39
    v_mfma_f32_16x16x32_bf16 v[32:35], a[180:183], a[84:87], v[32:35]
    ds_read_b64_tr_b16 a[200:201], v9 offset:16384
    v_cvt_pk_bf16_f32 v68, v36, v37
    v_mfma_f32_16x16x32_bf16 v[32:35], a[184:187], a[88:91], v[32:35]
    v_add_f32 v17, v17, v38
    v_add_f32 v17, v17, v39
    v_mfma_f32_16x16x32_bf16 v[32:35], a[188:191], a[92:95], v[32:35]
    s_waitcnt lgkmcnt(2)
    s_add_u32 m0, s28, 57344
    ds_read_b64_tr_b16 a[202:203], v9 offset:20480
    v_mfma_f32_16x16x32_bf16 v[128:131], a[192:195], v[104:107], v[128:131]
    s_waitcnt lgkmcnt(2)
    buffer_load_dwordx4 v14, s[20:23], s31 offen nt lds
    v_mfma_f32_16x16x32_bf16 v[128:131], a[196:199], v[108:111], v[128:131]
    ds_read_b64_tr_b16 a[204:205], v9 offset:24576
    v_cvt_pk_bf16_f32 v69, v38, v39
    v_mfma_f32_16x16x32_bf16 v[192:195], a[192:195], v[112:115], v[192:195]
    v_fma_f32 v40, v40, s29, v24
    v_fma_f32 v41, v41, s29, v24
    v_mfma_f32_16x16x32_bf16 v[192:195], a[196:199], v[116:119], v[192:195]
    ds_read_b64_tr_b16 a[206:207], v9 offset:28672
    v_fma_f32 v42, v42, s29, v24
    v_mfma_f32_16x16x32_bf16 a[0:3], a[192:195], v[120:123], a[0:3]
    v_exp_f32 v40, v40
    v_mfma_f32_16x16x32_bf16 a[0:3], a[196:199], v[124:127], a[0:3]
    s_add_u32 m0, s28, 61440
    ds_read_b64_tr_b16 a[208:209], v6 offset:16640
    v_mfma_f32_16x16x32_bf16 v[36:39], a[160:163], a[96:99], 0
    buffer_load_dwordx4 v15, s[20:23], s31 offen nt lds
    v_mfma_f32_16x16x32_bf16 v[36:39], a[164:167], a[100:103], v[36:39]
    ds_read_b64_tr_b16 a[210:211], v6 offset:20736
    v_fma_f32 v43, v43, s29, v24
    v_mfma_f32_16x16x32_bf16 v[36:39], a[168:171], a[104:107], v[36:39]
    v_exp_f32 v41, v41
    v_mfma_f32_16x16x32_bf16 v[36:39], a[172:175], a[108:111], v[36:39]
    ds_read_b64_tr_b16 a[212:213], v6 offset:24832
    v_add_f32 v18, v18, v40
    v_mfma_f32_16x16x32_bf16 v[36:39], a[176:179], a[112:115], v[36:39]
    v_exp_f32 v42, v42
    v_mfma_f32_16x16x32_bf16 v[36:39], a[180:183], a[116:119], v[36:39]
    ds_read_b64_tr_b16 a[214:215], v6 offset:28928
    v_add_f32 v18, v18, v41
    v_mfma_f32_16x16x32_bf16 v[36:39], a[184:187], a[120:123], v[36:39]
    v_exp_f32 v43, v43
    v_mfma_f32_16x16x32_bf16 v[36:39], a[188:191], a[124:127], v[36:39]
    s_waitcnt lgkmcnt(2)
    ds_read_b64_tr_b16 a[216:217], v9 offset:16640
    v_cvt_pk_bf16_f32 v76, v40, v41
    v_mfma_f32_16x16x32_bf16 v[132:135], a[200:203], v[104:107], v[132:135]
    v_add_f32 v18, v18, v42
    v_add_f32 v18, v18, v43
    v_mfma_f32_16x16x32_bf16 v[132:135], a[204:207], v[108:111], v[132:135]
    ds_read_b64_tr_b16 a[218:219], v9 offset:20736
    v_cvt_pk_bf16_f32 v77, v42, v43
    v_mfma_f32_16x16x32_bf16 v[196:199], a[200:203], v[112:115], v[196:199]
    v_fma_f32 v44, v44, s29, v20
    v_fma_f32 v45, v45, s29, v20
    v_mfma_f32_16x16x32_bf16 v[196:199], a[204:207], v[116:119], v[196:199]
    ds_read_b64_tr_b16 a[220:221], v9 offset:24832
    v_fma_f32 v46, v46, s29, v20
    v_mfma_f32_16x16x32_bf16 a[4:7], a[200:203], v[120:123], a[4:7]
    v_exp_f32 v44, v44
    v_mfma_f32_16x16x32_bf16 a[4:7], a[204:207], v[124:127], a[4:7]
    ds_read_b64_tr_b16 a[222:223], v9 offset:28928
    v_fma_f32 v47, v47, s29, v20
    v_mfma_f32_16x16x32_bf16 v[40:43], a[160:163], a[128:131], 0
    v_exp_f32 v45, v45
    v_mfma_f32_16x16x32_bf16 v[40:43], a[164:167], a[132:135], v[40:43]
    ds_read_b128 a[160:163], v3 offset:8192
    v_add_f32 v16, v16, v44
    v_mfma_f32_16x16x32_bf16 v[40:43], a[168:171], a[136:139], v[40:43]
    v_exp_f32 v46, v46
    v_mfma_f32_16x16x32_bf16 v[40:43], a[172:175], a[140:143], v[40:43]
    ds_read_b128 a[164:167], v3 offset:8448
    v_add_f32 v16, v16, v45
    v_mfma_f32_16x16x32_bf16 v[40:43], a[176:179], a[144:147], v[40:43]
    v_exp_f32 v47, v47
    v_mfma_f32_16x16x32_bf16 v[40:43], a[180:183], a[148:151], v[40:43]
    ds_read_b128 a[168:171], v3 offset:8704
    v_cvt_pk_bf16_f32 v62, v44, v45
    v_mfma_f32_16x16x32_bf16 v[40:43], a[184:187], a[152:155], v[40:43]
    v_add_f32 v16, v16, v46
    v_add_f32 v16, v16, v47
    v_mfma_f32_16x16x32_bf16 v[40:43], a[188:191], a[156:159], v[40:43]
    ds_read_b128 a[172:175], v3 offset:8960
    v_cvt_pk_bf16_f32 v63, v46, v47
    v_mfma_f32_16x16x32_bf16 v[136:139], a[208:211], v[104:107], v[136:139]
    s_waitcnt lgkmcnt(2)
    v_fma_f32 v48, v48, s29, v22
    v_fma_f32 v49, v49, s29, v22
    v_mfma_f32_16x16x32_bf16 v[136:139], a[212:215], v[108:111], v[136:139]
    ds_read_b128 a[176:179], v3 offset:12288
    v_fma_f32 v50, v50, s29, v22
    v_mfma_f32_16x16x32_bf16 v[200:203], a[208:211], v[112:115], v[200:203]
    v_exp_f32 v48, v48
    v_mfma_f32_16x16x32_bf16 v[200:203], a[212:215], v[116:119], v[200:203]
    ds_read_b128 a[180:183], v3 offset:12544
    v_fma_f32 v51, v51, s29, v22
    v_mfma_f32_16x16x32_bf16 a[8:11], a[208:211], v[120:123], a[8:11]
    v_exp_f32 v49, v49
    v_mfma_f32_16x16x32_bf16 a[8:11], a[212:215], v[124:127], a[8:11]
    ds_read_b128 a[184:187], v3 offset:12800
    v_add_f32 v17, v17, v48
    v_mfma_f32_16x16x32_bf16 v[140:143], a[216:219], v[104:107], v[140:143]
    s_mov_b32 s30, 196608
    v_exp_f32 v50, v50
    v_mfma_f32_16x16x32_bf16 v[140:143], a[220:223], v[108:111], v[140:143]
    s_add_u32 m0, s28, 98304
    ds_read_b128 a[188:191], v3 offset:13056
    v_mfma_f32_16x16x32_bf16 v[204:207], a[216:219], v[112:115], v[204:207]
    buffer_load_dwordx4 v10, s[16:19], s30 offen nt lds
    v_mfma_f32_16x16x32_bf16 v[204:207], a[220:223], v[116:119], v[204:207]
    ds_read_b64_tr_b16 a[192:193], v6 offset:16896
    v_add_f32 v17, v17, v49
    v_mfma_f32_16x16x32_bf16 a[12:15], a[216:219], v[120:123], a[12:15]
    v_exp_f32 v51, v51
    v_mfma_f32_16x16x32_bf16 a[12:15], a[220:223], v[124:127], a[12:15]
    ds_read_b64_tr_b16 a[194:195], v6 offset:20992
    v_cvt_pk_bf16_f32 v70, v48, v49
    v_mfma_f32_16x16x32_bf16 v[44:47], a[160:163], a[64:67], 0
    v_add_f32 v17, v17, v50
    v_add_f32 v17, v17, v51
    v_mfma_f32_16x16x32_bf16 v[44:47], a[164:167], a[68:71], v[44:47]
    s_waitcnt lgkmcnt(2)
    s_add_u32 m0, s28, 102144
    ds_read_b64_tr_b16 a[196:197], v6 offset:25088
    v_mfma_f32_16x16x32_bf16 v[44:47], a[168:171], a[72:75], v[44:47]
    buffer_load_dwordx4 v10, s[16:19], s30 offen offset:256 nt lds
    v_mfma_f32_16x16x32_bf16 v[44:47], a[172:175], a[76:79], v[44:47]
    ds_read_b64_tr_b16 a[198:199], v6 offset:29184
    v_cvt_pk_bf16_f32 v71, v50, v51
    v_mfma_f32_16x16x32_bf16 v[44:47], a[176:179], a[80:83], v[44:47]
    v_fma_f32 v52, v52, s29, v24
    v_fma_f32 v53, v53, s29, v24
    v_mfma_f32_16x16x32_bf16 v[44:47], a[180:183], a[84:87], v[44:47]
    ds_read_b64_tr_b16 a[200:201], v9 offset:16896
    v_fma_f32 v54, v54, s29, v24
    v_mfma_f32_16x16x32_bf16 v[44:47], a[184:187], a[88:91], v[44:47]
    v_exp_f32 v52, v52
    v_mfma_f32_16x16x32_bf16 v[44:47], a[188:191], a[92:95], v[44:47]
    s_waitcnt lgkmcnt(2)
    s_add_u32 m0, s28, 106496
    ds_read_b64_tr_b16 a[202:203], v9 offset:20992
    v_mfma_f32_16x16x32_bf16 v[144:147], a[192:195], v[104:107], v[144:147]
    s_waitcnt lgkmcnt(2)
    buffer_load_dwordx4 v11, s[16:19], s30 offen nt lds
    v_mfma_f32_16x16x32_bf16 v[144:147], a[196:199], v[108:111], v[144:147]
    ds_read_b64_tr_b16 a[204:205], v9 offset:25088
    v_fma_f32 v55, v55, s29, v24
    v_mfma_f32_16x16x32_bf16 v[208:211], a[192:195], v[112:115], v[208:211]
    v_exp_f32 v53, v53
    v_mfma_f32_16x16x32_bf16 v[208:211], a[196:199], v[116:119], v[208:211]
    ds_read_b64_tr_b16 a[206:207], v9 offset:29184
    v_add_f32 v18, v18, v52
    v_mfma_f32_16x16x32_bf16 a[16:19], a[192:195], v[120:123], a[16:19]
    v_exp_f32 v54, v54
    v_mfma_f32_16x16x32_bf16 a[16:19], a[196:199], v[124:127], a[16:19]
    s_add_u32 m0, s28, 110336
    ds_read_b64_tr_b16 a[208:209], v6 offset:17152
    v_mfma_f32_16x16x32_bf16 v[48:51], a[160:163], a[96:99], 0
    buffer_load_dwordx4 v11, s[16:19], s30 offen offset:256 nt lds
    v_mfma_f32_16x16x32_bf16 v[48:51], a[164:167], a[100:103], v[48:51]
    ds_read_b64_tr_b16 a[210:211], v6 offset:21248
    v_add_f32 v18, v18, v53
    v_mfma_f32_16x16x32_bf16 v[48:51], a[168:171], a[104:107], v[48:51]
    v_exp_f32 v55, v55
    v_mfma_f32_16x16x32_bf16 v[48:51], a[172:175], a[108:111], v[48:51]
    ds_read_b64_tr_b16 a[212:213], v6 offset:25344
    v_cvt_pk_bf16_f32 v78, v52, v53
    v_mfma_f32_16x16x32_bf16 v[48:51], a[176:179], a[112:115], v[48:51]
    v_add_f32 v18, v18, v54
    v_add_f32 v18, v18, v55
    v_mfma_f32_16x16x32_bf16 v[48:51], a[180:183], a[116:119], v[48:51]
    ds_read_b64_tr_b16 a[214:215], v6 offset:29440
    v_cvt_pk_bf16_f32 v79, v54, v55
    v_mfma_f32_16x16x32_bf16 v[48:51], a[184:187], a[120:123], v[48:51]
    v_fma_f32 v32, v32, s29, v20
    v_fma_f32 v33, v33, s29, v20
    v_mfma_f32_16x16x32_bf16 v[48:51], a[188:191], a[124:127], v[48:51]
    s_waitcnt lgkmcnt(2)
    ds_read_b64_tr_b16 a[216:217], v9 offset:17152
    v_fma_f32 v34, v34, s29, v20
    v_mfma_f32_16x16x32_bf16 v[148:151], a[200:203], v[104:107], v[148:151]
    v_exp_f32 v32, v32
    v_mfma_f32_16x16x32_bf16 v[148:151], a[204:207], v[108:111], v[148:151]
    ds_read_b64_tr_b16 a[218:219], v9 offset:21248
    v_fma_f32 v35, v35, s29, v20
    v_mfma_f32_16x16x32_bf16 v[212:215], a[200:203], v[112:115], v[212:215]
    v_exp_f32 v33, v33
    v_mfma_f32_16x16x32_bf16 v[212:215], a[204:207], v[116:119], v[212:215]
    ds_read_b64_tr_b16 a[220:221], v9 offset:25344
    v_add_f32 v16, v16, v32
    v_mfma_f32_16x16x32_bf16 a[20:23], a[200:203], v[120:123], a[20:23]
    s_mov_b32 s31, 131072
    v_exp_f32 v34, v34
    v_mfma_f32_16x16x32_bf16 a[20:23], a[204:207], v[124:127], a[20:23]
    s_waitcnt vmcnt(20)
    ds_read_b64_tr_b16 a[222:223], v9 offset:29440
    v_add_f32 v16, v16, v33
    v_mfma_f32_16x16x32_bf16 v[52:55], a[160:163], a[128:131], 0
    s_barrier
    v_exp_f32 v35, v35
    v_mfma_f32_16x16x32_bf16 v[52:55], a[164:167], a[132:135], v[52:55]
    s_add_u32 m0, s28, 114688
    ds_read_b128 a[160:163], v2 offset:0
    v_mfma_f32_16x16x32_bf16 v[52:55], a[168:171], a[136:139], v[52:55]
    buffer_load_dwordx4 v12, s[20:23], s31 offen nt lds
    v_mfma_f32_16x16x32_bf16 v[52:55], a[172:175], a[140:143], v[52:55]
    ds_read_b128 a[164:167], v2 offset:256
    v_cvt_pk_bf16_f32 v80, v32, v33
    v_mfma_f32_16x16x32_bf16 v[52:55], a[176:179], a[144:147], v[52:55]
    v_add_f32 v16, v16, v34
    v_add_f32 v16, v16, v35
    v_mfma_f32_16x16x32_bf16 v[52:55], a[180:183], a[148:151], v[52:55]
    ds_read_b128 a[168:171], v2 offset:512
    v_cvt_pk_bf16_f32 v81, v34, v35
    v_mfma_f32_16x16x32_bf16 v[52:55], a[184:187], a[152:155], v[52:55]
    v_fma_f32 v36, v36, s29, v22
L_pg3:
    s_cbranch_execz L_wr3
    v_fma_f32 v37, v37, s29, v22
    v_mfma_f32_16x16x32_bf16 v[52:55], a[188:191], a[156:159], v[52:55]
    s_add_u32 m0, s28, 118784
    ds_read_b128 a[172:175], v2 offset:768
    v_mfma_f32_16x16x32_bf16 v[152:155], a[208:211], v[104:107], v[152:155]
    s_waitcnt lgkmcnt(2)
    buffer_load_dwordx4 v13, s[20:23], s31 offen nt lds
    v_mfma_f32_16x16x32_bf16 v[152:155], a[212:215], v[108:111], v[152:155]
    ds_read_b128 a[176:179], v2 offset:4096
    v_fma_f32 v38, v38, s29, v22
    v_mfma_f32_16x16x32_bf16 v[216:219], a[208:211], v[112:115], v[216:219]
    v_exp_f32 v36, v36
    v_mfma_f32_16x16x32_bf16 v[216:219], a[212:215], v[116:119], v[216:219]
    ds_read_b128 a[180:183], v2 offset:4352
    v_fma_f32 v39, v39, s29, v22
    v_mfma_f32_16x16x32_bf16 a[24:27], a[208:211], v[120:123], a[24:27]
    v_exp_f32 v37, v37
    v_mfma_f32_16x16x32_bf16 a[24:27], a[212:215], v[124:127], a[24:27]
    s_add_u32 m0, s28, 122880
    ds_read_b128 a[184:187], v2 offset:4608
    v_mfma_f32_16x16x32_bf16 v[156:159], a[216:219], v[104:107], v[156:159]
    buffer_load_dwordx4 v14, s[20:23], s31 offen nt lds
    v_mfma_f32_16x16x32_bf16 v[156:159], a[220:223], v[108:111], v[156:159]
    ds_read_b128 a[188:191], v2 offset:4864
    v_add_f32 v17, v17, v36
    v_mfma_f32_16x16x32_bf16 v[220:223], a[216:219], v[112:115], v[220:223]
    v_exp_f32 v38, v38
    v_mfma_f32_16x16x32_bf16 v[220:223], a[220:223], v[116:119], v[220:223]
    ds_read_b64_tr_b16 a[192:193], v4 offset:0
    v_add_f32 v17, v17, v37
    v_mfma_f32_16x16x32_bf16 a[28:31], a[216:219], v[120:123], a[28:31]
    v_exp_f32 v39, v39
    v_mfma_f32_16x16x32_bf16 a[28:31], a[220:223], v[124:127], a[28:31]
    s_add_u32 m0, s28, 126976
    ds_read_b64_tr_b16 a[194:195], v4 offset:4096
    v_mfma_f32_16x16x32_bf16 v[32:35], a[160:163], a[64:67], 0
    buffer_load_dwordx4 v15, s[20:23], s31 offen nt lds
    v_mfma_f32_16x16x32_bf16 v[32:35], a[164:167], a[68:71], v[32:35]
    s_waitcnt lgkmcnt(2)
    ds_read_b64_tr_b16 a[196:197], v4 offset:8192
    v_cvt_pk_bf16_f32 v88, v36, v37
    v_mfma_f32_16x16x32_bf16 v[32:35], a[168:171], a[72:75], v[32:35]
    v_add_f32 v17, v17, v38
    v_add_f32 v17, v17, v39
    v_mfma_f32_16x16x32_bf16 v[32:35], a[172:175], a[76:79], v[32:35]
    ds_read_b64_tr_b16 a[198:199], v4 offset:12288
    v_cvt_pk_bf16_f32 v89, v38, v39
    v_mfma_f32_16x16x32_bf16 v[32:35], a[176:179], a[80:83], v[32:35]
    s_mov_b32 s30, 212992
    v_fma_f32 v40, v40, s29, v24
    v_fma_f32 v41, v41, s29, v24
    v_mfma_f32_16x16x32_bf16 v[32:35], a[180:183], a[84:87], v[32:35]
    s_add_u32 m0, s28, 131072
    ds_read_b64_tr_b16 a[200:201], v7 offset:0
    v_mfma_f32_16x16x32_bf16 v[32:35], a[184:187], a[88:91], v[32:35]
    buffer_load_dwordx4 v10, s[16:19], s30 offen nt lds
    v_mfma_f32_16x16x32_bf16 v[32:35], a[188:191], a[92:95], v[32:35]
    s_waitcnt lgkmcnt(2)
    ds_read_b64_tr_b16 a[202:203], v7 offset:4096
    v_fma_f32 v42, v42, s29, v24
    v_mfma_f32_16x16x32_bf16 v[160:163], a[192:195], v[104:107], v[160:163]
    s_waitcnt lgkmcnt(2)
    v_exp_f32 v40, v40
    v_mfma_f32_16x16x32_bf16 v[160:163], a[196:199], v[108:111], v[160:163]
    ds_read_b64_tr_b16 a[204:205], v7 offset:8192
    v_fma_f32 v43, v43, s29, v24
    v_mfma_f32_16x16x32_bf16 v[224:227], a[192:195], v[112:115], v[224:227]
    v_exp_f32 v41, v41
    v_mfma_f32_16x16x32_bf16 v[224:227], a[196:199], v[116:119], v[224:227]
    s_add_u32 m0, s28, 134912
    ds_read_b64_tr_b16 a[206:207], v7 offset:12288
    v_mfma_f32_16x16x32_bf16 a[32:35], a[192:195], v[120:123], a[32:35]
    buffer_load_dwordx4 v10, s[16:19], s30 offen offset:256 nt lds
    v_mfma_f32_16x16x32_bf16 a[32:35], a[196:199], v[124:127], a[32:35]
    ds_read_b64_tr_b16 a[208:209], v4 offset:256
    v_add_f32 v18, v18, v40
    v_mfma_f32_16x16x32_bf16 v[36:39], a[160:163], a[96:99], 0
    v_exp_f32 v42, v42
    v_mfma_f32_16x16x32_bf16 v[36:39], a[164:167], a[100:103], v[36:39]
    ds_read_b64_tr_b16 a[210:211], v4 offset:4352
    v_add_f32 v18, v18, v41
    v_mfma_f32_16x16x32_bf16 v[36:39], a[168:171], a[104:107], v[36:39]
    v_exp_f32 v43, v43
    v_mfma_f32_16x16x32_bf16 v[36:39], a[172:175], a[108:111], v[36:39]
    s_add_u32 m0, s28, 139264
    ds_read_b64_tr_b16 a[212:213], v4 offset:8448
    v_mfma_f32_16x16x32_bf16 v[36:39], a[176:179], a[112:115], v[36:39]
    buffer_load_dwordx4 v11, s[16:19], s30 offen nt lds
    v_mfma_f32_16x16x32_bf16 v[36:39], a[180:183], a[116:119], v[36:39]
    ds_read_b64_tr_b16 a[214:215], v4 offset:12544
    v_cvt_pk_bf16_f32 v96, v40, v41
    v_mfma_f32_16x16x32_bf16 v[36:39], a[184:187], a[120:123], v[36:39]
    v_add_f32 v18, v18, v42
    v_add_f32 v18, v18, v43
    v_mfma_f32_16x16x32_bf16 v[36:39], a[188:191], a[124:127], v[36:39]
    s_waitcnt lgkmcnt(2)
    ds_read_b64_tr_b16 a[216:217], v7 offset:256
    v_cvt_pk_bf16_f32 v97, v42, v43
    v_mfma_f32_16x16x32_bf16 v[164:167], a[200:203], v[104:107], v[164:167]
    v_fma_f32 v44, v44, s29, v20
    v_fma_f32 v45, v45, s29, v20
    v_mfma_f32_16x16x32_bf16 v[164:167], a[204:207], v[108:111], v[164:167]
    s_add_u32 m0, s28, 143104
    ds_read_b64_tr_b16 a[218:219], v7 offset:4352
    v_mfma_f32_16x16x32_bf16 v[228:231], a[200:203], v[112:115], v[228:231]
    buffer_load_dwordx4 v11, s[16:19], s30 offen offset:256 nt lds
    v_mfma_f32_16x16x32_bf16 v[228:231], a[204:207], v[116:119], v[228:231]
    ds_read_b64_tr_b16 a[220:221], v7 offset:8448
    v_fma_f32 v46, v46, s29, v20
    v_mfma_f32_16x16x32_bf16 a[36:39], a[200:203], v[120:123], a[36:39]
    v_exp_f32 v44, v44
    v_mfma_f32_16x16x32_bf16 a[36:39], a[204:207], v[124:127], a[36:39]
    ds_read_b64_tr_b16 a[222:223], v7 offset:12544
    v_fma_f32 v47, v47, s29, v20
    v_mfma_f32_16x16x32_bf16 v[40:43], a[160:163], a[128:131], 0
    v_exp_f32 v45, v45
    v_mfma_f32_16x16x32_bf16 v[40:43], a[164:167], a[132:135], v[40:43]
    ds_read_b128 a[160:163], v2 offset:8192
    v_add_f32 v16, v16, v44
    v_mfma_f32_16x16x32_bf16 v[40:43], a[168:171], a[136:139], v[40:43]
    v_exp_f32 v46, v46
    v_mfma_f32_16x16x32_bf16 v[40:43], a[172:175], a[140:143], v[40:43]
    ds_read_b128 a[164:167], v2 offset:8448
    v_add_f32 v16, v16, v45
    v_mfma_f32_16x16x32_bf16 v[40:43], a[176:179], a[144:147], v[40:43]
    v_exp_f32 v47, v47
    v_mfma_f32_16x16x32_bf16 v[40:43], a[180:183], a[148:151], v[40:43]
    ds_read_b128 a[168:171], v2 offset:8704
    v_cvt_pk_bf16_f32 v82, v44, v45
    v_mfma_f32_16x16x32_bf16 v[40:43], a[184:187], a[152:155], v[40:43]
    v_add_f32 v16, v16, v46
    v_add_f32 v16, v16, v47
    v_mfma_f32_16x16x32_bf16 v[40:43], a[188:191], a[156:159], v[40:43]
    ds_read_b128 a[172:175], v2 offset:8960
    v_cvt_pk_bf16_f32 v83, v46, v47
    v_mfma_f32_16x16x32_bf16 v[168:171], a[208:211], v[104:107], v[168:171]
    s_waitcnt lgkmcnt(2)
    v_fma_f32 v48, v48, s29, v22
    v_fma_f32 v49, v49, s29, v22
    v_mfma_f32_16x16x32_bf16 v[168:171], a[212:215], v[108:111], v[168:171]
    ds_read_b128 a[176:179], v2 offset:12288
    v_fma_f32 v50, v50, s29, v22
    v_mfma_f32_16x16x32_bf16 v[232:235], a[208:211], v[112:115], v[232:235]
    v_exp_f32 v48, v48
    v_mfma_f32_16x16x32_bf16 v[232:235], a[212:215], v[116:119], v[232:235]
    ds_read_b128 a[180:183], v2 offset:12544
    v_fma_f32 v51, v51, s29, v22
    v_mfma_f32_16x16x32_bf16 a[40:43], a[208:211], v[120:123], a[40:43]
    v_exp_f32 v49, v49
    v_mfma_f32_16x16x32_bf16 a[40:43], a[212:215], v[124:127], a[40:43]
    ds_read_b128 a[184:187], v2 offset:12800
    v_add_f32 v17, v17, v48
    v_mfma_f32_16x16x32_bf16 v[172:175], a[216:219], v[104:107], v[172:175]
    v_exp_f32 v50, v50
    v_mfma_f32_16x16x32_bf16 v[172:175], a[220:223], v[108:111], v[172:175]
    ds_read_b128 a[188:191], v2 offset:13056
    v_add_f32 v17, v17, v49
    v_mfma_f32_16x16x32_bf16 v[236:239], a[216:219], v[112:115], v[236:239]
    v_exp_f32 v51, v51
    v_mfma_f32_16x16x32_bf16 v[236:239], a[220:223], v[116:119], v[236:239]
    ds_read_b64_tr_b16 a[192:193], v4 offset:512
    v_cvt_pk_bf16_f32 v90, v48, v49
    v_mfma_f32_16x16x32_bf16 a[44:47], a[216:219], v[120:123], a[44:47]
    v_add_f32 v17, v17, v50
    v_add_f32 v17, v17, v51
    v_mfma_f32_16x16x32_bf16 a[44:47], a[220:223], v[124:127], a[44:47]
    ds_read_b64_tr_b16 a[194:195], v4 offset:4608
    v_cvt_pk_bf16_f32 v91, v50, v51
    v_mfma_f32_16x16x32_bf16 v[44:47], a[160:163], a[64:67], 0
    v_fma_f32 v52, v52, s29, v24
    v_fma_f32 v53, v53, s29, v24
    v_mfma_f32_16x16x32_bf16 v[44:47], a[164:167], a[68:71], v[44:47]
    s_waitcnt lgkmcnt(2)
    ds_read_b64_tr_b16 a[196:197], v4 offset:8704
    v_fma_f32 v54, v54, s29, v24
    v_mfma_f32_16x16x32_bf16 v[44:47], a[168:171], a[72:75], v[44:47]
    v_exp_f32 v52, v52
    v_mfma_f32_16x16x32_bf16 v[44:47], a[172:175], a[76:79], v[44:47]
    ds_read_b64_tr_b16 a[198:199], v4 offset:12800
    v_fma_f32 v55, v55, s29, v24
    v_mfma_f32_16x16x32_bf16 v[44:47], a[176:179], a[80:83], v[44:47]
    v_exp_f32 v53, v53
    v_mfma_f32_16x16x32_bf16 v[44:47], a[180:183], a[84:87], v[44:47]
    ds_read_b64_tr_b16 a[200:201], v7 offset:512
    v_add_f32 v18, v18, v52
    v_mfma_f32_16x16x32_bf16 v[44:47], a[184:187], a[88:91], v[44:47]
    v_exp_f32 v54, v54
    v_mfma_f32_16x16x32_bf16 v[44:47], a[188:191], a[92:95], v[44:47]
    s_waitcnt lgkmcnt(2)
    ds_read_b64_tr_b16 a[202:203], v7 offset:4608
    v_add_f32 v18, v18, v53
    v_mfma_f32_16x16x32_bf16 v[176:179], a[192:195], v[104:107], v[176:179]
    s_waitcnt lgkmcnt(2)
    v_exp_f32 v55, v55
    v_mfma_f32_16x16x32_bf16 v[176:179], a[196:199], v[108:111], v[176:179]
    ds_read_b64_tr_b16 a[204:205], v7 offset:8704
    v_cvt_pk_bf16_f32 v98, v52, v53
    v_mfma_f32_16x16x32_bf16 v[240:243], a[192:195], v[112:115], v[240:243]
    v_add_f32 v18, v18, v54
    v_add_f32 v18, v18, v55
    v_mfma_f32_16x16x32_bf16 v[240:243], a[196:199], v[116:119], v[240:243]
    ds_read_b64_tr_b16 a[206:207], v7 offset:12800
    v_cvt_pk_bf16_f32 v99, v54, v55
    v_mfma_f32_16x16x32_bf16 a[48:51], a[192:195], v[120:123], a[48:51]
    v_fma_f32 v32, v32, s29, v20
    v_fma_f32 v33, v33, s29, v20
    v_mfma_f32_16x16x32_bf16 a[48:51], a[196:199], v[124:127], a[48:51]
    ds_read_b64_tr_b16 a[208:209], v4 offset:768
    v_fma_f32 v34, v34, s29, v20
    v_mfma_f32_16x16x32_bf16 v[48:51], a[160:163], a[96:99], 0
    v_exp_f32 v32, v32
    v_mfma_f32_16x16x32_bf16 v[48:51], a[164:167], a[100:103], v[48:51]
    ds_read_b64_tr_b16 a[210:211], v4 offset:4864
    v_fma_f32 v35, v35, s29, v20
    v_mfma_f32_16x16x32_bf16 v[48:51], a[168:171], a[104:107], v[48:51]
    v_exp_f32 v33, v33
    v_mfma_f32_16x16x32_bf16 v[48:51], a[172:175], a[108:111], v[48:51]
    ds_read_b64_tr_b16 a[212:213], v4 offset:8960
    v_add_f32 v16, v16, v32
    v_mfma_f32_16x16x32_bf16 v[48:51], a[176:179], a[112:115], v[48:51]
    v_exp_f32 v34, v34
    v_mfma_f32_16x16x32_bf16 v[48:51], a[180:183], a[116:119], v[48:51]
    ds_read_b64_tr_b16 a[214:215], v4 offset:13056
    v_add_f32 v16, v16, v33
    v_mfma_f32_16x16x32_bf16 v[48:51], a[184:187], a[120:123], v[48:51]
    v_exp_f32 v35, v35
    v_mfma_f32_16x16x32_bf16 v[48:51], a[188:191], a[124:127], v[48:51]
    s_waitcnt lgkmcnt(2)
    ds_read_b64_tr_b16 a[216:217], v7 offset:768
    v_cvt_pk_bf16_f32 v84, v32, v33
    v_mfma_f32_16x16x32_bf16 v[180:183], a[200:203], v[104:107], v[180:183]
    v_add_f32 v16, v16, v34
    v_add_f32 v16, v16, v35
    v_mfma_f32_16x16x32_bf16 v[180:183], a[204:207], v[108:111], v[180:183]
    ds_read_b64_tr_b16 a[218:219], v7 offset:4864
    v_cvt_pk_bf16_f32 v85, v34, v35
    v_mfma_f32_16x16x32_bf16 v[244:247], a[200:203], v[112:115], v[244:247]
    v_fma_f32 v36, v36, s29, v22
    v_fma_f32 v37, v37, s29, v22
    v_mfma_f32_16x16x32_bf16 v[244:247], a[204:207], v[116:119], v[244:247]
    ds_read_b64_tr_b16 a[220:221], v7 offset:8960
    v_fma_f32 v38, v38, s29, v22
    v_mfma_f32_16x16x32_bf16 a[52:55], a[200:203], v[120:123], a[52:55]
    s_mov_b32 s31, 131328
    v_exp_f32 v36, v36
    v_mfma_f32_16x16x32_bf16 a[52:55], a[204:207], v[124:127], a[52:55]
    s_waitcnt vmcnt(20)
    ds_read_b64_tr_b16 a[222:223], v7 offset:13056
    v_fma_f32 v39, v39, s29, v22
    v_mfma_f32_16x16x32_bf16 v[52:55], a[160:163], a[128:131], 0
    s_barrier
    v_exp_f32 v37, v37
    v_mfma_f32_16x16x32_bf16 v[52:55], a[164:167], a[132:135], v[52:55]
    s_add_u32 m0, s28, 65536
    ds_read_b128 a[160:163], v2 offset:16384
    v_mfma_f32_16x16x32_bf16 v[52:55], a[168:171], a[136:139], v[52:55]
    buffer_load_dwordx4 v12, s[20:23], s31 offen nt lds
    v_mfma_f32_16x16x32_bf16 v[52:55], a[172:175], a[140:143], v[52:55]
    ds_read_b128 a[164:167], v2 offset:16640
    v_add_f32 v17, v17, v36
    v_mfma_f32_16x16x32_bf16 v[52:55], a[176:179], a[144:147], v[52:55]
    v_exp_f32 v38, v38
    v_mfma_f32_16x16x32_bf16 v[52:55], a[180:183], a[148:151], v[52:55]
    ds_read_b128 a[168:171], v2 offset:16896
    v_add_f32 v17, v17, v37
    v_mfma_f32_16x16x32_bf16 v[52:55], a[184:187], a[152:155], v[52:55]
    v_exp_f32 v39, v39
    v_mfma_f32_16x16x32_bf16 v[52:55], a[188:191], a[156:159], v[52:55]
    s_add_u32 m0, s28, 69632
    ds_read_b128 a[172:175], v2 offset:17152
    v_mfma_f32_16x16x32_bf16 v[184:187], a[208:211], v[104:107], v[184:187]
    s_waitcnt lgkmcnt(2)
    buffer_load_dwordx4 v13, s[20:23], s31 offen nt lds
    v_mfma_f32_16x16x32_bf16 v[184:187], a[212:215], v[108:111], v[184:187]
    ds_read_b128 a[176:179], v2 offset:20480
    v_cvt_pk_bf16_f32 v92, v36, v37
    v_mfma_f32_16x16x32_bf16 v[248:251], a[208:211], v[112:115], v[248:251]
    v_add_f32 v17, v17, v38
    v_add_f32 v17, v17, v39
    v_mfma_f32_16x16x32_bf16 v[248:251], a[212:215], v[116:119], v[248:251]
    ds_read_b128 a[180:183], v2 offset:20736
    v_cvt_pk_bf16_f32 v93, v38, v39
    v_mfma_f32_16x16x32_bf16 a[56:59], a[208:211], v[120:123], a[56:59]
    v_fma_f32 v40, v40, s29, v24
    v_fma_f32 v41, v41, s29, v24
    v_mfma_f32_16x16x32_bf16 a[56:59], a[212:215], v[124:127], a[56:59]
    s_add_u32 m0, s28, 73728
    ds_read_b128 a[184:187], v2 offset:20992
    v_mfma_f32_16x16x32_bf16 v[188:191], a[216:219], v[104:107], v[188:191]
    buffer_load_dwordx4 v14, s[20:23], s31 offen nt lds
    v_mfma_f32_16x16x32_bf16 v[188:191], a[220:223], v[108:111], v[188:191]
    ds_read_b128 a[188:191], v2 offset:21248
    v_fma_f32 v42, v42, s29, v24
    v_mfma_f32_16x16x32_bf16 v[252:255], a[216:219], v[112:115], v[252:255]
    v_exp_f32 v40, v40
    v_mfma_f32_16x16x32_bf16 v[252:255], a[220:223], v[116:119], v[252:255]
    ds_read_b64_tr_b16 a[192:193], v4 offset:16384
    v_fma_f32 v43, v43, s29, v24
    v_mfma_f32_16x16x32_bf16 a[60:63], a[216:219], v[120:123], a[60:63]
    v_exp_f32 v41, v41
    v_mfma_f32_16x16x32_bf16 a[60:63], a[220:223], v[124:127], a[60:63]
    s_add_u32 m0, s28, 77824
    ds_read_b64_tr_b16 a[194:195], v4 offset:20480
    v_mfma_f32_16x16x32_bf16 v[32:35], a[160:163], a[64:67], 0
    buffer_load_dwordx4 v15, s[20:23], s31 offen nt lds
    v_mfma_f32_16x16x32_bf16 v[32:35], a[164:167], a[68:71], v[32:35]
    s_waitcnt lgkmcnt(2)
    ds_read_b64_tr_b16 a[196:197], v4 offset:24576
    v_add_f32 v18, v18, v40
    v_mfma_f32_16x16x32_bf16 v[32:35], a[168:171], a[72:75], v[32:35]
    v_exp_f32 v42, v42
    v_mfma_f32_16x16x32_bf16 v[32:35], a[172:175], a[76:79], v[32:35]
    ds_read_b64_tr_b16 a[198:199], v4 offset:28672
    v_add_f32 v18, v18, v41
    v_mfma_f32_16x16x32_bf16 v[32:35], a[176:179], a[80:83], v[32:35]
    s_mov_b32 s30, 229376
    v_exp_f32 v43, v43
    v_mfma_f32_16x16x32_bf16 v[32:35], a[180:183], a[84:87], v[32:35]
    s_add_u32 m0, s28, 147456
    ds_read_b64_tr_b16 a[200:201], v7 offset:16384
    v_mfma_f32_16x16x32_bf16 v[32:35], a[184:187], a[88:91], v[32:35]
    buffer_load_dwordx4 v10, s[16:19], s30 offen nt lds
    v_mfma_f32_16x16x32_bf16 v[32:35], a[188:191], a[92:95], v[32:35]
    s_waitcnt lgkmcnt(2)
    ds_read_b64_tr_b16 a[202:203], v7 offset:20480
    v_cvt_pk_bf16_f32 v100, v40, v41
    v_mfma_f32_16x16x32_bf16 v[128:131], a[192:195], v[56:59], v[128:131]
    s_waitcnt lgkmcnt(2)
    v_add_f32 v18, v18, v42
    v_add_f32 v18, v18, v43
    v_mfma_f32_16x16x32_bf16 v[128:131], a[196:199], v[60:63], v[128:131]
    ds_read_b64_tr_b16 a[204:205], v7 offset:24576
    v_cvt_pk_bf16_f32 v101, v42, v43
    v_mfma_f32_16x16x32_bf16 v[192:195], a[192:195], v[64:67], v[192:195]
    v_fma_f32 v44, v44, s29, v20
    v_fma_f32 v45, v45, s29, v20
    v_mfma_f32_16x16x32_bf16 v[192:195], a[196:199], v[68:71], v[192:195]
    s_add_u32 m0, s28, 151296
    ds_read_b64_tr_b16 a[206:207], v7 offset:28672
    v_mfma_f32_16x16x32_bf16 a[0:3], a[192:195], v[72:75], a[0:3]
    buffer_load_dwordx4 v10, s[16:19], s30 offen offset:256 nt lds
    v_mfma_f32_16x16x32_bf16 a[0:3], a[196:199], v[76:79], a[0:3]
    ds_read_b64_tr_b16 a[208:209], v4 offset:16640
    v_fma_f32 v46, v46, s29, v20
    v_mfma_f32_16x16x32_bf16 v[36:39], a[160:163], a[96:99], 0
    v_exp_f32 v44, v44
    v_mfma_f32_16x16x32_bf16 v[36:39], a[164:167], a[100:103], v[36:39]
    ds_read_b64_tr_b16 a[210:211], v4 offset:20736
    v_fma_f32 v47, v47, s29, v20
    v_mfma_f32_16x16x32_bf16 v[36:39], a[168:171], a[104:107], v[36:39]
    v_exp_f32 v45, v45
    v_mfma_f32_16x16x32_bf16 v[36:39], a[172:175], a[108:111], v[36:39]
    s_add_u32 m0, s28, 155648
    ds_read_b64_tr_b16 a[212:213], v4 offset:24832
    v_mfma_f32_16x16x32_bf16 v[36:39], a[176:179], a[112:115], v[36:39]
    buffer_load_dwordx4 v11, s[16:19], s30 offen nt lds
    v_mfma_f32_16x16x32_bf16 v[36:39], a[180:183], a[116:119], v[36:39]
    ds_read_b64_tr_b16 a[214:215], v4 offset:28928
    v_add_f32 v16, v16, v44
    v_mfma_f32_16x16x32_bf16 v[36:39], a[184:187], a[120:123], v[36:39]
    v_exp_f32 v46, v46
    v_mfma_f32_16x16x32_bf16 v[36:39], a[188:191], a[124:127], v[36:39]
    s_waitcnt lgkmcnt(2)
    ds_read_b64_tr_b16 a[216:217], v7 offset:16640
    v_add_f32 v16, v16, v45
    v_mfma_f32_16x16x32_bf16 v[132:135], a[200:203], v[56:59], v[132:135]
    v_exp_f32 v47, v47
    v_mfma_f32_16x16x32_bf16 v[132:135], a[204:207], v[60:63], v[132:135]
    s_add_u32 m0, s28, 159488
    ds_read_b64_tr_b16 a[218:219], v7 offset:20736
    v_mfma_f32_16x16x32_bf16 v[196:199], a[200:203], v[64:67], v[196:199]
    buffer_load_dwordx4 v11, s[16:19], s30 offen offset:256 nt lds
    v_mfma_f32_16x16x32_bf16 v[196:199], a[204:207], v[68:71], v[196:199]
    ds_read_b64_tr_b16 a[220:221], v7 offset:24832
    v_cvt_pk_bf16_f32 v86, v44, v45
    v_mfma_f32_16x16x32_bf16 a[4:7], a[200:203], v[72:75], a[4:7]
    v_add_f32 v16, v16, v46
    v_add_f32 v16, v16, v47
    v_mfma_f32_16x16x32_bf16 a[4:7], a[204:207], v[76:79], a[4:7]
    ds_read_b64_tr_b16 a[222:223], v7 offset:28928
    v_cvt_pk_bf16_f32 v87, v46, v47
    v_mfma_f32_16x16x32_bf16 v[40:43], a[160:163], a[128:131], 0
    v_fma_f32 v48, v48, s29, v22
    v_fma_f32 v49, v49, s29, v22
    v_mfma_f32_16x16x32_bf16 v[40:43], a[164:167], a[132:135], v[40:43]
    ds_read_b128 a[160:163], v2 offset:24576
    v_fma_f32 v50, v50, s29, v22
    v_mfma_f32_16x16x32_bf16 v[40:43], a[168:171], a[136:139], v[40:43]
    v_exp_f32 v48, v48
    v_mfma_f32_16x16x32_bf16 v[40:43], a[172:175], a[140:143], v[40:43]
    ds_read_b128 a[164:167], v2 offset:24832
    v_fma_f32 v51, v51, s29, v22
    v_mfma_f32_16x16x32_bf16 v[40:43], a[176:179], a[144:147], v[40:43]
    v_exp_f32 v49, v49
    v_mfma_f32_16x16x32_bf16 v[40:43], a[180:183], a[148:151], v[40:43]
    ds_read_b128 a[168:171], v2 offset:25088
    v_add_f32 v17, v17, v48
    v_mfma_f32_16x16x32_bf16 v[40:43], a[184:187], a[152:155], v[40:43]
    v_exp_f32 v50, v50
    v_mfma_f32_16x16x32_bf16 v[40:43], a[188:191], a[156:159], v[40:43]
    ds_read_b128 a[172:175], v2 offset:25344
    v_add_f32 v17, v17, v49
    v_mfma_f32_16x16x32_bf16 v[136:139], a[208:211], v[56:59], v[136:139]
    s_waitcnt lgkmcnt(2)
    v_exp_f32 v51, v51
    v_mfma_f32_16x16x32_bf16 v[136:139], a[212:215], v[60:63], v[136:139]
    ds_read_b128 a[176:179], v2 offset:28672
    v_cvt_pk_bf16_f32 v94, v48, v49
    v_mfma_f32_16x16x32_bf16 v[200:203], a[208:211], v[64:67], v[200:203]
    v_add_f32 v17, v17, v50
    v_add_f32 v17, v17, v51
    v_mfma_f32_16x16x32_bf16 v[200:203], a[212:215], v[68:71], v[200:203]
    ds_read_b128 a[180:183], v2 offset:28928
    v_cvt_pk_bf16_f32 v95, v50, v51
    v_mfma_f32_16x16x32_bf16 a[8:11], a[208:211], v[72:75], a[8:11]
    v_fma_f32 v52, v52, s29, v24
    v_fma_f32 v53, v53, s29, v24
    v_mfma_f32_16x16x32_bf16 a[8:11], a[212:215], v[76:79], a[8:11]
    ds_read_b128 a[184:187], v2 offset:29184
    v_fma_f32 v54, v54, s29, v24
    v_mfma_f32_16x16x32_bf16 v[140:143], a[216:219], v[56:59], v[140:143]
    v_exp_f32 v52, v52
    v_mfma_f32_16x16x32_bf16 v[140:143], a[220:223], v[60:63], v[140:143]
    ds_read_b128 a[188:191], v2 offset:29440
    v_fma_f32 v55, v55, s29, v24
    v_mfma_f32_16x16x32_bf16 v[204:207], a[216:219], v[64:67], v[204:207]
    v_exp_f32 v53, v53
    v_mfma_f32_16x16x32_bf16 v[204:207], a[220:223], v[68:71], v[204:207]
    ds_read_b64_tr_b16 a[192:193], v4 offset:16896
    v_add_f32 v18, v18, v52
    v_mfma_f32_16x16x32_bf16 a[12:15], a[216:219], v[72:75], a[12:15]
    v_exp_f32 v54, v54
    v_mfma_f32_16x16x32_bf16 a[12:15], a[220:223], v[76:79], a[12:15]
    ds_read_b64_tr_b16 a[194:195], v4 offset:20992
    v_add_f32 v18, v18, v53
    v_mfma_f32_16x16x32_bf16 v[44:47], a[160:163], a[64:67], 0
    v_exp_f32 v55, v55
    v_mfma_f32_16x16x32_bf16 v[44:47], a[164:167], a[68:71], v[44:47]
    s_waitcnt lgkmcnt(2)
    ds_read_b64_tr_b16 a[196:197], v4 offset:25088
    v_cvt_pk_bf16_f32 v102, v52, v53
    v_mfma_f32_16x16x32_bf16 v[44:47], a[168:171], a[72:75], v[44:47]
    v_add_f32 v18, v18, v54
    v_add_f32 v18, v18, v55
    v_mfma_f32_16x16x32_bf16 v[44:47], a[172:175], a[76:79], v[44:47]
    ds_read_b64_tr_b16 a[198:199], v4 offset:29184
    v_cvt_pk_bf16_f32 v103, v54, v55
    v_mfma_f32_16x16x32_bf16 v[44:47], a[176:179], a[80:83], v[44:47]
    v_fma_f32 v32, v32, s29, v20
    v_fma_f32 v33, v33, s29, v20
    v_mfma_f32_16x16x32_bf16 v[44:47], a[180:183], a[84:87], v[44:47]
    ds_read_b64_tr_b16 a[200:201], v7 offset:16896
    v_fma_f32 v34, v34, s29, v20
    v_mfma_f32_16x16x32_bf16 v[44:47], a[184:187], a[88:91], v[44:47]
    v_exp_f32 v32, v32
    v_mfma_f32_16x16x32_bf16 v[44:47], a[188:191], a[92:95], v[44:47]
    s_waitcnt lgkmcnt(2)
    ds_read_b64_tr_b16 a[202:203], v7 offset:20992
    v_fma_f32 v35, v35, s29, v20
    v_mfma_f32_16x16x32_bf16 v[144:147], a[192:195], v[56:59], v[144:147]
    s_waitcnt lgkmcnt(2)
    v_exp_f32 v33, v33
    v_mfma_f32_16x16x32_bf16 v[144:147], a[196:199], v[60:63], v[144:147]
    ds_read_b64_tr_b16 a[204:205], v7 offset:25088
    v_add_f32 v16, v16, v32
    v_mfma_f32_16x16x32_bf16 v[208:211], a[192:195], v[64:67], v[208:211]
    v_exp_f32 v34, v34
    v_mfma_f32_16x16x32_bf16 v[208:211], a[196:199], v[68:71], v[208:211]
    ds_read_b64_tr_b16 a[206:207], v7 offset:29184
    v_add_f32 v16, v16, v33
    v_mfma_f32_16x16x32_bf16 a[16:19], a[192:195], v[72:75], a[16:19]
    v_exp_f32 v35, v35
    v_mfma_f32_16x16x32_bf16 a[16:19], a[196:199], v[76:79], a[16:19]
    ds_read_b64_tr_b16 a[208:209], v4 offset:17152
    v_cvt_pk_bf16_f32 v104, v32, v33
    v_mfma_f32_16x16x32_bf16 v[48:51], a[160:163], a[96:99], 0
    v_add_f32 v16, v16, v34
    v_add_f32 v16, v16, v35
    v_mfma_f32_16x16x32_bf16 v[48:51], a[164:167], a[100:103], v[48:51]
    ds_read_b64_tr_b16 a[210:211], v4 offset:21248
    v_cvt_pk_bf16_f32 v105, v34, v35
    v_mfma_f32_16x16x32_bf16 v[48:51], a[168:171], a[104:107], v[48:51]
    v_fma_f32 v36, v36, s29, v22
    v_fma_f32 v37, v37, s29, v22
    v_mfma_f32_16x16x32_bf16 v[48:51], a[172:175], a[108:111], v[48:51]
    ds_read_b64_tr_b16 a[212:213], v4 offset:25344
    v_fma_f32 v38, v38, s29, v22
    v_mfma_f32_16x16x32_bf16 v[48:51], a[176:179], a[112:115], v[48:51]
    v_exp_f32 v36, v36
    v_mfma_f32_16x16x32_bf16 v[48:51], a[180:183], a[116:119], v[48:51]
    ds_read_b64_tr_b16 a[214:215], v4 offset:29440
    v_fma_f32 v39, v39, s29, v22
    v_mfma_f32_16x16x32_bf16 v[48:51], a[184:187], a[120:123], v[48:51]
    v_exp_f32 v37, v37
    v_mfma_f32_16x16x32_bf16 v[48:51], a[188:191], a[124:127], v[48:51]
    s_waitcnt lgkmcnt(2)
    ds_read_b64_tr_b16 a[216:217], v7 offset:17152
    v_add_f32 v17, v17, v36
    v_mfma_f32_16x16x32_bf16 v[148:151], a[200:203], v[56:59], v[148:151]
    v_exp_f32 v38, v38
    v_mfma_f32_16x16x32_bf16 v[148:151], a[204:207], v[60:63], v[148:151]
    ds_read_b64_tr_b16 a[218:219], v7 offset:21248
    v_add_f32 v17, v17, v37
    v_mfma_f32_16x16x32_bf16 v[212:215], a[200:203], v[64:67], v[212:215]
    v_exp_f32 v39, v39
    v_mfma_f32_16x16x32_bf16 v[212:215], a[204:207], v[68:71], v[212:215]
    ds_read_b64_tr_b16 a[220:221], v7 offset:25344
    v_cvt_pk_bf16_f32 v112, v36, v37
    v_mfma_f32_16x16x32_bf16 a[20:23], a[200:203], v[72:75], a[20:23]
    s_mov_b32 s30, 245760
    v_add_f32 v17, v17, v38
    v_add_f32 v17, v17, v39
    v_mfma_f32_16x16x32_bf16 a[20:23], a[204:207], v[76:79], a[20:23]
    s_waitcnt vmcnt(20)
    ds_read_b64_tr_b16 a[222:223], v7 offset:29440
    v_cvt_pk_bf16_f32 v113, v38, v39
    v_mfma_f32_16x16x32_bf16 v[52:55], a[160:163], a[128:131], 0
    s_barrier
    v_fma_f32 v40, v40, s29, v24
    v_fma_f32 v41, v41, s29, v24
    v_mfma_f32_16x16x32_bf16 v[52:55], a[164:167], a[132:135], v[52:55]
    s_add_u32 m0, s28, 81920
    ds_read_b128 a[160:163], v1 offset:32768
    v_mfma_f32_16x16x32_bf16 v[52:55], a[168:171], a[136:139], v[52:55]
    buffer_load_dwordx4 v10, s[16:19], s30 offen nt lds
    v_mfma_f32_16x16x32_bf16 v[52:55], a[172:175], a[140:143], v[52:55]
    ds_read_b128 a[164:167], v1 offset:33024
    v_fma_f32 v42, v42, s29, v24
    v_mfma_f32_16x16x32_bf16 v[52:55], a[176:179], a[144:147], v[52:55]
    v_exp_f32 v40, v40
    v_mfma_f32_16x16x32_bf16 v[52:55], a[180:183], a[148:151], v[52:55]
    ds_read_b128 a[168:171], v1 offset:33280
    v_fma_f32 v43, v43, s29, v24
    v_mfma_f32_16x16x32_bf16 v[52:55], a[184:187], a[152:155], v[52:55]
    v_exp_f32 v41, v41
    v_mfma_f32_16x16x32_bf16 v[52:55], a[188:191], a[156:159], v[52:55]
    s_add_u32 m0, s28, 85760
    ds_read_b128 a[172:175], v1 offset:33536
    v_mfma_f32_16x16x32_bf16 v[152:155], a[208:211], v[56:59], v[152:155]
    s_waitcnt lgkmcnt(2)
    buffer_load_dwordx4 v10, s[16:19], s30 offen offset:256 nt lds
    v_mfma_f32_16x16x32_bf16 v[152:155], a[212:215], v[60:63], v[152:155]
    ds_read_b128 a[176:179], v1 offset:36864
    v_add_f32 v18, v18, v40
    v_mfma_f32_16x16x32_bf16 v[216:219], a[208:211], v[64:67], v[216:219]
    v_exp_f32 v42, v42
    v_mfma_f32_16x16x32_bf16 v[216:219], a[212:215], v[68:71], v[216:219]
    ds_read_b128 a[180:183], v1 offset:37120
    v_add_f32 v18, v18, v41
    v_mfma_f32_16x16x32_bf16 a[24:27], a[208:211], v[72:75], a[24:27]
    v_exp_f32 v43, v43
    v_mfma_f32_16x16x32_bf16 a[24:27], a[212:215], v[76:79], a[24:27]
    s_add_u32 m0, s28, 90112
    ds_read_b128 a[184:187], v1 offset:37376
    v_mfma_f32_16x16x32_bf16 v[156:159], a[216:219], v[56:59], v[156:159]
    buffer_load_dwordx4 v11, s[16:19], s30 offen nt lds
    v_mfma_f32_16x16x32_bf16 v[156:159], a[220:223], v[60:63], v[156:159]
    ds_read_b128 a[188:191], v1 offset:37632
    v_cvt_pk_bf16_f32 v120, v40, v41
    v_mfma_f32_16x16x32_bf16 v[220:223], a[216:219], v[64:67], v[220:223]
    v_add_f32 v18, v18, v42
    v_add_f32 v18, v18, v43
    v_mfma_f32_16x16x32_bf16 v[220:223], a[220:223], v[68:71], v[220:223]
    ds_read_b64_tr_b16 a[192:193], v4 offset:49152
    v_cvt_pk_bf16_f32 v121, v42, v43
    v_mfma_f32_16x16x32_bf16 a[28:31], a[216:219], v[72:75], a[28:31]
    v_fma_f32 v44, v44, s29, v20
    v_fma_f32 v45, v45, s29, v20
    v_mfma_f32_16x16x32_bf16 a[28:31], a[220:223], v[76:79], a[28:31]
    s_add_u32 m0, s28, 93952
    ds_read_b64_tr_b16 a[194:195], v4 offset:53248
    v_mfma_f32_16x16x32_bf16 v[32:35], a[160:163], a[64:67], 0
    buffer_load_dwordx4 v11, s[16:19], s30 offen offset:256 nt lds
    v_mfma_f32_16x16x32_bf16 v[32:35], a[164:167], a[68:71], v[32:35]
    s_waitcnt lgkmcnt(2)
    ds_read_b64_tr_b16 a[196:197], v4 offset:57344
    v_fma_f32 v46, v46, s29, v20
    v_mfma_f32_16x16x32_bf16 v[32:35], a[168:171], a[72:75], v[32:35]
    v_exp_f32 v44, v44
    v_mfma_f32_16x16x32_bf16 v[32:35], a[172:175], a[76:79], v[32:35]
    ds_read_b64_tr_b16 a[198:199], v4 offset:61440
    v_fma_f32 v47, v47, s29, v20
    v_mfma_f32_16x16x32_bf16 v[32:35], a[176:179], a[80:83], v[32:35]
L_pg4:
    s_cbranch_execz L_wr4
    v_exp_f32 v45, v45
    v_mfma_f32_16x16x32_bf16 v[32:35], a[180:183], a[84:87], v[32:35]
    ds_read_b64_tr_b16 a[200:201], v7 offset:49152
    v_add_f32 v16, v16, v44
    v_mfma_f32_16x16x32_bf16 v[32:35], a[184:187], a[88:91], v[32:35]
    v_exp_f32 v46, v46
    v_mfma_f32_16x16x32_bf16 v[32:35], a[188:191], a[92:95], v[32:35]
    s_waitcnt lgkmcnt(2)
    ds_read_b64_tr_b16 a[202:203], v7 offset:53248
    v_add_f32 v16, v16, v45
    v_mfma_f32_16x16x32_bf16 v[160:163], a[192:195], v[56:59], v[160:163]
    s_waitcnt lgkmcnt(2)
    v_exp_f32 v47, v47
    v_mfma_f32_16x16x32_bf16 v[160:163], a[196:199], v[60:63], v[160:163]
    ds_read_b64_tr_b16 a[204:205], v7 offset:57344
    v_cvt_pk_bf16_f32 v106, v44, v45
    v_mfma_f32_16x16x32_bf16 v[224:227], a[192:195], v[64:67], v[224:227]
    v_add_f32 v16, v16, v46
    v_add_f32 v16, v16, v47
    v_mfma_f32_16x16x32_bf16 v[224:227], a[196:199], v[68:71], v[224:227]
    ds_read_b64_tr_b16 a[206:207], v7 offset:61440
    v_cvt_pk_bf16_f32 v107, v46, v47
    v_mfma_f32_16x16x32_bf16 a[32:35], a[192:195], v[72:75], a[32:35]
    v_fma_f32 v48, v48, s29, v22
    v_fma_f32 v49, v49, s29, v22
    v_mfma_f32_16x16x32_bf16 a[32:35], a[196:199], v[76:79], a[32:35]
    ds_read_b64_tr_b16 a[208:209], v4 offset:49408
    v_fma_f32 v50, v50, s29, v22
    v_mfma_f32_16x16x32_bf16 v[36:39], a[160:163], a[96:99], 0
    v_exp_f32 v48, v48
    v_mfma_f32_16x16x32_bf16 v[36:39], a[164:167], a[100:103], v[36:39]
    ds_read_b64_tr_b16 a[210:211], v4 offset:53504
    v_fma_f32 v51, v51, s29, v22
    v_mfma_f32_16x16x32_bf16 v[36:39], a[168:171], a[104:107], v[36:39]
    v_exp_f32 v49, v49
    v_mfma_f32_16x16x32_bf16 v[36:39], a[172:175], a[108:111], v[36:39]
    ds_read_b64_tr_b16 a[212:213], v4 offset:57600
    v_add_f32 v17, v17, v48
    v_mfma_f32_16x16x32_bf16 v[36:39], a[176:179], a[112:115], v[36:39]
    v_exp_f32 v50, v50
    v_mfma_f32_16x16x32_bf16 v[36:39], a[180:183], a[116:119], v[36:39]
    ds_read_b64_tr_b16 a[214:215], v4 offset:61696
    v_add_f32 v17, v17, v49
    v_mfma_f32_16x16x32_bf16 v[36:39], a[184:187], a[120:123], v[36:39]
    v_exp_f32 v51, v51
    v_mfma_f32_16x16x32_bf16 v[36:39], a[188:191], a[124:127], v[36:39]
    s_waitcnt lgkmcnt(2)
    ds_read_b64_tr_b16 a[216:217], v7 offset:49408
    v_cvt_pk_bf16_f32 v114, v48, v49
    v_mfma_f32_16x16x32_bf16 v[164:167], a[200:203], v[56:59], v[164:167]
    v_add_f32 v17, v17, v50
    v_add_f32 v17, v17, v51
    v_mfma_f32_16x16x32_bf16 v[164:167], a[204:207], v[60:63], v[164:167]
    ds_read_b64_tr_b16 a[218:219], v7 offset:53504
    v_cvt_pk_bf16_f32 v115, v50, v51
    v_mfma_f32_16x16x32_bf16 v[228:231], a[200:203], v[64:67], v[228:231]
    v_fma_f32 v52, v52, s29, v24
    v_fma_f32 v53, v53, s29, v24
    v_mfma_f32_16x16x32_bf16 v[228:231], a[204:207], v[68:71], v[228:231]
    ds_read_b64_tr_b16 a[220:221], v7 offset:57600
    v_fma_f32 v54, v54, s29, v24
    v_mfma_f32_16x16x32_bf16 a[36:39], a[200:203], v[72:75], a[36:39]
    v_exp_f32 v52, v52
    v_mfma_f32_16x16x32_bf16 a[36:39], a[204:207], v[76:79], a[36:39]
    ds_read_b64_tr_b16 a[222:223], v7 offset:61696
    v_fma_f32 v55, v55, s29, v24
    v_mfma_f32_16x16x32_bf16 v[40:43], a[160:163], a[128:131], 0
    v_exp_f32 v53, v53
    v_mfma_f32_16x16x32_bf16 v[40:43], a[164:167], a[132:135], v[40:43]
    ds_read_b128 a[160:163], v1 offset:40960
    v_add_f32 v18, v18, v52
    v_mfma_f32_16x16x32_bf16 v[40:43], a[168:171], a[136:139], v[40:43]
    v_exp_f32 v54, v54
    v_mfma_f32_16x16x32_bf16 v[40:43], a[172:175], a[140:143], v[40:43]
    ds_read_b128 a[164:167], v1 offset:41216
    v_add_f32 v18, v18, v53
    v_mfma_f32_16x16x32_bf16 v[40:43], a[176:179], a[144:147], v[40:43]
    v_exp_f32 v55, v55
    v_mfma_f32_16x16x32_bf16 v[40:43], a[180:183], a[148:151], v[40:43]
    ds_read_b128 a[168:171], v1 offset:41472
    v_cvt_pk_bf16_f32 v122, v52, v53
    v_mfma_f32_16x16x32_bf16 v[40:43], a[184:187], a[152:155], v[40:43]
    v_add_f32 v18, v18, v54
    v_add_f32 v18, v18, v55
    v_mfma_f32_16x16x32_bf16 v[40:43], a[188:191], a[156:159], v[40:43]
    ds_read_b128 a[172:175], v1 offset:41728
    v_cvt_pk_bf16_f32 v123, v54, v55
    v_mfma_f32_16x16x32_bf16 v[168:171], a[208:211], v[56:59], v[168:171]
    s_waitcnt lgkmcnt(2)
    v_fma_f32 v32, v32, s29, v20
    v_fma_f32 v33, v33, s29, v20
    v_mfma_f32_16x16x32_bf16 v[168:171], a[212:215], v[60:63], v[168:171]
    ds_read_b128 a[176:179], v1 offset:45056
    v_fma_f32 v34, v34, s29, v20
    v_mfma_f32_16x16x32_bf16 v[232:235], a[208:211], v[64:67], v[232:235]
    v_exp_f32 v32, v32
    v_mfma_f32_16x16x32_bf16 v[232:235], a[212:215], v[68:71], v[232:235]
    ds_read_b128 a[180:183], v1 offset:45312
    v_fma_f32 v35, v35, s29, v20
    v_mfma_f32_16x16x32_bf16 a[40:43], a[208:211], v[72:75], a[40:43]
    v_exp_f32 v33, v33
    v_mfma_f32_16x16x32_bf16 a[40:43], a[212:215], v[76:79], a[40:43]
    ds_read_b128 a[184:187], v1 offset:45568
    v_add_f32 v16, v16, v32
    v_mfma_f32_16x16x32_bf16 v[172:175], a[216:219], v[56:59], v[172:175]
    v_exp_f32 v34, v34
    v_mfma_f32_16x16x32_bf16 v[172:175], a[220:223], v[60:63], v[172:175]
    ds_read_b128 a[188:191], v1 offset:45824
    v_add_f32 v16, v16, v33
    v_mfma_f32_16x16x32_bf16 v[236:239], a[216:219], v[64:67], v[236:239]
    v_exp_f32 v35, v35
    v_mfma_f32_16x16x32_bf16 v[236:239], a[220:223], v[68:71], v[236:239]
    ds_read_b64_tr_b16 a[192:193], v4 offset:49664
    v_cvt_pk_bf16_f32 v108, v32, v33
    v_mfma_f32_16x16x32_bf16 a[44:47], a[216:219], v[72:75], a[44:47]
    v_add_f32 v16, v16, v34
    v_add_f32 v16, v16, v35
    v_mfma_f32_16x16x32_bf16 a[44:47], a[220:223], v[76:79], a[44:47]
    ds_read_b64_tr_b16 a[194:195], v4 offset:53760
    v_cvt_pk_bf16_f32 v109, v34, v35
    v_mfma_f32_16x16x32_bf16 v[44:47], a[160:163], a[64:67], 0
    v_fma_f32 v36, v36, s29, v22
    v_fma_f32 v37, v37, s29, v22
    v_mfma_f32_16x16x32_bf16 v[44:47], a[164:167], a[68:71], v[44:47]
    s_waitcnt lgkmcnt(2)
    ds_read_b64_tr_b16 a[196:197], v4 offset:57856
    v_fma_f32 v38, v38, s29, v22
    v_mfma_f32_16x16x32_bf16 v[44:47], a[168:171], a[72:75], v[44:47]
    v_exp_f32 v36, v36
    v_mfma_f32_16x16x32_bf16 v[44:47], a[172:175], a[76:79], v[44:47]
    ds_read_b64_tr_b16 a[198:199], v4 offset:61952
    v_fma_f32 v39, v39, s29, v22
    v_mfma_f32_16x16x32_bf16 v[44:47], a[176:179], a[80:83], v[44:47]
    v_exp_f32 v37, v37
    v_mfma_f32_16x16x32_bf16 v[44:47], a[180:183], a[84:87], v[44:47]
    ds_read_b64_tr_b16 a[200:201], v7 offset:49664
    v_add_f32 v17, v17, v36
    v_mfma_f32_16x16x32_bf16 v[44:47], a[184:187], a[88:91], v[44:47]
    v_exp_f32 v38, v38
    v_mfma_f32_16x16x32_bf16 v[44:47], a[188:191], a[92:95], v[44:47]
    s_waitcnt lgkmcnt(2)
    ds_read_b64_tr_b16 a[202:203], v7 offset:53760
    v_add_f32 v17, v17, v37
    v_mfma_f32_16x16x32_bf16 v[176:179], a[192:195], v[56:59], v[176:179]
    s_waitcnt lgkmcnt(2)
    v_exp_f32 v39, v39
    v_mfma_f32_16x16x32_bf16 v[176:179], a[196:199], v[60:63], v[176:179]
    ds_read_b64_tr_b16 a[204:205], v7 offset:57856
    v_cvt_pk_bf16_f32 v116, v36, v37
    v_mfma_f32_16x16x32_bf16 v[240:243], a[192:195], v[64:67], v[240:243]
    v_add_f32 v17, v17, v38
    v_add_f32 v17, v17, v39
    v_mfma_f32_16x16x32_bf16 v[240:243], a[196:199], v[68:71], v[240:243]
    ds_read_b64_tr_b16 a[206:207], v7 offset:61952
    v_cvt_pk_bf16_f32 v117, v38, v39
    v_mfma_f32_16x16x32_bf16 a[48:51], a[192:195], v[72:75], a[48:51]
    v_fma_f32 v40, v40, s29, v24
    v_fma_f32 v41, v41, s29, v24
    v_mfma_f32_16x16x32_bf16 a[48:51], a[196:199], v[76:79], a[48:51]
    ds_read_b64_tr_b16 a[208:209], v4 offset:49920
    v_fma_f32 v42, v42, s29, v24
    v_mfma_f32_16x16x32_bf16 v[48:51], a[160:163], a[96:99], 0
    v_exp_f32 v40, v40
    v_mfma_f32_16x16x32_bf16 v[48:51], a[164:167], a[100:103], v[48:51]
    ds_read_b64_tr_b16 a[210:211], v4 offset:54016
    v_fma_f32 v43, v43, s29, v24
    v_mfma_f32_16x16x32_bf16 v[48:51], a[168:171], a[104:107], v[48:51]
    v_exp_f32 v41, v41
    v_mfma_f32_16x16x32_bf16 v[48:51], a[172:175], a[108:111], v[48:51]
    ds_read_b64_tr_b16 a[212:213], v4 offset:58112
    v_add_f32 v18, v18, v40
    v_mfma_f32_16x16x32_bf16 v[48:51], a[176:179], a[112:115], v[48:51]
    v_exp_f32 v42, v42
    v_mfma_f32_16x16x32_bf16 v[48:51], a[180:183], a[116:119], v[48:51]
    ds_read_b64_tr_b16 a[214:215], v4 offset:62208
    v_add_f32 v18, v18, v41
    v_mfma_f32_16x16x32_bf16 v[48:51], a[184:187], a[120:123], v[48:51]
    v_exp_f32 v43, v43
    v_mfma_f32_16x16x32_bf16 v[48:51], a[188:191], a[124:127], v[48:51]
    s_waitcnt lgkmcnt(2)
    ds_read_b64_tr_b16 a[216:217], v7 offset:49920
    v_cvt_pk_bf16_f32 v124, v40, v41
    v_mfma_f32_16x16x32_bf16 v[180:183], a[200:203], v[56:59], v[180:183]
    v_add_f32 v18, v18, v42
    v_add_f32 v18, v18, v43
    v_mfma_f32_16x16x32_bf16 v[180:183], a[204:207], v[60:63], v[180:183]
    ds_read_b64_tr_b16 a[218:219], v7 offset:54016
    v_cvt_pk_bf16_f32 v125, v42, v43
    v_mfma_f32_16x16x32_bf16 v[244:247], a[200:203], v[64:67], v[244:247]
    v_fma_f32 v44, v44, s29, v20
    v_fma_f32 v45, v45, s29, v20
    v_mfma_f32_16x16x32_bf16 v[244:247], a[204:207], v[68:71], v[244:247]
    ds_read_b64_tr_b16 a[220:221], v7 offset:58112
    v_fma_f32 v46, v46, s29, v20
    v_mfma_f32_16x16x32_bf16 a[52:55], a[200:203], v[72:75], a[52:55]
    s_mov_b32 s31, 163840
    v_exp_f32 v44, v44
    v_mfma_f32_16x16x32_bf16 a[52:55], a[204:207], v[76:79], a[52:55]
    s_waitcnt vmcnt(16)
    ds_read_b64_tr_b16 a[222:223], v7 offset:62208
    v_fma_f32 v47, v47, s29, v20
    v_mfma_f32_16x16x32_bf16 v[52:55], a[160:163], a[128:131], 0
    s_barrier
    v_exp_f32 v45, v45
    v_mfma_f32_16x16x32_bf16 v[52:55], a[164:167], a[132:135], v[52:55]
    s_add_u32 m0, s28, 16384
    ds_read_b128 a[160:163], v2 offset:32768
    v_mfma_f32_16x16x32_bf16 v[52:55], a[168:171], a[136:139], v[52:55]
    buffer_load_dwordx4 v12, s[20:23], s31 offen nt lds
    v_mfma_f32_16x16x32_bf16 v[52:55], a[172:175], a[140:143], v[52:55]
    ds_read_b128 a[164:167], v2 offset:33024
    v_add_f32 v16, v16, v44
    v_mfma_f32_16x16x32_bf16 v[52:55], a[176:179], a[144:147], v[52:55]
    v_exp_f32 v46, v46
    v_mfma_f32_16x16x32_bf16 v[52:55], a[180:183], a[148:151], v[52:55]
    ds_read_b128 a[168:171], v2 offset:33280
    v_add_f32 v16, v16, v45
    v_mfma_f32_16x16x32_bf16 v[52:55], a[184:187], a[152:155], v[52:55]
    v_exp_f32 v47, v47
    v_mfma_f32_16x16x32_bf16 v[52:55], a[188:191], a[156:159], v[52:55]
    s_add_u32 m0, s28, 20480
    ds_read_b128 a[172:175], v2 offset:33536
    v_mfma_f32_16x16x32_bf16 v[184:187], a[208:211], v[56:59], v[184:187]
    s_waitcnt lgkmcnt(2)
    buffer_load_dwordx4 v13, s[20:23], s31 offen nt lds
    v_mfma_f32_16x16x32_bf16 v[184:187], a[212:215], v[60:63], v[184:187]
    ds_read_b128 a[176:179], v2 offset:36864
    v_cvt_pk_bf16_f32 v110, v44, v45
    v_mfma_f32_16x16x32_bf16 v[248:251], a[208:211], v[64:67], v[248:251]
    v_add_f32 v16, v16, v46
    v_add_f32 v16, v16, v47
    v_mfma_f32_16x16x32_bf16 v[248:251], a[212:215], v[68:71], v[248:251]
    ds_read_b128 a[180:183], v2 offset:37120
    v_cvt_pk_bf16_f32 v111, v46, v47
    v_mfma_f32_16x16x32_bf16 a[56:59], a[208:211], v[72:75], a[56:59]
    v_fma_f32 v48, v48, s29, v22
    v_fma_f32 v49, v49, s29, v22
    v_mfma_f32_16x16x32_bf16 a[56:59], a[212:215], v[76:79], a[56:59]
    s_add_u32 m0, s28, 24576
    ds_read_b128 a[184:187], v2 offset:37376
    v_mfma_f32_16x16x32_bf16 v[188:191], a[216:219], v[56:59], v[188:191]
    buffer_load_dwordx4 v14, s[20:23], s31 offen nt lds
    v_mfma_f32_16x16x32_bf16 v[188:191], a[220:223], v[60:63], v[188:191]
    ds_read_b128 a[188:191], v2 offset:37632
    v_fma_f32 v50, v50, s29, v22
    v_mfma_f32_16x16x32_bf16 v[252:255], a[216:219], v[64:67], v[252:255]
    v_exp_f32 v48, v48
    v_mfma_f32_16x16x32_bf16 v[252:255], a[220:223], v[68:71], v[252:255]
    ds_read_b64_tr_b16 a[192:193], v5 offset:49152
    v_fma_f32 v51, v51, s29, v22
    v_mfma_f32_16x16x32_bf16 a[60:63], a[216:219], v[72:75], a[60:63]
    v_exp_f32 v49, v49
    v_mfma_f32_16x16x32_bf16 a[60:63], a[220:223], v[76:79], a[60:63]
    s_add_u32 m0, s28, 28672
    ds_read_b64_tr_b16 a[194:195], v5 offset:53248
    v_mfma_f32_16x16x32_bf16 v[32:35], a[160:163], a[64:67], 0
    buffer_load_dwordx4 v15, s[20:23], s31 offen nt lds
    v_mfma_f32_16x16x32_bf16 v[32:35], a[164:167], a[68:71], v[32:35]
    s_waitcnt lgkmcnt(2)
    ds_read_b64_tr_b16 a[196:197], v5 offset:57344
    v_add_f32 v17, v17, v48
    v_mfma_f32_16x16x32_bf16 v[32:35], a[168:171], a[72:75], v[32:35]
    v_exp_f32 v50, v50
    v_mfma_f32_16x16x32_bf16 v[32:35], a[172:175], a[76:79], v[32:35]
    ds_read_b64_tr_b16 a[198:199], v5 offset:61440
    v_add_f32 v17, v17, v49
    v_mfma_f32_16x16x32_bf16 v[32:35], a[176:179], a[80:83], v[32:35]
    s_mov_b32 s31, 196608
    v_exp_f32 v51, v51
    v_mfma_f32_16x16x32_bf16 v[32:35], a[180:183], a[84:87], v[32:35]
    s_add_u32 m0, s28, 32768
    ds_read_b64_tr_b16 a[200:201], v8 offset:49152
    v_mfma_f32_16x16x32_bf16 v[32:35], a[184:187], a[88:91], v[32:35]
    buffer_load_dwordx4 v12, s[20:23], s31 offen nt lds
    v_mfma_f32_16x16x32_bf16 v[32:35], a[188:191], a[92:95], v[32:35]
    s_waitcnt lgkmcnt(2)
    ds_read_b64_tr_b16 a[202:203], v8 offset:53248
    v_cvt_pk_bf16_f32 v118, v48, v49
    v_mfma_f32_16x16x32_bf16 v[128:131], a[192:195], v[80:83], v[128:131]
    s_waitcnt lgkmcnt(2)
    v_add_f32 v17, v17, v50
    v_add_f32 v17, v17, v51
    v_mfma_f32_16x16x32_bf16 v[128:131], a[196:199], v[84:87], v[128:131]
    ds_read_b64_tr_b16 a[204:205], v8 offset:57344
    v_cvt_pk_bf16_f32 v119, v50, v51
    v_mfma_f32_16x16x32_bf16 v[192:195], a[192:195], v[88:91], v[192:195]
    v_fma_f32 v52, v52, s29, v24
    v_fma_f32 v53, v53, s29, v24
    v_mfma_f32_16x16x32_bf16 v[192:195], a[196:199], v[92:95], v[192:195]
    s_add_u32 m0, s28, 36864
    ds_read_b64_tr_b16 a[206:207], v8 offset:61440
    v_mfma_f32_16x16x32_bf16 a[0:3], a[192:195], v[96:99], a[0:3]
    buffer_load_dwordx4 v13, s[20:23], s31 offen nt lds
    v_mfma_f32_16x16x32_bf16 a[0:3], a[196:199], v[100:103], a[0:3]
    ds_read_b64_tr_b16 a[208:209], v5 offset:49408
    v_fma_f32 v54, v54, s29, v24
    v_mfma_f32_16x16x32_bf16 v[36:39], a[160:163], a[96:99], 0
    v_exp_f32 v52, v52
    v_mfma_f32_16x16x32_bf16 v[36:39], a[164:167], a[100:103], v[36:39]
    ds_read_b64_tr_b16 a[210:211], v5 offset:53504
    v_fma_f32 v55, v55, s29, v24
    v_mfma_f32_16x16x32_bf16 v[36:39], a[168:171], a[104:107], v[36:39]
    v_exp_f32 v53, v53
    v_mfma_f32_16x16x32_bf16 v[36:39], a[172:175], a[108:111], v[36:39]
    s_add_u32 m0, s28, 40960
    ds_read_b64_tr_b16 a[212:213], v5 offset:57600
    v_mfma_f32_16x16x32_bf16 v[36:39], a[176:179], a[112:115], v[36:39]
    buffer_load_dwordx4 v14, s[20:23], s31 offen nt lds
    v_mfma_f32_16x16x32_bf16 v[36:39], a[180:183], a[116:119], v[36:39]
    ds_read_b64_tr_b16 a[214:215], v5 offset:61696
    v_add_f32 v18, v18, v52
    v_mfma_f32_16x16x32_bf16 v[36:39], a[184:187], a[120:123], v[36:39]
    v_exp_f32 v54, v54
    v_mfma_f32_16x16x32_bf16 v[36:39], a[188:191], a[124:127], v[36:39]
    s_waitcnt lgkmcnt(2)
    ds_read_b64_tr_b16 a[216:217], v8 offset:49408
    v_add_f32 v18, v18, v53
    v_mfma_f32_16x16x32_bf16 v[132:135], a[200:203], v[80:83], v[132:135]
    v_exp_f32 v55, v55
    v_mfma_f32_16x16x32_bf16 v[132:135], a[204:207], v[84:87], v[132:135]
    s_add_u32 m0, s28, 45056
    ds_read_b64_tr_b16 a[218:219], v8 offset:53504
    v_mfma_f32_16x16x32_bf16 v[196:199], a[200:203], v[88:91], v[196:199]
    buffer_load_dwordx4 v15, s[20:23], s31 offen nt lds
    v_mfma_f32_16x16x32_bf16 v[196:199], a[204:207], v[92:95], v[196:199]
    ds_read_b64_tr_b16 a[220:221], v8 offset:57600
    v_cvt_pk_bf16_f32 v126, v52, v53
    v_mfma_f32_16x16x32_bf16 a[4:7], a[200:203], v[96:99], a[4:7]
    v_add_f32 v18, v18, v54
    v_add_f32 v18, v18, v55
    v_mfma_f32_16x16x32_bf16 a[4:7], a[204:207], v[100:103], a[4:7]
    ds_read_b64_tr_b16 a[222:223], v8 offset:61696
    v_cvt_pk_bf16_f32 v127, v54, v55
    v_mfma_f32_16x16x32_bf16 v[40:43], a[160:163], a[128:131], 0
    v_fma_f32 v32, v32, s29, v20
    v_fma_f32 v33, v33, s29, v20
    v_mfma_f32_16x16x32_bf16 v[40:43], a[164:167], a[132:135], v[40:43]
    ds_read_b128 a[160:163], v2 offset:40960
    v_fma_f32 v34, v34, s29, v20
    v_mfma_f32_16x16x32_bf16 v[40:43], a[168:171], a[136:139], v[40:43]
    v_exp_f32 v32, v32
    v_mfma_f32_16x16x32_bf16 v[40:43], a[172:175], a[140:143], v[40:43]
    ds_read_b128 a[164:167], v2 offset:41216
    v_fma_f32 v35, v35, s29, v20
    v_mfma_f32_16x16x32_bf16 v[40:43], a[176:179], a[144:147], v[40:43]
    v_exp_f32 v33, v33
    v_mfma_f32_16x16x32_bf16 v[40:43], a[180:183], a[148:151], v[40:43]
    ds_read_b128 a[168:171], v2 offset:41472
    v_add_f32 v16, v16, v32
    v_mfma_f32_16x16x32_bf16 v[40:43], a[184:187], a[152:155], v[40:43]
    v_exp_f32 v34, v34
    v_mfma_f32_16x16x32_bf16 v[40:43], a[188:191], a[156:159], v[40:43]
    ds_read_b128 a[172:175], v2 offset:41728
    v_add_f32 v16, v16, v33
    v_mfma_f32_16x16x32_bf16 v[136:139], a[208:211], v[80:83], v[136:139]
    s_waitcnt lgkmcnt(2)
    v_exp_f32 v35, v35
    v_mfma_f32_16x16x32_bf16 v[136:139], a[212:215], v[84:87], v[136:139]
    ds_read_b128 a[176:179], v2 offset:45056
    v_cvt_pk_bf16_f32 v56, v32, v33
    v_mfma_f32_16x16x32_bf16 v[200:203], a[208:211], v[88:91], v[200:203]
    v_add_f32 v16, v16, v34
    v_add_f32 v16, v16, v35
    v_mfma_f32_16x16x32_bf16 v[200:203], a[212:215], v[92:95], v[200:203]
    ds_read_b128 a[180:183], v2 offset:45312
    v_cvt_pk_bf16_f32 v57, v34, v35
    v_mfma_f32_16x16x32_bf16 a[8:11], a[208:211], v[96:99], a[8:11]
    v_fma_f32 v36, v36, s29, v22
    v_fma_f32 v37, v37, s29, v22
    v_mfma_f32_16x16x32_bf16 a[8:11], a[212:215], v[100:103], a[8:11]
    ds_read_b128 a[184:187], v2 offset:45568
    v_fma_f32 v38, v38, s29, v22
    v_mfma_f32_16x16x32_bf16 v[140:143], a[216:219], v[80:83], v[140:143]
    v_exp_f32 v36, v36
    v_mfma_f32_16x16x32_bf16 v[140:143], a[220:223], v[84:87], v[140:143]
    ds_read_b128 a[188:191], v2 offset:45824
    v_fma_f32 v39, v39, s29, v22
    v_mfma_f32_16x16x32_bf16 v[204:207], a[216:219], v[88:91], v[204:207]
    v_exp_f32 v37, v37
    v_mfma_f32_16x16x32_bf16 v[204:207], a[220:223], v[92:95], v[204:207]
    ds_read_b64_tr_b16 a[192:193], v5 offset:49664
    v_add_f32 v17, v17, v36
    v_mfma_f32_16x16x32_bf16 a[12:15], a[216:219], v[96:99], a[12:15]
    v_exp_f32 v38, v38
    v_mfma_f32_16x16x32_bf16 a[12:15], a[220:223], v[100:103], a[12:15]
    ds_read_b64_tr_b16 a[194:195], v5 offset:53760
    v_add_f32 v17, v17, v37
    v_mfma_f32_16x16x32_bf16 v[44:47], a[160:163], a[64:67], 0
    v_exp_f32 v39, v39
    v_mfma_f32_16x16x32_bf16 v[44:47], a[164:167], a[68:71], v[44:47]
    s_waitcnt lgkmcnt(2)
    ds_read_b64_tr_b16 a[196:197], v5 offset:57856
    v_cvt_pk_bf16_f32 v64, v36, v37
    v_mfma_f32_16x16x32_bf16 v[44:47], a[168:171], a[72:75], v[44:47]
    v_add_f32 v17, v17, v38
    v_add_f32 v17, v17, v39
    v_mfma_f32_16x16x32_bf16 v[44:47], a[172:175], a[76:79], v[44:47]
    ds_read_b64_tr_b16 a[198:199], v5 offset:61952
    v_cvt_pk_bf16_f32 v65, v38, v39
    v_mfma_f32_16x16x32_bf16 v[44:47], a[176:179], a[80:83], v[44:47]
    v_fma_f32 v40, v40, s29, v24
    v_fma_f32 v41, v41, s29, v24
    v_mfma_f32_16x16x32_bf16 v[44:47], a[180:183], a[84:87], v[44:47]
    ds_read_b64_tr_b16 a[200:201], v8 offset:49664
    v_fma_f32 v42, v42, s29, v24
    v_mfma_f32_16x16x32_bf16 v[44:47], a[184:187], a[88:91], v[44:47]
    v_exp_f32 v40, v40
    v_mfma_f32_16x16x32_bf16 v[44:47], a[188:191], a[92:95], v[44:47]
    s_waitcnt lgkmcnt(2)
    ds_read_b64_tr_b16 a[202:203], v8 offset:53760
    v_fma_f32 v43, v43, s29, v24
    v_mfma_f32_16x16x32_bf16 v[144:147], a[192:195], v[80:83], v[144:147]
    s_waitcnt lgkmcnt(2)
    v_exp_f32 v41, v41
    v_mfma_f32_16x16x32_bf16 v[144:147], a[196:199], v[84:87], v[144:147]
    ds_read_b64_tr_b16 a[204:205], v8 offset:57856
    v_add_f32 v18, v18, v40
    v_mfma_f32_16x16x32_bf16 v[208:211], a[192:195], v[88:91], v[208:211]
    v_exp_f32 v42, v42
    v_mfma_f32_16x16x32_bf16 v[208:211], a[196:199], v[92:95], v[208:211]
    ds_read_b64_tr_b16 a[206:207], v8 offset:61952
    v_add_f32 v18, v18, v41
    v_mfma_f32_16x16x32_bf16 a[16:19], a[192:195], v[96:99], a[16:19]
    v_exp_f32 v43, v43
    v_mfma_f32_16x16x32_bf16 a[16:19], a[196:199], v[100:103], a[16:19]
    ds_read_b64_tr_b16 a[208:209], v5 offset:49920
    v_cvt_pk_bf16_f32 v72, v40, v41
    v_mfma_f32_16x16x32_bf16 v[48:51], a[160:163], a[96:99], 0
    v_add_f32 v18, v18, v42
    v_add_f32 v18, v18, v43
    v_mfma_f32_16x16x32_bf16 v[48:51], a[164:167], a[100:103], v[48:51]
    ds_read_b64_tr_b16 a[210:211], v5 offset:54016
    v_cvt_pk_bf16_f32 v73, v42, v43
    v_mfma_f32_16x16x32_bf16 v[48:51], a[168:171], a[104:107], v[48:51]
    v_fma_f32 v44, v44, s29, v20
    v_fma_f32 v45, v45, s29, v20
    v_mfma_f32_16x16x32_bf16 v[48:51], a[172:175], a[108:111], v[48:51]
    ds_read_b64_tr_b16 a[212:213], v5 offset:58112
    v_fma_f32 v46, v46, s29, v20
    v_mfma_f32_16x16x32_bf16 v[48:51], a[176:179], a[112:115], v[48:51]
    v_exp_f32 v44, v44
    v_mfma_f32_16x16x32_bf16 v[48:51], a[180:183], a[116:119], v[48:51]
    ds_read_b64_tr_b16 a[214:215], v5 offset:62208
    v_fma_f32 v47, v47, s29, v20
    v_mfma_f32_16x16x32_bf16 v[48:51], a[184:187], a[120:123], v[48:51]
    v_exp_f32 v45, v45
    v_mfma_f32_16x16x32_bf16 v[48:51], a[188:191], a[124:127], v[48:51]
    s_waitcnt lgkmcnt(2)
    ds_read_b64_tr_b16 a[216:217], v8 offset:49920
    v_add_f32 v16, v16, v44
    v_mfma_f32_16x16x32_bf16 v[148:151], a[200:203], v[80:83], v[148:151]
    v_exp_f32 v46, v46
    v_mfma_f32_16x16x32_bf16 v[148:151], a[204:207], v[84:87], v[148:151]
    ds_read_b64_tr_b16 a[218:219], v8 offset:54016
    v_add_f32 v16, v16, v45
    v_mfma_f32_16x16x32_bf16 v[212:215], a[200:203], v[88:91], v[212:215]
    v_exp_f32 v47, v47
    v_mfma_f32_16x16x32_bf16 v[212:215], a[204:207], v[92:95], v[212:215]
    ds_read_b64_tr_b16 a[220:221], v8 offset:58112
    v_cvt_pk_bf16_f32 v58, v44, v45
    v_mfma_f32_16x16x32_bf16 a[20:23], a[200:203], v[96:99], a[20:23]
    s_mov_b32 s31, 229376
    v_add_f32 v16, v16, v46
    v_add_f32 v16, v16, v47
    v_mfma_f32_16x16x32_bf16 a[20:23], a[204:207], v[100:103], a[20:23]
    s_waitcnt vmcnt(16)
    ds_read_b64_tr_b16 a[222:223], v8 offset:62208
    v_cvt_pk_bf16_f32 v59, v46, v47
    v_mfma_f32_16x16x32_bf16 v[52:55], a[160:163], a[128:131], 0
    s_barrier
    v_fma_f32 v48, v48, s29, v22
    v_fma_f32 v49, v49, s29, v22
    v_mfma_f32_16x16x32_bf16 v[52:55], a[164:167], a[132:135], v[52:55]
    s_add_u32 m0, s28, 49152
    ds_read_b128 a[160:163], v3 offset:0
    v_mfma_f32_16x16x32_bf16 v[52:55], a[168:171], a[136:139], v[52:55]
    buffer_load_dwordx4 v12, s[20:23], s31 offen nt lds
    v_mfma_f32_16x16x32_bf16 v[52:55], a[172:175], a[140:143], v[52:55]
    ds_read_b128 a[164:167], v3 offset:256
    v_fma_f32 v50, v50, s29, v22
    v_mfma_f32_16x16x32_bf16 v[52:55], a[176:179], a[144:147], v[52:55]
    v_exp_f32 v48, v48
    v_mfma_f32_16x16x32_bf16 v[52:55], a[180:183], a[148:151], v[52:55]
    ds_read_b128 a[168:171], v3 offset:512
    v_fma_f32 v51, v51, s29, v22
    v_mfma_f32_16x16x32_bf16 v[52:55], a[184:187], a[152:155], v[52:55]
    v_exp_f32 v49, v49
    v_mfma_f32_16x16x32_bf16 v[52:55], a[188:191], a[156:159], v[52:55]
    s_add_u32 m0, s28, 53248
    ds_read_b128 a[172:175], v3 offset:768
    v_mfma_f32_16x16x32_bf16 v[152:155], a[208:211], v[80:83], v[152:155]
    s_waitcnt lgkmcnt(2)
    buffer_load_dwordx4 v13, s[20:23], s31 offen nt lds
    v_mfma_f32_16x16x32_bf16 v[152:155], a[212:215], v[84:87], v[152:155]
    ds_read_b128 a[176:179], v3 offset:4096
    v_add_f32 v17, v17, v48
    v_mfma_f32_16x16x32_bf16 v[216:219], a[208:211], v[88:91], v[216:219]
    v_exp_f32 v50, v50
    v_mfma_f32_16x16x32_bf16 v[216:219], a[212:215], v[92:95], v[216:219]
    ds_read_b128 a[180:183], v3 offset:4352
    v_add_f32 v17, v17, v49
    v_mfma_f32_16x16x32_bf16 a[24:27], a[208:211], v[96:99], a[24:27]
    v_exp_f32 v51, v51
    v_mfma_f32_16x16x32_bf16 a[24:27], a[212:215], v[100:103], a[24:27]
    s_add_u32 m0, s28, 57344
    ds_read_b128 a[184:187], v3 offset:4608
    v_mfma_f32_16x16x32_bf16 v[156:159], a[216:219], v[80:83], v[156:159]
    buffer_load_dwordx4 v14, s[20:23], s31 offen nt lds
    v_mfma_f32_16x16x32_bf16 v[156:159], a[220:223], v[84:87], v[156:159]
    ds_read_b128 a[188:191], v3 offset:4864
    v_cvt_pk_bf16_f32 v66, v48, v49
    v_mfma_f32_16x16x32_bf16 v[220:223], a[216:219], v[88:91], v[220:223]
    v_add_f32 v17, v17, v50
    v_add_f32 v17, v17, v51
    v_mfma_f32_16x16x32_bf16 v[220:223], a[220:223], v[92:95], v[220:223]
    ds_read_b64_tr_b16 a[192:193], v5 offset:0
    v_cvt_pk_bf16_f32 v67, v50, v51
    v_mfma_f32_16x16x32_bf16 a[28:31], a[216:219], v[96:99], a[28:31]
    v_fma_f32 v52, v52, s29, v24
    v_fma_f32 v53, v53, s29, v24
    v_mfma_f32_16x16x32_bf16 a[28:31], a[220:223], v[100:103], a[28:31]
    s_add_u32 m0, s28, 61440
    ds_read_b64_tr_b16 a[194:195], v5 offset:4096
    v_mfma_f32_16x16x32_bf16 v[32:35], a[160:163], a[64:67], 0
    buffer_load_dwordx4 v15, s[20:23], s31 offen nt lds
    v_mfma_f32_16x16x32_bf16 v[32:35], a[164:167], a[68:71], v[32:35]
    s_waitcnt lgkmcnt(2)
    ds_read_b64_tr_b16 a[196:197], v5 offset:8192
    v_fma_f32 v54, v54, s29, v24
    v_mfma_f32_16x16x32_bf16 v[32:35], a[168:171], a[72:75], v[32:35]
    v_exp_f32 v52, v52
    v_mfma_f32_16x16x32_bf16 v[32:35], a[172:175], a[76:79], v[32:35]
    ds_read_b64_tr_b16 a[198:199], v5 offset:12288
    v_fma_f32 v55, v55, s29, v24
    v_mfma_f32_16x16x32_bf16 v[32:35], a[176:179], a[80:83], v[32:35]
    s_mov_b32 s31, 164096
    v_exp_f32 v53, v53
    v_mfma_f32_16x16x32_bf16 v[32:35], a[180:183], a[84:87], v[32:35]
    s_add_u32 m0, s28, 98304
    ds_read_b64_tr_b16 a[200:201], v8 offset:0
    v_mfma_f32_16x16x32_bf16 v[32:35], a[184:187], a[88:91], v[32:35]
    buffer_load_dwordx4 v12, s[20:23], s31 offen nt lds
    v_mfma_f32_16x16x32_bf16 v[32:35], a[188:191], a[92:95], v[32:35]
    s_waitcnt lgkmcnt(2)
    ds_read_b64_tr_b16 a[202:203], v8 offset:4096
    v_add_f32 v18, v18, v52
    v_mfma_f32_16x16x32_bf16 v[160:163], a[192:195], v[80:83], v[160:163]
    s_waitcnt lgkmcnt(2)
    v_exp_f32 v54, v54
    v_mfma_f32_16x16x32_bf16 v[160:163], a[196:199], v[84:87], v[160:163]
    ds_read_b64_tr_b16 a[204:205], v8 offset:8192
    v_add_f32 v18, v18, v53
    v_mfma_f32_16x16x32_bf16 v[224:227], a[192:195], v[88:91], v[224:227]
    v_exp_f32 v55, v55
    v_mfma_f32_16x16x32_bf16 v[224:227], a[196:199], v[92:95], v[224:227]
    s_add_u32 m0, s28, 102400
    ds_read_b64_tr_b16 a[206:207], v8 offset:12288
    v_mfma_f32_16x16x32_bf16 a[32:35], a[192:195], v[96:99], a[32:35]
    buffer_load_dwordx4 v13, s[20:23], s31 offen nt lds
    v_mfma_f32_16x16x32_bf16 a[32:35], a[196:199], v[100:103], a[32:35]
    ds_read_b64_tr_b16 a[208:209], v5 offset:256
    v_cvt_pk_bf16_f32 v74, v52, v53
    v_mfma_f32_16x16x32_bf16 v[36:39], a[160:163], a[96:99], 0
    v_add_f32 v18, v18, v54
    v_add_f32 v18, v18, v55
    v_mfma_f32_16x16x32_bf16 v[36:39], a[164:167], a[100:103], v[36:39]
    ds_read_b64_tr_b16 a[210:211], v5 offset:4352
    v_cvt_pk_bf16_f32 v75, v54, v55
    v_mfma_f32_16x16x32_bf16 v[36:39], a[168:171], a[104:107], v[36:39]
    v_fma_f32 v32, v32, s29, v20
    v_fma_f32 v33, v33, s29, v20
    v_mfma_f32_16x16x32_bf16 v[36:39], a[172:175], a[108:111], v[36:39]
    s_add_u32 m0, s28, 106496
    ds_read_b64_tr_b16 a[212:213], v5 offset:8448
    v_mfma_f32_16x16x32_bf16 v[36:39], a[176:179], a[112:115], v[36:39]
    buffer_load_dwordx4 v14, s[20:23], s31 offen nt lds
    v_mfma_f32_16x16x32_bf16 v[36:39], a[180:183], a[116:119], v[36:39]
    ds_read_b64_tr_b16 a[214:215], v5 offset:12544
    v_fma_f32 v34, v34, s29, v20
    v_mfma_f32_16x16x32_bf16 v[36:39], a[184:187], a[120:123], v[36:39]
    v_exp_f32 v32, v32
    v_mfma_f32_16x16x32_bf16 v[36:39], a[188:191], a[124:127], v[36:39]
    s_waitcnt lgkmcnt(2)
    ds_read_b64_tr_b16 a[216:217], v8 offset:256
    v_fma_f32 v35, v35, s29, v20
    v_mfma_f32_16x16x32_bf16 v[164:167], a[200:203], v[80:83], v[164:167]
L_pg5:
    s_cbranch_execz L_wr5
    v_exp_f32 v33, v33
    v_mfma_f32_16x16x32_bf16 v[164:167], a[204:207], v[84:87], v[164:167]
    s_add_u32 m0, s28, 110592
    ds_read_b64_tr_b16 a[218:219], v8 offset:4352
    v_mfma_f32_16x16x32_bf16 v[228:231], a[200:203], v[88:91], v[228:231]
    buffer_load_dwordx4 v15, s[20:23], s31 offen nt lds
    v_mfma_f32_16x16x32_bf16 v[228:231], a[204:207], v[92:95], v[228:231]
    ds_read_b64_tr_b16 a[220:221], v8 offset:8448
    v_add_f32 v16, v16, v32
    v_mfma_f32_16x16x32_bf16 a[36:39], a[200:203], v[96:99], a[36:39]
    v_exp_f32 v34, v34
    v_mfma_f32_16x16x32_bf16 a[36:39], a[204:207], v[100:103], a[36:39]
    ds_read_b64_tr_b16 a[222:223], v8 offset:12544
    v_add_f32 v16, v16, v33
    v_mfma_f32_16x16x32_bf16 v[40:43], a[160:163], a[128:131], 0
    v_exp_f32 v35, v35
    v_mfma_f32_16x16x32_bf16 v[40:43], a[164:167], a[132:135], v[40:43]
    ds_read_b128 a[160:163], v3 offset:8192
    v_cvt_pk_bf16_f32 v60, v32, v33
    v_mfma_f32_16x16x32_bf16 v[40:43], a[168:171], a[136:139], v[40:43]
    v_add_f32 v16, v16, v34
    v_add_f32 v16, v16, v35
    v_mfma_f32_16x16x32_bf16 v[40:43], a[172:175], a[140:143], v[40:43]
    ds_read_b128 a[164:167], v3 offset:8448
    v_cvt_pk_bf16_f32 v61, v34, v35
    v_mfma_f32_16x16x32_bf16 v[40:43], a[176:179], a[144:147], v[40:43]
    v_fma_f32 v36, v36, s29, v22
    v_fma_f32 v37, v37, s29, v22
    v_mfma_f32_16x16x32_bf16 v[40:43], a[180:183], a[148:151], v[40:43]
    ds_read_b128 a[168:171], v3 offset:8704
    v_fma_f32 v38, v38, s29, v22
    v_mfma_f32_16x16x32_bf16 v[40:43], a[184:187], a[152:155], v[40:43]
    v_exp_f32 v36, v36
    v_mfma_f32_16x16x32_bf16 v[40:43], a[188:191], a[156:159], v[40:43]
    ds_read_b128 a[172:175], v3 offset:8960
    v_fma_f32 v39, v39, s29, v22
    v_mfma_f32_16x16x32_bf16 v[168:171], a[208:211], v[80:83], v[168:171]
    s_waitcnt lgkmcnt(2)
    v_exp_f32 v37, v37
    v_mfma_f32_16x16x32_bf16 v[168:171], a[212:215], v[84:87], v[168:171]
    ds_read_b128 a[176:179], v3 offset:12288
    v_add_f32 v17, v17, v36
    v_mfma_f32_16x16x32_bf16 v[232:235], a[208:211], v[88:91], v[232:235]
    v_exp_f32 v38, v38
    v_mfma_f32_16x16x32_bf16 v[232:235], a[212:215], v[92:95], v[232:235]
    ds_read_b128 a[180:183], v3 offset:12544
    v_add_f32 v17, v17, v37
    v_mfma_f32_16x16x32_bf16 a[40:43], a[208:211], v[96:99], a[40:43]
    v_exp_f32 v39, v39
    v_mfma_f32_16x16x32_bf16 a[40:43], a[212:215], v[100:103], a[40:43]
    ds_read_b128 a[184:187], v3 offset:12800
    v_cvt_pk_bf16_f32 v68, v36, v37
    v_mfma_f32_16x16x32_bf16 v[172:175], a[216:219], v[80:83], v[172:175]
    v_add_f32 v17, v17, v38
    v_add_f32 v17, v17, v39
    v_mfma_f32_16x16x32_bf16 v[172:175], a[220:223], v[84:87], v[172:175]
    ds_read_b128 a[188:191], v3 offset:13056
    v_cvt_pk_bf16_f32 v69, v38, v39
    v_mfma_f32_16x16x32_bf16 v[236:239], a[216:219], v[88:91], v[236:239]
    v_fma_f32 v40, v40, s29, v24
    v_fma_f32 v41, v41, s29, v24
    v_mfma_f32_16x16x32_bf16 v[236:239], a[220:223], v[92:95], v[236:239]
    ds_read_b64_tr_b16 a[192:193], v5 offset:512
    v_fma_f32 v42, v42, s29, v24
    v_mfma_f32_16x16x32_bf16 a[44:47], a[216:219], v[96:99], a[44:47]
    v_exp_f32 v40, v40
    v_mfma_f32_16x16x32_bf16 a[44:47], a[220:223], v[100:103], a[44:47]
    ds_read_b64_tr_b16 a[194:195], v5 offset:4608
    v_fma_f32 v43, v43, s29, v24
    v_mfma_f32_16x16x32_bf16 v[44:47], a[160:163], a[64:67], 0
    v_exp_f32 v41, v41
    v_mfma_f32_16x16x32_bf16 v[44:47], a[164:167], a[68:71], v[44:47]
    s_waitcnt lgkmcnt(2)
    ds_read_b64_tr_b16 a[196:197], v5 offset:8704
    v_add_f32 v18, v18, v40
    v_mfma_f32_16x16x32_bf16 v[44:47], a[168:171], a[72:75], v[44:47]
    v_exp_f32 v42, v42
    v_mfma_f32_16x16x32_bf16 v[44:47], a[172:175], a[76:79], v[44:47]
    ds_read_b64_tr_b16 a[198:199], v5 offset:12800
    v_add_f32 v18, v18, v41
    v_mfma_f32_16x16x32_bf16 v[44:47], a[176:179], a[80:83], v[44:47]
    v_exp_f32 v43, v43
    v_mfma_f32_16x16x32_bf16 v[44:47], a[180:183], a[84:87], v[44:47]
    v_cvt_pk_bf16_f32 v76, v40, v41
    v_add_f32 v18, v18, v42
    v_mfma_f32_16x16x32_bf16 v[44:47], a[184:187], a[88:91], v[44:47]
    v_add_f32 v18, v18, v43
    v_cvt_pk_bf16_f32 v77, v42, v43
    v_mfma_f32_16x16x32_bf16 v[44:47], a[188:191], a[92:95], v[44:47]
    s_waitcnt lgkmcnt(1)
    v_mfma_f32_16x16x32_bf16 v[176:179], a[192:195], v[80:83], v[176:179]
    s_waitcnt lgkmcnt(0)
    v_mfma_f32_16x16x32_bf16 v[176:179], a[196:199], v[84:87], v[176:179]
    v_mfma_f32_16x16x32_bf16 v[240:243], a[192:195], v[88:91], v[240:243]
    v_mfma_f32_16x16x32_bf16 v[240:243], a[196:199], v[92:95], v[240:243]
    ds_read_b64_tr_b16 a[200:201], v8 offset:512
    s_nop 0
    v_fma_f32 v44, v44, s29, v20
    v_mfma_f32_16x16x32_bf16 a[48:51], a[192:195], v[96:99], a[48:51]
    v_exp_f32 v44, v44
    v_mfma_f32_16x16x32_bf16 a[48:51], a[196:199], v[100:103], a[48:51]
    ds_read_b64_tr_b16 a[202:203], v8 offset:4608
    v_fma_f32 v45, v45, s29, v20
    v_mfma_f32_16x16x32_bf16 v[48:51], a[160:163], a[96:99], 0
    v_exp_f32 v45, v45
    v_mfma_f32_16x16x32_bf16 v[48:51], a[164:167], a[100:103], v[48:51]
    ds_read_b64_tr_b16 a[204:205], v8 offset:8704
    v_fma_f32 v46, v46, s29, v20
    v_mfma_f32_16x16x32_bf16 v[48:51], a[168:171], a[104:107], v[48:51]
    v_exp_f32 v46, v46
    v_mfma_f32_16x16x32_bf16 v[48:51], a[172:175], a[108:111], v[48:51]
    ds_read_b64_tr_b16 a[206:207], v8 offset:12800
    v_fma_f32 v47, v47, s29, v20
    v_mfma_f32_16x16x32_bf16 v[48:51], a[176:179], a[112:115], v[48:51]
    v_exp_f32 v47, v47
    v_mfma_f32_16x16x32_bf16 v[48:51], a[180:183], a[116:119], v[48:51]
    ds_read_b64_tr_b16 a[208:209], v5 offset:768
    v_add_f32 v16, v16, v44
    v_mfma_f32_16x16x32_bf16 v[48:51], a[184:187], a[120:123], v[48:51]
    v_add_f32 v16, v16, v45
    v_cvt_pk_bf16_f32 v62, v44, v45
    v_mfma_f32_16x16x32_bf16 v[48:51], a[188:191], a[124:127], v[48:51]
    s_waitcnt lgkmcnt(2)
    ds_read_b64_tr_b16 a[210:211], v5 offset:4864
    v_add_f32 v16, v16, v46
    v_mfma_f32_16x16x32_bf16 v[180:183], a[200:203], v[80:83], v[180:183]
    s_waitcnt lgkmcnt(2)
    v_add_f32 v16, v16, v47
    v_cvt_pk_bf16_f32 v63, v46, v47
    v_mfma_f32_16x16x32_bf16 v[180:183], a[204:207], v[84:87], v[180:183]
    ds_read_b64_tr_b16 a[212:213], v5 offset:8960
    v_mfma_f32_16x16x32_bf16 v[244:247], a[200:203], v[88:91], v[244:247]
    v_mfma_f32_16x16x32_bf16 v[244:247], a[204:207], v[92:95], v[244:247]
    ds_read_b64_tr_b16 a[214:215], v5 offset:13056
    v_fma_f32 v48, v48, s29, v22
    v_mfma_f32_16x16x32_bf16 a[52:55], a[200:203], v[96:99], a[52:55]
    v_exp_f32 v48, v48
    v_mfma_f32_16x16x32_bf16 a[52:55], a[204:207], v[100:103], a[52:55]
    ds_read_b64_tr_b16 a[216:217], v8 offset:768
    v_fma_f32 v49, v49, s29, v22
    v_mfma_f32_16x16x32_bf16 v[52:55], a[160:163], a[128:131], 0
    v_exp_f32 v49, v49
    v_mfma_f32_16x16x32_bf16 v[52:55], a[164:167], a[132:135], v[52:55]
    ds_read_b64_tr_b16 a[218:219], v8 offset:4864
    v_fma_f32 v50, v50, s29, v22
    v_mfma_f32_16x16x32_bf16 v[52:55], a[168:171], a[136:139], v[52:55]
    v_exp_f32 v50, v50
    v_mfma_f32_16x16x32_bf16 v[52:55], a[172:175], a[140:143], v[52:55]
    ds_read_b64_tr_b16 a[220:221], v8 offset:8960
    v_fma_f32 v51, v51, s29, v22
    v_mfma_f32_16x16x32_bf16 v[52:55], a[176:179], a[144:147], v[52:55]
    s_mov_b32 s31, 196864
    v_exp_f32 v51, v51
    v_mfma_f32_16x16x32_bf16 v[52:55], a[180:183], a[148:151], v[52:55]
    s_waitcnt vmcnt(20)
    ds_read_b64_tr_b16 a[222:223], v8 offset:13056
    v_add_f32 v17, v17, v48
    v_mfma_f32_16x16x32_bf16 v[52:55], a[184:187], a[152:155], v[52:55]
    s_barrier
    v_add_f32 v17, v17, v49
    v_cvt_pk_bf16_f32 v70, v48, v49
    v_mfma_f32_16x16x32_bf16 v[52:55], a[188:191], a[156:159], v[52:55]
    s_waitcnt lgkmcnt(2)
    s_add_u32 m0, s28, 114688
    ds_read_b128 a[224:227], v3 offset:16384
    v_mfma_f32_16x16x32_bf16 v[184:187], a[208:211], v[80:83], v[184:187]
    buffer_load_dwordx4 v12, s[20:23], s31 offen nt lds
    v_mfma_f32_16x16x32_bf16 v[184:187], a[212:215], v[84:87], v[184:187]
    ds_read_b128 a[228:231], v3 offset:16640
    v_add_f32 v17, v17, v50
    v_mfma_f32_16x16x32_bf16 v[248:251], a[208:211], v[88:91], v[248:251]
    v_add_f32 v17, v17, v51
    v_cvt_pk_bf16_f32 v71, v50, v51
    v_mfma_f32_16x16x32_bf16 v[248:251], a[212:215], v[92:95], v[248:251]
    ds_read_b128 a[232:235], v3 offset:16896
    v_fma_f32 v52, v52, s29, v24
    v_mfma_f32_16x16x32_bf16 a[56:59], a[208:211], v[96:99], a[56:59]
    v_exp_f32 v52, v52
    v_mfma_f32_16x16x32_bf16 a[56:59], a[212:215], v[100:103], a[56:59]
    s_add_u32 m0, s28, 118784
    ds_read_b128 a[236:239], v3 offset:17152
    v_mfma_f32_16x16x32_bf16 v[188:191], a[216:219], v[80:83], v[188:191]
    s_waitcnt lgkmcnt(2)
    buffer_load_dwordx4 v13, s[20:23], s31 offen nt lds
    v_mfma_f32_16x16x32_bf16 v[188:191], a[220:223], v[84:87], v[188:191]
    ds_read_b128 a[240:243], v3 offset:20480
    v_fma_f32 v53, v53, s29, v24
    v_mfma_f32_16x16x32_bf16 v[252:255], a[216:219], v[88:91], v[252:255]
    v_exp_f32 v53, v53
    v_mfma_f32_16x16x32_bf16 v[252:255], a[220:223], v[92:95], v[252:255]
    ds_read_b128 a[244:247], v3 offset:20736
    v_fma_f32 v54, v54, s29, v24
    v_mfma_f32_16x16x32_bf16 a[60:63], a[216:219], v[96:99], a[60:63]
    v_exp_f32 v54, v54
    v_mfma_f32_16x16x32_bf16 a[60:63], a[220:223], v[100:103], a[60:63]
    s_add_u32 m0, s28, 122880
    ds_read_b128 a[248:251], v3 offset:20992
    v_mfma_f32_16x16x32_bf16 v[32:35], a[224:227], a[64:67], 0
    buffer_load_dwordx4 v14, s[20:23], s31 offen nt lds
    v_mfma_f32_16x16x32_bf16 v[32:35], a[228:231], a[68:71], v[32:35]
    s_waitcnt lgkmcnt(2)
    ds_read_b128 a[252:255], v3 offset:21248
    v_fma_f32 v55, v55, s29, v24
    v_mfma_f32_16x16x32_bf16 v[32:35], a[232:235], a[72:75], v[32:35]
    v_exp_f32 v55, v55
    v_mfma_f32_16x16x32_bf16 v[32:35], a[236:239], a[76:79], v[32:35]
    v_add_f32 v18, v18, v52
    v_add_f32 v18, v18, v53
    v_mfma_f32_16x16x32_bf16 v[32:35], a[240:243], a[80:83], v[32:35]
    s_waitcnt lgkmcnt(1)
    v_cvt_pk_bf16_f32 v78, v52, v53
    v_add_f32 v18, v18, v54
    v_mfma_f32_16x16x32_bf16 v[32:35], a[244:247], a[84:87], v[32:35]
    s_add_u32 m0, s28, 126976
    v_add_f32 v18, v18, v55
    v_mfma_f32_16x16x32_bf16 v[32:35], a[248:251], a[88:91], v[32:35]
    s_waitcnt lgkmcnt(0)
    buffer_load_dwordx4 v15, s[20:23], s31 offen nt lds
    v_mfma_f32_16x16x32_bf16 v[32:35], a[252:255], a[92:95], v[32:35]
    v_cvt_pk_bf16_f32 v79, v54, v55
    v_mfma_f32_16x16x32_bf16 v[36:39], a[224:227], a[128:131], 0
    v_mfma_f32_16x16x32_bf16 v[36:39], a[228:231], a[132:135], v[36:39]
    v_mfma_f32_16x16x32_bf16 v[36:39], a[232:235], a[136:139], v[36:39]
    s_mov_b32 s31, 229632
    v_mfma_f32_16x16x32_bf16 v[36:39], a[236:239], a[140:143], v[36:39]
    s_add_u32 m0, s28, 131072
    ds_read_b128 a[160:163], v3 offset:24576
    v_mfma_f32_16x16x32_bf16 v[36:39], a[240:243], a[144:147], v[36:39]
    buffer_load_dwordx4 v12, s[20:23], s31 offen nt lds
    v_mfma_f32_16x16x32_bf16 v[36:39], a[244:247], a[148:151], v[36:39]
    ds_read_b128 a[164:167], v3 offset:24832
    v_fma_f32 v32, v32, s29, v20
    v_mfma_f32_16x16x32_bf16 v[36:39], a[248:251], a[152:155], v[36:39]
    v_exp_f32 v32, v32
    v_mfma_f32_16x16x32_bf16 v[36:39], a[252:255], a[156:159], v[36:39]
    ds_read_b128 a[168:171], v3 offset:25088
    v_fma_f32 v33, v33, s29, v20
    v_mfma_f32_16x16x32_bf16 v[40:43], a[224:227], a[96:99], 0
    v_exp_f32 v33, v33
    v_mfma_f32_16x16x32_bf16 v[40:43], a[228:231], a[100:103], v[40:43]
    s_add_u32 m0, s28, 135168
    ds_read_b128 a[172:175], v3 offset:25344
    v_mfma_f32_16x16x32_bf16 v[40:43], a[232:235], a[104:107], v[40:43]
    buffer_load_dwordx4 v13, s[20:23], s31 offen nt lds
    v_mfma_f32_16x16x32_bf16 v[40:43], a[236:239], a[108:111], v[40:43]
    ds_read_b128 a[176:179], v3 offset:28672
    v_fma_f32 v34, v34, s29, v20
    v_mfma_f32_16x16x32_bf16 v[40:43], a[240:243], a[112:115], v[40:43]
    v_exp_f32 v34, v34
    v_mfma_f32_16x16x32_bf16 v[40:43], a[244:247], a[116:119], v[40:43]
    ds_read_b128 a[180:183], v3 offset:28928
    v_fma_f32 v35, v35, s29, v20
    v_mfma_f32_16x16x32_bf16 v[40:43], a[248:251], a[120:123], v[40:43]
    v_exp_f32 v35, v35
    v_mfma_f32_16x16x32_bf16 v[40:43], a[252:255], a[124:127], v[40:43]
    s_waitcnt lgkmcnt(2)
    s_add_u32 m0, s28, 139264
    ds_read_b128 a[184:187], v3 offset:29184
    v_mfma_f32_16x16x32_bf16 v[44:47], a[160:163], a[64:67], 0
    buffer_load_dwordx4 v14, s[20:23], s31 offen nt lds
    v_mfma_f32_16x16x32_bf16 v[44:47], a[164:167], a[68:71], v[44:47]
    ds_read_b128 a[188:191], v3 offset:29440
    v_add_f32 v16, v16, v32
    v_mfma_f32_16x16x32_bf16 v[44:47], a[168:171], a[72:75], v[44:47]
    v_add_f32 v16, v16, v33
    v_cvt_pk_bf16_f32 v80, v32, v33
    v_mfma_f32_16x16x32_bf16 v[44:47], a[172:175], a[76:79], v[44:47]
    s_waitcnt lgkmcnt(2)
    v_add_f32 v16, v16, v34
    v_add_f32 v16, v16, v35
    v_mfma_f32_16x16x32_bf16 v[44:47], a[176:179], a[80:83], v[44:47]
    v_cvt_pk_bf16_f32 v81, v34, v35
    v_fma_f32 v36, v36, s29, v24
    v_mfma_f32_16x16x32_bf16 v[44:47], a[180:183], a[84:87], v[44:47]
    s_waitcnt lgkmcnt(1)
    s_add_u32 m0, s28, 143360
    v_fma_f32 v37, v37, s29, v24
    v_mfma_f32_16x16x32_bf16 v[44:47], a[184:187], a[88:91], v[44:47]
    s_waitcnt lgkmcnt(0)
    buffer_load_dwordx4 v15, s[20:23], s31 offen nt lds
    v_mfma_f32_16x16x32_bf16 v[44:47], a[188:191], a[92:95], v[44:47]
    v_exp_f32 v36, v36
    v_mfma_f32_16x16x32_bf16 v[48:51], a[160:163], a[128:131], 0
    v_exp_f32 v37, v37
    v_mfma_f32_16x16x32_bf16 v[48:51], a[164:167], a[132:135], v[48:51]
    s_waitcnt vmcnt(24)
    v_fma_f32 v38, v38, s29, v24
    v_fma_f32 v39, v39, s29, v24
    v_mfma_f32_16x16x32_bf16 v[48:51], a[168:171], a[136:139], v[48:51]
    s_barrier
    v_exp_f32 v38, v38
    v_mfma_f32_16x16x32_bf16 v[48:51], a[172:175], a[140:143], v[48:51]
    ds_read_b128 a[224:227], v2 offset:16384
    v_add_f32 v18, v18, v36
    v_mfma_f32_16x16x32_bf16 v[48:51], a[176:179], a[144:147], v[48:51]
    v_exp_f32 v39, v39
    v_mfma_f32_16x16x32_bf16 v[48:51], a[180:183], a[148:151], v[48:51]
    ds_read_b128 a[228:231], v2 offset:16640
    v_add_f32 v18, v18, v37
    v_mfma_f32_16x16x32_bf16 v[48:51], a[184:187], a[152:155], v[48:51]
    v_cvt_pk_bf16_f32 v96, v36, v37
    v_add_f32 v18, v18, v38
    v_mfma_f32_16x16x32_bf16 v[48:51], a[188:191], a[156:159], v[48:51]
    ds_read_b128 a[232:235], v2 offset:16896
    v_add_f32 v18, v18, v39
    v_mfma_f32_16x16x32_bf16 v[52:55], a[160:163], a[96:99], 0
    v_cvt_pk_bf16_f32 v97, v38, v39
    v_fma_f32 v40, v40, s29, v22
    v_mfma_f32_16x16x32_bf16 v[52:55], a[164:167], a[100:103], v[52:55]
    ds_read_b128 a[236:239], v2 offset:17152
    v_fma_f32 v41, v41, s29, v22
    v_mfma_f32_16x16x32_bf16 v[52:55], a[168:171], a[104:107], v[52:55]
    v_exp_f32 v40, v40
    v_mfma_f32_16x16x32_bf16 v[52:55], a[172:175], a[108:111], v[52:55]
    ds_read_b128 a[240:243], v2 offset:20480
    v_fma_f32 v42, v42, s29, v22
    v_mfma_f32_16x16x32_bf16 v[52:55], a[176:179], a[112:115], v[52:55]
    v_exp_f32 v41, v41
    v_mfma_f32_16x16x32_bf16 v[52:55], a[180:183], a[116:119], v[52:55]
    ds_read_b128 a[244:247], v2 offset:20736
    v_fma_f32 v43, v43, s29, v22
    v_mfma_f32_16x16x32_bf16 v[52:55], a[184:187], a[120:123], v[52:55]
    v_exp_f32 v42, v42
    v_mfma_f32_16x16x32_bf16 v[52:55], a[188:191], a[124:127], v[52:55]
    s_waitcnt lgkmcnt(2)
    ds_read_b128 a[248:251], v2 offset:20992
    v_add_f32 v17, v17, v40
    v_mfma_f32_16x16x32_bf16 v[32:35], a[224:227], a[64:67], 0
    v_exp_f32 v43, v43
    v_mfma_f32_16x16x32_bf16 v[32:35], a[228:231], a[68:71], v[32:35]
    ds_read_b128 a[252:255], v2 offset:21248
    v_add_f32 v17, v17, v41
    v_mfma_f32_16x16x32_bf16 v[32:35], a[232:235], a[72:75], v[32:35]
    v_cvt_pk_bf16_f32 v88, v40, v41
    v_add_f32 v17, v17, v42
    v_mfma_f32_16x16x32_bf16 v[32:35], a[236:239], a[76:79], v[32:35]
    s_waitcnt lgkmcnt(2)
    ds_read_b128 a[160:163], v2 offset:24576
    v_add_f32 v17, v17, v43
    v_mfma_f32_16x16x32_bf16 v[32:35], a[240:243], a[80:83], v[32:35]
    v_cvt_pk_bf16_f32 v89, v42, v43
    v_fma_f32 v44, v44, s29, v20
    v_mfma_f32_16x16x32_bf16 v[32:35], a[244:247], a[84:87], v[32:35]
    s_waitcnt lgkmcnt(2)
    ds_read_b128 a[164:167], v2 offset:24832
    v_fma_f32 v45, v45, s29, v20
    v_mfma_f32_16x16x32_bf16 v[32:35], a[248:251], a[88:91], v[32:35]
    s_waitcnt lgkmcnt(2)
    v_exp_f32 v44, v44
    v_mfma_f32_16x16x32_bf16 v[32:35], a[252:255], a[92:95], v[32:35]
    ds_read_b128 a[168:171], v2 offset:25088
    v_fma_f32 v46, v46, s29, v20
    v_mfma_f32_16x16x32_bf16 v[36:39], a[224:227], a[128:131], 0
    v_exp_f32 v45, v45
    v_mfma_f32_16x16x32_bf16 v[36:39], a[228:231], a[132:135], v[36:39]
    ds_read_b128 a[172:175], v2 offset:25344
    v_fma_f32 v47, v47, s29, v20
    v_mfma_f32_16x16x32_bf16 v[36:39], a[232:235], a[136:139], v[36:39]
    v_exp_f32 v46, v46
    v_mfma_f32_16x16x32_bf16 v[36:39], a[236:239], a[140:143], v[36:39]
    ds_read_b128 a[176:179], v2 offset:28672
    v_add_f32 v16, v16, v44
    v_mfma_f32_16x16x32_bf16 v[36:39], a[240:243], a[144:147], v[36:39]
    v_exp_f32 v47, v47
    v_mfma_f32_16x16x32_bf16 v[36:39], a[244:247], a[148:151], v[36:39]
    ds_read_b128 a[180:183], v2 offset:28928
    v_add_f32 v16, v16, v45
    v_mfma_f32_16x16x32_bf16 v[36:39], a[248:251], a[152:155], v[36:39]
    v_cvt_pk_bf16_f32 v82, v44, v45
    v_add_f32 v16, v16, v46
    v_mfma_f32_16x16x32_bf16 v[36:39], a[252:255], a[156:159], v[36:39]
    ds_read_b128 a[184:187], v2 offset:29184
    v_add_f32 v16, v16, v47
    v_mfma_f32_16x16x32_bf16 v[40:43], a[224:227], a[96:99], 0
    v_cvt_pk_bf16_f32 v83, v46, v47
    v_fma_f32 v48, v48, s29, v24
    v_mfma_f32_16x16x32_bf16 v[40:43], a[228:231], a[100:103], v[40:43]
    s_waitcnt vmcnt(12)
    ds_read_b128 a[188:191], v2 offset:29440
    v_fma_f32 v49, v49, s29, v24
    v_mfma_f32_16x16x32_bf16 v[40:43], a[232:235], a[104:107], v[40:43]
    s_barrier
    v_exp_f32 v48, v48
    v_mfma_f32_16x16x32_bf16 v[40:43], a[236:239], a[108:111], v[40:43]
    ds_read_b64_tr_b16 a[192:193], v4 offset:16384
    v_fma_f32 v50, v50, s29, v24
    v_mfma_f32_16x16x32_bf16 v[40:43], a[240:243], a[112:115], v[40:43]
    ds_read_b64_tr_b16 a[194:195], v4 offset:20480
    v_fma_f32 v51, v51, s29, v24
    v_mfma_f32_16x16x32_bf16 v[40:43], a[244:247], a[116:119], v[40:43]
    v_exp_f32 v49, v49
    v_mfma_f32_16x16x32_bf16 v[40:43], a[248:251], a[120:123], v[40:43]
    ds_read_b64_tr_b16 a[196:197], v4 offset:24576
    v_add_f32 v18, v18, v48
    v_mfma_f32_16x16x32_bf16 v[40:43], a[252:255], a[124:127], v[40:43]
    s_waitcnt lgkmcnt(3)
    ds_read_b64_tr_b16 a[198:199], v4 offset:28672
    v_add_f32 v18, v18, v49
    v_mfma_f32_16x16x32_bf16 v[44:47], a[160:163], a[64:67], 0
    v_exp_f32 v50, v50
    v_mfma_f32_16x16x32_bf16 v[44:47], a[164:167], a[68:71], v[44:47]
    ds_read_b64_tr_b16 a[200:201], v4 offset:32768
    v_cvt_pk_bf16_f32 v98, v48, v49
    v_mfma_f32_16x16x32_bf16 v[44:47], a[168:171], a[72:75], v[44:47]
    ds_read_b64_tr_b16 a[202:203], v4 offset:36864
    v_add_f32 v18, v18, v50
    v_mfma_f32_16x16x32_bf16 v[44:47], a[172:175], a[76:79], v[44:47]
    v_exp_f32 v51, v51
    v_mfma_f32_16x16x32_bf16 v[44:47], a[176:179], a[80:83], v[44:47]
    ds_read_b64_tr_b16 a[204:205], v4 offset:40960
    v_add_f32 v18, v18, v51
    v_mfma_f32_16x16x32_bf16 v[44:47], a[180:183], a[84:87], v[44:47]
    ds_read_b64_tr_b16 a[206:207], v4 offset:45056
    v_cvt_pk_bf16_f32 v99, v50, v51
    v_mfma_f32_16x16x32_bf16 v[44:47], a[184:187], a[88:91], v[44:47]
    v_fma_f32 v52, v52, s29, v22
    v_fma_f32 v53, v53, s29, v22
    v_mfma_f32_16x16x32_bf16 v[44:47], a[188:191], a[92:95], v[44:47]
    ds_read_b64_tr_b16 a[216:217], v7 offset:16384
    v_fma_f32 v54, v54, s29, v22
    v_mfma_f32_16x16x32_bf16 v[48:51], a[160:163], a[128:131], 0
    ds_read_b64_tr_b16 a[218:219], v7 offset:20480
    v_fma_f32 v55, v55, s29, v22
    v_mfma_f32_16x16x32_bf16 v[48:51], a[164:167], a[132:135], v[48:51]
    v_exp_f32 v52, v52
    v_mfma_f32_16x16x32_bf16 v[48:51], a[168:171], a[136:139], v[48:51]
    ds_read_b64_tr_b16 a[220:221], v7 offset:24576
    v_add_f32 v17, v17, v52
    v_mfma_f32_16x16x32_bf16 v[48:51], a[172:175], a[140:143], v[48:51]
    ds_read_b64_tr_b16 a[222:223], v7 offset:28672
    v_fma_f32 v32, v32, s29, v20
    v_mfma_f32_16x16x32_bf16 v[48:51], a[176:179], a[144:147], v[48:51]
    v_exp_f32 v53, v53
    v_mfma_f32_16x16x32_bf16 v[48:51], a[180:183], a[148:151], v[48:51]
    ds_read_b64_tr_b16 a[224:225], v7 offset:32768
    v_add_f32 v17, v17, v53
    v_mfma_f32_16x16x32_bf16 v[48:51], a[184:187], a[152:155], v[48:51]
    ds_read_b64_tr_b16 a[226:227], v7 offset:36864
    v_cvt_pk_bf16_f32 v90, v52, v53
    v_mfma_f32_16x16x32_bf16 v[48:51], a[188:191], a[156:159], v[48:51]
    v_exp_f32 v54, v54
    s_nop 0
    v_add_f32 v17, v17, v54
    v_exp_f32 v55, v55
    s_nop 0
    v_add_f32 v17, v17, v55
    v_cvt_pk_bf16_f32 v91, v54, v55
    v_mfma_f32_16x16x32_bf16 v[52:55], a[160:163], a[96:99], 0
    ds_read_b64_tr_b16 a[228:229], v7 offset:40960
    v_fma_f32 v33, v33, s29, v20
    v_mfma_f32_16x16x32_bf16 v[52:55], a[164:167], a[100:103], v[52:55]
    ds_read_b64_tr_b16 a[230:231], v7 offset:45056
    v_fma_f32 v34, v34, s29, v20
    v_mfma_f32_16x16x32_bf16 v[52:55], a[168:171], a[104:107], v[52:55]
    v_exp_f32 v32, v32
    v_mfma_f32_16x16x32_bf16 v[52:55], a[172:175], a[108:111], v[52:55]
    ds_read_b64_tr_b16 a[208:209], v4 offset:49152
    v_fma_f32 v35, v35, s29, v20
    v_mfma_f32_16x16x32_bf16 v[52:55], a[176:179], a[112:115], v[52:55]
    ds_read_b64_tr_b16 a[210:211], v4 offset:53248
    v_add_f32 v16, v16, v32
    v_mfma_f32_16x16x32_bf16 v[52:55], a[180:183], a[116:119], v[52:55]
    v_exp_f32 v33, v33
    v_mfma_f32_16x16x32_bf16 v[52:55], a[184:187], a[120:123], v[52:55]
    ds_read_b64_tr_b16 a[212:213], v4 offset:57344
    v_add_f32 v16, v16, v33
    v_mfma_f32_16x16x32_bf16 v[52:55], a[188:191], a[124:127], v[52:55]
    s_waitcnt lgkmcnt(3)
    ds_read_b64_tr_b16 a[214:215], v4 offset:61440
    v_cvt_pk_bf16_f32 v84, v32, v33
    v_mfma_f32_16x16x32_bf16 v[128:131], a[192:195], v[104:107], v[128:131]
    v_exp_f32 v34, v34
    v_mfma_f32_16x16x32_bf16 v[128:131], a[196:199], v[108:111], v[128:131]
    ds_read_b64_tr_b16 a[232:233], v7 offset:49152
    v_add_f32 v16, v16, v34
    v_fma_f32 v36, v36, s29, v24
    v_mfma_f32_16x16x32_bf16 v[128:131], a[200:203], v[56:59], v[128:131]
    ds_read_b64_tr_b16 a[234:235], v7 offset:53248
    v_fma_f32 v37, v37, s29, v24
    v_mfma_f32_16x16x32_bf16 v[128:131], a[204:207], v[60:63], v[128:131]
    v_exp_f32 v35, v35
    v_fma_f32 v38, v38, s29, v24
    v_mfma_f32_16x16x32_bf16 v[132:135], a[216:219], v[104:107], v[132:135]
    ds_read_b64_tr_b16 a[236:237], v7 offset:57344
    v_add_f32 v16, v16, v35
    v_mfma_f32_16x16x32_bf16 v[132:135], a[220:223], v[108:111], v[132:135]
    ds_read_b64_tr_b16 a[238:239], v7 offset:61440
    v_cvt_pk_bf16_f32 v85, v34, v35
    v_fma_f32 v39, v39, s29, v24
    v_mfma_f32_16x16x32_bf16 v[132:135], a[224:227], v[56:59], v[132:135]
    v_exp_f32 v36, v36
    v_mfma_f32_16x16x32_bf16 v[132:135], a[228:231], v[60:63], v[132:135]
    s_waitcnt lgkmcnt(2)
    ds_read_b64_tr_b16 a[160:161], v4 offset:16640
    v_add_f32 v18, v18, v36
    v_fma_f32 v40, v40, s29, v22
    v_fma_f32 v44, v44, s29, v20
    v_exp_f32 v44, v44
    v_fma_f32 v45, v45, s29, v20
    v_exp_f32 v45, v45
    s_nop 0
    v_cvt_pk_bf16_f32 v86, v44, v45
    v_fma_f32 v46, v46, s29, v20
    v_exp_f32 v46, v46
    v_fma_f32 v47, v47, s29, v20
    v_exp_f32 v47, v47
    s_nop 0
    v_cvt_pk_bf16_f32 v87, v46, v47
    v_mfma_f32_16x16x32_bf16 v[128:131], a[208:211], v[80:83], v[128:131]
    ds_read_b64_tr_b16 a[162:163], v4 offset:20736
    v_fma_f32 v41, v41, s29, v22
    v_mfma_f32_16x16x32_bf16 v[128:131], a[212:215], v[84:87], v[128:131]
    v_exp_f32 v37, v37
    v_fma_f32 v42, v42, s29, v22
    v_mfma_f32_16x16x32_bf16 v[132:135], a[232:235], v[80:83], v[132:135]
    s_waitcnt lgkmcnt(2)
    ds_read_b64_tr_b16 a[164:165], v4 offset:24832
    v_add_f32 v18, v18, v37
    v_mfma_f32_16x16x32_bf16 v[132:135], a[236:239], v[84:87], v[132:135]
    ds_read_b64_tr_b16 a[166:167], v4 offset:28928
    v_cvt_pk_bf16_f32 v100, v36, v37
    v_fma_f32 v43, v43, s29, v22
    v_mfma_f32_16x16x32_bf16 a[0:3], a[192:195], v[120:123], a[0:3]
    v_exp_f32 v38, v38
    v_mfma_f32_16x16x32_bf16 a[0:3], a[196:199], v[124:127], a[0:3]
    ds_read_b64_tr_b16 a[168:169], v4 offset:33024
    v_add_f32 v18, v18, v38
    v_add_f32 v16, v16, v44
    v_mfma_f32_16x16x32_bf16 a[0:3], a[200:203], v[72:75], a[0:3]
    ds_read_b64_tr_b16 a[170:171], v4 offset:37120
    v_add_f32 v16, v16, v45
    v_mfma_f32_16x16x32_bf16 a[0:3], a[204:207], v[76:79], a[0:3]
    v_exp_f32 v39, v39
    v_add_f32 v16, v16, v46
    v_cvt_pk_bf16_f32 v101, v38, v39
    v_fma_f32 v48, v48, s29, v24
    v_exp_f32 v48, v48
    v_fma_f32 v49, v49, s29, v24
    v_exp_f32 v49, v49
    s_nop 0
    v_cvt_pk_bf16_f32 v102, v48, v49
    v_fma_f32 v50, v50, s29, v24
    v_exp_f32 v50, v50
    v_fma_f32 v51, v51, s29, v24
    v_exp_f32 v51, v51
    s_nop 0
    v_cvt_pk_bf16_f32 v103, v50, v51
    v_mfma_f32_16x16x32_bf16 a[0:3], a[208:211], v[96:99], a[0:3]
    ds_read_b64_tr_b16 a[172:173], v4 offset:41216
    v_add_f32 v18, v18, v39
    v_mfma_f32_16x16x32_bf16 a[0:3], a[212:215], v[100:103], a[0:3]
    ds_read_b64_tr_b16 a[174:175], v4 offset:45312
    v_add_f32 v16, v16, v47
    v_add_f32 v18, v18, v48
    v_mfma_f32_16x16x32_bf16 a[4:7], a[216:219], v[120:123], a[4:7]
    v_exp_f32 v40, v40
    v_mfma_f32_16x16x32_bf16 a[4:7], a[220:223], v[124:127], a[4:7]
    ds_read_b64_tr_b16 a[176:177], v4 offset:49408
    v_add_f32 v17, v17, v40
    v_add_f32 v18, v18, v49
    v_mfma_f32_16x16x32_bf16 a[4:7], a[224:227], v[72:75], a[4:7]
    ds_read_b64_tr_b16 a[178:179], v4 offset:53504
    v_add_f32 v18, v18, v50
    v_mfma_f32_16x16x32_bf16 a[4:7], a[228:231], v[76:79], a[4:7]
    v_exp_f32 v41, v41
    v_add_f32 v18, v18, v51
    v_mfma_f32_16x16x32_bf16 a[4:7], a[232:235], v[96:99], a[4:7]
    ds_read_b64_tr_b16 a[180:181], v4 offset:57600
    v_add_f32 v17, v17, v41
    v_mfma_f32_16x16x32_bf16 a[4:7], a[236:239], v[100:103], a[4:7]
    ds_read_b64_tr_b16 a[182:183], v4 offset:61696
    v_cvt_pk_bf16_f32 v92, v40, v41
    v_fma_f32 v52, v52, s29, v22
    v_mfma_f32_16x16x32_bf16 v[192:195], a[192:195], v[112:115], v[192:195]
    v_exp_f32 v42, v42
    v_mfma_f32_16x16x32_bf16 v[192:195], a[196:199], v[116:119], v[192:195]
    ds_read_b64_tr_b16 a[96:97], v7 offset:16640
    v_add_f32 v17, v17, v42
    v_fma_f32 v53, v53, s29, v22
    v_mfma_f32_16x16x32_bf16 v[192:195], a[200:203], v[64:67], v[192:195]
    ds_read_b64_tr_b16 a[98:99], v7 offset:20736
    v_fma_f32 v54, v54, s29, v22
    v_mfma_f32_16x16x32_bf16 v[192:195], a[204:207], v[68:71], v[192:195]
    v_exp_f32 v43, v43
    v_fma_f32 v55, v55, s29, v22
    v_cvt_pk_bf16_f32 v93, v42, v43
    v_exp_f32 v52, v52
    v_exp_f32 v53, v53
    s_nop 0
    v_cvt_pk_bf16_f32 v94, v52, v53
    v_exp_f32 v54, v54
    v_exp_f32 v55, v55
    s_nop 0
    v_cvt_pk_bf16_f32 v95, v54, v55
    v_mfma_f32_16x16x32_bf16 v[192:195], a[208:211], v[88:91], v[192:195]
    ds_read_b64_tr_b16 a[100:101], v7 offset:24832
    v_add_f32 v17, v17, v43
    v_mfma_f32_16x16x32_bf16 v[192:195], a[212:215], v[92:95], v[192:195]
L_pg6:
    s_cbranch_execz L_wr6
    ds_read_b64_tr_b16 a[102:103], v7 offset:28928
    v_add_f32 v17, v17, v52
    v_add_f32 v17, v17, v53
    v_mfma_f32_16x16x32_bf16 v[196:199], a[216:219], v[112:115], v[196:199]
    v_add_f32 v17, v17, v54
    v_add_f32 v17, v17, v55
    v_mfma_f32_16x16x32_bf16 v[196:199], a[220:223], v[116:119], v[196:199]
    ds_read_b64_tr_b16 a[104:105], v7 offset:33024
    v_mov_b32 v28, v16
    v_mov_b32 v29, v17
    v_mfma_f32_16x16x32_bf16 v[196:199], a[224:227], v[64:67], v[196:199]
    ds_read_b64_tr_b16 a[106:107], v7 offset:37120
    v_mov_b32 v30, v18
    v_mfma_f32_16x16x32_bf16 v[196:199], a[228:231], v[68:71], v[196:199]
    v_permlane32_swap_b32 v16, v28
    v_permlane32_swap_b32 v17, v29
    v_permlane32_swap_b32 v18, v30
    v_mfma_f32_16x16x32_bf16 v[196:199], a[232:235], v[88:91], v[196:199]
    ds_read_b64_tr_b16 a[108:109], v7 offset:41216
    v_add_f32 v16, v16, v28
    v_mfma_f32_16x16x32_bf16 v[196:199], a[236:239], v[92:95], v[196:199]
    s_waitcnt lgkmcnt(3)
    ds_read_b64_tr_b16 a[110:111], v7 offset:45312
    v_add_f32 v17, v17, v29
    v_add_f32 v18, v18, v30
    v_mfma_f32_16x16x32_bf16 v[136:139], a[160:163], v[104:107], v[136:139]
    v_mov_b32 v28, v16
    v_mov_b32 v29, v17
    v_mfma_f32_16x16x32_bf16 v[136:139], a[164:167], v[108:111], v[136:139]
    ds_read_b64_tr_b16 a[112:113], v7 offset:49408
    v_mov_b32 v30, v18
    v_permlane16_swap_b32 v16, v28
    v_mfma_f32_16x16x32_bf16 v[136:139], a[168:171], v[56:59], v[136:139]
    ds_read_b64_tr_b16 a[114:115], v7 offset:53504
    v_permlane16_swap_b32 v17, v29
    v_mfma_f32_16x16x32_bf16 v[136:139], a[172:175], v[60:63], v[136:139]
    v_permlane16_swap_b32 v18, v30
    v_add_f32 v16, v16, v28
    v_add_f32 v17, v17, v29
    v_mfma_f32_16x16x32_bf16 v[136:139], a[176:179], v[80:83], v[136:139]
    ds_read_b64_tr_b16 a[116:117], v7 offset:57600
    v_add_f32 v18, v18, v30
    v_mfma_f32_16x16x32_bf16 v[136:139], a[180:183], v[84:87], v[136:139]
    ds_read_b64_tr_b16 a[118:119], v7 offset:61696
    v_cmp_lt_f32 vcc, s37, v16
    v_add_u32 v10, 0, v19
    v_mfma_f32_16x16x32_bf16 v[140:143], a[96:99], v[104:107], v[140:143]
    v_rcp_f32 v20, v16
    v_mfma_f32_16x16x32_bf16 v[140:143], a[100:103], v[108:111], v[140:143]
    s_waitcnt lgkmcnt(2)
    s_or_b64 s[40:41], s[40:41], vcc
    ds_read_b64_tr_b16 a[192:193], v4 offset:16896
    v_cmp_lt_f32 vcc, s37, v17
    v_add_u32 v11, 4096, v19
    v_mfma_f32_16x16x32_bf16 v[140:143], a[104:107], v[56:59], v[140:143]
    ds_read_b64_tr_b16 a[194:195], v4 offset:20992
    v_add_u32 v12, 8192, v19
    v_mfma_f32_16x16x32_bf16 v[140:143], a[108:111], v[60:63], v[140:143]
    s_or_b64 s[40:41], s[40:41], vcc
    v_rcp_f32 v22, v17
    v_cmp_lt_f32 vcc, s37, v18
    v_mfma_f32_16x16x32_bf16 v[140:143], a[112:115], v[80:83], v[140:143]
    s_waitcnt lgkmcnt(2)
    ds_read_b64_tr_b16 a[196:197], v4 offset:25088
    v_add_u32 v13, 12288, v19
    v_mfma_f32_16x16x32_bf16 v[140:143], a[116:119], v[84:87], v[140:143]
    s_or_b64 s[40:41], s[40:41], vcc
    ds_read_b64_tr_b16 a[198:199], v4 offset:29184
    v_add_u32 v14, 16384, v19
    v_add_u32 v15, 20480, v19
    v_mfma_f32_16x16x32_bf16 a[8:11], a[160:163], v[120:123], a[8:11]
    v_rcp_f32 v24, v18
    v_mfma_f32_16x16x32_bf16 a[8:11], a[164:167], v[124:127], a[8:11]
    ds_read_b64_tr_b16 a[200:201], v4 offset:33280
    v_mul_f32 v128, v128, v20
    v_mul_f32 v129, v129, v20
    v_mfma_f32_16x16x32_bf16 a[8:11], a[168:171], v[72:75], a[8:11]
    ds_read_b64_tr_b16 a[202:203], v4 offset:37376
    v_mul_f32 v130, v130, v20
    v_mfma_f32_16x16x32_bf16 a[8:11], a[172:175], v[76:79], a[8:11]
    v_mul_f32 v131, v131, v20
    v_mul_f32 v132, v132, v20
    v_mul_f32 v133, v133, v20
    v_mfma_f32_16x16x32_bf16 a[8:11], a[176:179], v[96:99], a[8:11]
    ds_read_b64_tr_b16 a[204:205], v4 offset:41472
    v_mul_f32 v134, v134, v20
    v_mfma_f32_16x16x32_bf16 a[8:11], a[180:183], v[100:103], a[8:11]
    ds_read_b64_tr_b16 a[206:207], v4 offset:45568
    v_mul_f32 v135, v135, v20
    v_cvt_pk_bf16_f32 v128, v128, v129
    v_mfma_f32_16x16x32_bf16 a[12:15], a[96:99], v[120:123], a[12:15]
    v_cvt_pk_bf16_f32 v129, v130, v131
    v_cvt_pk_bf16_f32 v130, v132, v133
    v_mfma_f32_16x16x32_bf16 a[12:15], a[100:103], v[124:127], a[12:15]
    ds_read_b64_tr_b16 a[208:209], v4 offset:49664
    v_cvt_pk_bf16_f32 v131, v134, v135
    v_mul_f32 v136, v136, v20
    v_mfma_f32_16x16x32_bf16 a[12:15], a[104:107], v[72:75], a[12:15]
    ds_read_b64_tr_b16 a[210:211], v4 offset:53760
    v_mul_f32 v137, v137, v20
    v_mfma_f32_16x16x32_bf16 a[12:15], a[108:111], v[76:79], a[12:15]
    ds_write_b64 v23, v[128:129] offset:0
    v_mul_f32 v138, v138, v20
    v_mfma_f32_16x16x32_bf16 a[12:15], a[112:115], v[96:99], a[12:15]
    ds_read_b64_tr_b16 a[212:213], v4 offset:57856
    v_mul_f32 v139, v139, v20
    v_mfma_f32_16x16x32_bf16 a[12:15], a[116:119], v[100:103], a[12:15]
    ds_read_b64_tr_b16 a[214:215], v4 offset:61952
    v_mul_f32 v140, v140, v20
    v_mul_f32 v141, v141, v20
    v_mfma_f32_16x16x32_bf16 v[200:203], a[160:163], v[112:115], v[200:203]
    ds_write_b64 v25, v[130:131] offset:0
    v_mul_f32 v142, v142, v20
    v_mfma_f32_16x16x32_bf16 v[200:203], a[164:167], v[116:119], v[200:203]
    ds_read_b64_tr_b16 a[216:217], v7 offset:16896
    v_mul_f32 v143, v143, v20
    v_cvt_pk_bf16_f32 v136, v136, v137
    v_mfma_f32_16x16x32_bf16 v[200:203], a[168:171], v[64:67], v[200:203]
    ds_read_b64_tr_b16 a[218:219], v7 offset:20992
    v_cvt_pk_bf16_f32 v137, v138, v139
    v_mfma_f32_16x16x32_bf16 v[200:203], a[172:175], v[68:71], v[200:203]
    ds_write_b64 v26, v[136:137] offset:0
    v_cvt_pk_bf16_f32 v138, v140, v141
    v_mfma_f32_16x16x32_bf16 v[200:203], a[176:179], v[88:91], v[200:203]
    ds_read_b64_tr_b16 a[220:221], v7 offset:25088
    v_cvt_pk_bf16_f32 v139, v142, v143
    v_mfma_f32_16x16x32_bf16 v[200:203], a[180:183], v[92:95], v[200:203]
    ds_read_b64_tr_b16 a[222:223], v7 offset:29184
    v_accvgpr_read_b32 v32, a0
    v_accvgpr_read_b32 v33, a1
    v_mfma_f32_16x16x32_bf16 v[204:207], a[96:99], v[112:115], v[204:207]
    ds_write_b64 v27, v[138:139] offset:0
    v_accvgpr_read_b32 v34, a2
    v_mfma_f32_16x16x32_bf16 v[204:207], a[100:103], v[116:119], v[204:207]
    ds_read_b64_tr_b16 a[224:225], v7 offset:33280
    v_accvgpr_read_b32 v35, a3
    v_accvgpr_read_b32 v36, a4
    v_mfma_f32_16x16x32_bf16 v[204:207], a[104:107], v[64:67], v[204:207]
    ds_read_b64_tr_b16 a[226:227], v7 offset:37376
    v_accvgpr_read_b32 v37, a5
    v_mfma_f32_16x16x32_bf16 v[204:207], a[108:111], v[68:71], v[204:207]
    ds_read_b128 a[64:67], v21 offset:0
    v_accvgpr_read_b32 v38, a6
    v_accvgpr_read_b32 v39, a7
    v_mfma_f32_16x16x32_bf16 v[204:207], a[112:115], v[88:91], v[204:207]
    ds_read_b64_tr_b16 a[228:229], v7 offset:41472
    v_mul_f32 v32, v32, v24
    v_mfma_f32_16x16x32_bf16 v[204:207], a[116:119], v[92:95], v[204:207]
    s_waitcnt lgkmcnt(5)
    ds_read_b64_tr_b16 a[230:231], v7 offset:45568
    v_mul_f32 v33, v33, v24
    v_mul_f32 v34, v34, v24
    v_mfma_f32_16x16x32_bf16 v[144:147], a[192:195], v[104:107], v[144:147]
    ds_read_b128 a[68:71], v21 offset:1024
    v_mul_f32 v35, v35, v24
    v_mfma_f32_16x16x32_bf16 v[144:147], a[196:199], v[108:111], v[144:147]
    ds_read_b64_tr_b16 a[232:233], v7 offset:49664
    v_mul_f32 v36, v36, v24
    v_mul_f32 v37, v37, v24
    v_mfma_f32_16x16x32_bf16 v[144:147], a[200:203], v[56:59], v[144:147]
    ds_read_b64_tr_b16 a[234:235], v7 offset:53760
    v_mul_f32 v38, v38, v24
    v_mfma_f32_16x16x32_bf16 v[144:147], a[204:207], v[60:63], v[144:147]
    s_waitcnt lgkmcnt(5)
    buffer_store_dwordx4 a[64:67], v10, s[24:27], 0 offen offset:0 nt
    v_mul_f32 v39, v39, v24
    v_cvt_pk_bf16_f32 v32, v32, v33
    v_cvt_pk_bf16_f32 v33, v34, v35
    v_cvt_pk_bf16_f32 v34, v36, v37
    v_mfma_f32_16x16x32_bf16 v[144:147], a[208:211], v[80:83], v[144:147]
    ds_read_b64_tr_b16 a[236:237], v7 offset:57856
    v_cvt_pk_bf16_f32 v35, v38, v39
    v_mfma_f32_16x16x32_bf16 v[144:147], a[212:215], v[84:87], v[144:147]
    ds_read_b64_tr_b16 a[238:239], v7 offset:61952
    v_accvgpr_read_b32 v40, a8
    v_accvgpr_read_b32 v41, a9
    v_mfma_f32_16x16x32_bf16 v[148:151], a[216:219], v[104:107], v[148:151]
    s_waitcnt lgkmcnt(4)
    buffer_store_dwordx4 a[68:71], v11, s[24:27], 0 offen offset:0 nt
    v_accvgpr_read_b32 v42, a10
    v_accvgpr_read_b32 v43, a11
    v_accvgpr_read_b32 v44, a12
    v_accvgpr_read_b32 v45, a13
    v_mfma_f32_16x16x32_bf16 v[148:151], a[220:223], v[108:111], v[148:151]
    s_waitcnt lgkmcnt(2)
    ds_read_b64_tr_b16 a[160:161], v4 offset:17152
    v_accvgpr_read_b32 v46, a14
    v_mfma_f32_16x16x32_bf16 v[148:151], a[224:227], v[56:59], v[148:151]
    ds_read_b64_tr_b16 a[162:163], v4 offset:21248
    v_accvgpr_read_b32 v47, a15
    v_mfma_f32_16x16x32_bf16 v[148:151], a[228:231], v[60:63], v[148:151]
    ds_write_b64 v23, v[32:33] offset:0
    v_mul_f32 v40, v40, v24
    v_mfma_f32_16x16x32_bf16 v[148:151], a[232:235], v[80:83], v[148:151]
    s_waitcnt lgkmcnt(3)
    ds_read_b64_tr_b16 a[164:165], v4 offset:25344
    v_mul_f32 v41, v41, v24
    v_mfma_f32_16x16x32_bf16 v[148:151], a[236:239], v[84:87], v[148:151]
    ds_read_b64_tr_b16 a[166:167], v4 offset:29440
    v_mul_f32 v42, v42, v24
    v_mfma_f32_16x16x32_bf16 a[16:19], a[192:195], v[120:123], a[16:19]
    ds_write_b64 v25, v[34:35] offset:0
    v_mul_f32 v43, v43, v24
    v_mfma_f32_16x16x32_bf16 a[16:19], a[196:199], v[124:127], a[16:19]
    ds_read_b64_tr_b16 a[168:169], v4 offset:33536
    v_mul_f32 v44, v44, v24
    v_mfma_f32_16x16x32_bf16 a[16:19], a[200:203], v[72:75], a[16:19]
    ds_read_b64_tr_b16 a[170:171], v4 offset:37632
    v_mul_f32 v45, v45, v24
    v_mfma_f32_16x16x32_bf16 a[16:19], a[204:207], v[76:79], a[16:19]
    v_mul_f32 v46, v46, v24
    v_mul_f32 v47, v47, v24
    v_mfma_f32_16x16x32_bf16 a[16:19], a[208:211], v[96:99], a[16:19]
    ds_read_b64_tr_b16 a[172:173], v4 offset:41728
    v_cvt_pk_bf16_f32 v40, v40, v41
    v_mfma_f32_16x16x32_bf16 a[16:19], a[212:215], v[100:103], a[16:19]
    ds_read_b64_tr_b16 a[174:175], v4 offset:45824
    v_cvt_pk_bf16_f32 v41, v42, v43
    v_mfma_f32_16x16x32_bf16 a[20:23], a[216:219], v[120:123], a[20:23]
    ds_write_b64 v26, v[40:41] offset:0
    v_cvt_pk_bf16_f32 v42, v44, v45
    v_mfma_f32_16x16x32_bf16 a[20:23], a[220:223], v[124:127], a[20:23]
    ds_read_b64_tr_b16 a[176:177], v4 offset:49920
    v_cvt_pk_bf16_f32 v43, v46, v47
    v_mfma_f32_16x16x32_bf16 a[20:23], a[224:227], v[72:75], a[20:23]
    ds_read_b64_tr_b16 a[178:179], v4 offset:54016
    v_mul_f32 v192, v192, v22
    v_mfma_f32_16x16x32_bf16 a[20:23], a[228:231], v[76:79], a[20:23]
    ds_write_b64 v27, v[42:43] offset:0
    v_mul_f32 v193, v193, v22
    v_mfma_f32_16x16x32_bf16 a[20:23], a[232:235], v[96:99], a[20:23]
    ds_read_b64_tr_b16 a[180:181], v4 offset:58112
    v_mul_f32 v194, v194, v22
    v_mfma_f32_16x16x32_bf16 a[20:23], a[236:239], v[100:103], a[20:23]
    ds_read_b64_tr_b16 a[182:183], v4 offset:62208
    v_mul_f32 v195, v195, v22
    v_mfma_f32_16x16x32_bf16 v[208:211], a[192:195], v[112:115], v[208:211]
    ds_read_b128 a[72:75], v21 offset:0
    v_mul_f32 v196, v196, v22
    v_mfma_f32_16x16x32_bf16 v[208:211], a[196:199], v[116:119], v[208:211]
    ds_read_b64_tr_b16 a[96:97], v7 offset:17152
    v_mul_f32 v197, v197, v22
    v_mfma_f32_16x16x32_bf16 v[208:211], a[200:203], v[64:67], v[208:211]
    ds_read_b64_tr_b16 a[98:99], v7 offset:21248
    v_mul_f32 v198, v198, v22
    v_mfma_f32_16x16x32_bf16 v[208:211], a[204:207], v[68:71], v[208:211]
    ds_read_b128 a[76:79], v21 offset:1024
    v_mul_f32 v199, v199, v22
    v_mfma_f32_16x16x32_bf16 v[208:211], a[208:211], v[88:91], v[208:211]
    ds_read_b64_tr_b16 a[100:101], v7 offset:25344
    v_cvt_pk_bf16_f32 v192, v192, v193
    v_mfma_f32_16x16x32_bf16 v[208:211], a[212:215], v[92:95], v[208:211]
    ds_read_b64_tr_b16 a[102:103], v7 offset:29440
    v_cvt_pk_bf16_f32 v193, v194, v195
    v_mfma_f32_16x16x32_bf16 v[212:215], a[216:219], v[112:115], v[212:215]
    s_waitcnt lgkmcnt(5)
    buffer_store_dwordx4 a[72:75], v14, s[24:27], 0 offen offset:0 nt
    v_cvt_pk_bf16_f32 v194, v196, v197
    v_cvt_pk_bf16_f32 v195, v198, v199
    v_mul_f32 v200, v200, v22
    v_mul_f32 v201, v201, v22
    v_mfma_f32_16x16x32_bf16 v[212:215], a[220:223], v[116:119], v[212:215]
    ds_read_b64_tr_b16 a[104:105], v7 offset:33536
    v_mul_f32 v202, v202, v22
    v_mfma_f32_16x16x32_bf16 v[212:215], a[224:227], v[64:67], v[212:215]
    ds_read_b64_tr_b16 a[106:107], v7 offset:37632
    v_mul_f32 v203, v203, v22
    v_mfma_f32_16x16x32_bf16 v[212:215], a[228:231], v[68:71], v[212:215]
    s_waitcnt lgkmcnt(4)
    buffer_store_dwordx4 a[76:79], v15, s[24:27], 0 offen offset:0 nt
    v_mul_f32 v204, v204, v22
    v_mul_f32 v205, v205, v22
    v_mul_f32 v206, v206, v22
    v_mul_f32 v207, v207, v22
    v_mfma_f32_16x16x32_bf16 v[212:215], a[232:235], v[88:91], v[212:215]
    ds_read_b64_tr_b16 a[108:109], v7 offset:41728
    v_cvt_pk_bf16_f32 v200, v200, v201
    v_mfma_f32_16x16x32_bf16 v[212:215], a[236:239], v[92:95], v[212:215]
    s_waitcnt lgkmcnt(3)
    ds_read_b64_tr_b16 a[110:111], v7 offset:45824
    v_cvt_pk_bf16_f32 v201, v202, v203
    v_mfma_f32_16x16x32_bf16 v[152:155], a[160:163], v[104:107], v[152:155]
    ds_write_b64 v23, v[192:193] offset:2048
    v_cvt_pk_bf16_f32 v202, v204, v205
    v_mfma_f32_16x16x32_bf16 v[152:155], a[164:167], v[108:111], v[152:155]
    ds_read_b64_tr_b16 a[112:113], v7 offset:49920
    v_cvt_pk_bf16_f32 v203, v206, v207
    v_mfma_f32_16x16x32_bf16 v[152:155], a[168:171], v[56:59], v[152:155]
    ds_read_b64_tr_b16 a[114:115], v7 offset:54016
    v_mul_f32 v144, v144, v20
    v_mfma_f32_16x16x32_bf16 v[152:155], a[172:175], v[60:63], v[152:155]
    ds_write_b64 v25, v[194:195] offset:2048
    v_mul_f32 v145, v145, v20
    v_mfma_f32_16x16x32_bf16 v[152:155], a[176:179], v[80:83], v[152:155]
    ds_read_b64_tr_b16 a[116:117], v7 offset:58112
    v_mul_f32 v146, v146, v20
    v_mfma_f32_16x16x32_bf16 v[152:155], a[180:183], v[84:87], v[152:155]
    s_waitcnt vmcnt(4)
    ds_read_b64_tr_b16 a[118:119], v7 offset:62208
    v_mul_f32 v147, v147, v20
    v_mfma_f32_16x16x32_bf16 v[156:159], a[96:99], v[104:107], v[156:159]
    s_barrier
    ds_write_b64 v26, v[200:201] offset:2048
    v_mul_f32 v148, v148, v20
    v_mfma_f32_16x16x32_bf16 v[156:159], a[100:103], v[108:111], v[156:159]
    s_waitcnt lgkmcnt(4)
    ds_read_b64_tr_b16 a[192:193], v5 offset:32768
    v_mul_f32 v149, v149, v20
    v_mfma_f32_16x16x32_bf16 v[156:159], a[104:107], v[56:59], v[156:159]
    ds_read_b64_tr_b16 a[194:195], v5 offset:36864
    v_mul_f32 v150, v150, v20
    v_mfma_f32_16x16x32_bf16 v[156:159], a[108:111], v[60:63], v[156:159]
    ds_write_b64 v27, v[202:203] offset:2048
    v_mul_f32 v151, v151, v20
    v_mfma_f32_16x16x32_bf16 v[156:159], a[112:115], v[80:83], v[156:159]
    s_waitcnt lgkmcnt(4)
    ds_read_b64_tr_b16 a[196:197], v5 offset:40960
    v_cvt_pk_bf16_f32 v144, v144, v145
    v_mfma_f32_16x16x32_bf16 v[156:159], a[116:119], v[84:87], v[156:159]
    ds_read_b64_tr_b16 a[198:199], v5 offset:45056
    v_cvt_pk_bf16_f32 v145, v146, v147
    v_mfma_f32_16x16x32_bf16 a[24:27], a[160:163], v[120:123], a[24:27]
    ds_read_b128 a[80:83], v21 offset:2048
    v_cvt_pk_bf16_f32 v146, v148, v149
    v_mfma_f32_16x16x32_bf16 a[24:27], a[164:167], v[124:127], a[24:27]
    ds_read_b64_tr_b16 a[200:201], v5 offset:49152
    v_cvt_pk_bf16_f32 v147, v150, v151
    v_mfma_f32_16x16x32_bf16 a[24:27], a[168:171], v[72:75], a[24:27]
    ds_read_b64_tr_b16 a[202:203], v5 offset:53248
    v_accvgpr_read_b32 v48, a16
    v_mfma_f32_16x16x32_bf16 a[24:27], a[172:175], v[76:79], a[24:27]
    ds_read_b128 a[84:87], v21 offset:3072
    v_mul_f32 v152, v152, v20
    v_mfma_f32_16x16x32_bf16 a[24:27], a[176:179], v[96:99], a[24:27]
    ds_read_b64_tr_b16 a[204:205], v5 offset:57344
    v_mul_f32 v153, v153, v20
    v_mfma_f32_16x16x32_bf16 a[24:27], a[180:183], v[100:103], a[24:27]
    ds_read_b64_tr_b16 a[206:207], v5 offset:61440
    v_mul_f32 v154, v154, v20
    v_mfma_f32_16x16x32_bf16 a[28:31], a[96:99], v[120:123], a[28:31]
    s_waitcnt lgkmcnt(5)
    buffer_store_dwordx4 a[80:83], v12, s[24:27], 0 offen offset:0 nt
    v_mul_f32 v155, v155, v20
    v_mul_f32 v156, v156, v20
    v_mul_f32 v157, v157, v20
    v_mul_f32 v158, v158, v20
    v_mfma_f32_16x16x32_bf16 a[28:31], a[100:103], v[124:127], a[28:31]
    ds_read_b64_tr_b16 a[208:209], v6 offset:0
    v_mul_f32 v159, v159, v20
    v_mfma_f32_16x16x32_bf16 a[28:31], a[104:107], v[72:75], a[28:31]
    ds_read_b64_tr_b16 a[210:211], v6 offset:4096
    v_cvt_pk_bf16_f32 v152, v152, v153
    v_mfma_f32_16x16x32_bf16 a[28:31], a[108:111], v[76:79], a[28:31]
    s_waitcnt lgkmcnt(4)
    buffer_store_dwordx4 a[84:87], v13, s[24:27], 0 offen offset:0 nt
    v_cvt_pk_bf16_f32 v153, v154, v155
    v_cvt_pk_bf16_f32 v154, v156, v157
    v_cvt_pk_bf16_f32 v155, v158, v159
    v_accvgpr_read_b32 v49, a17
    v_mfma_f32_16x16x32_bf16 a[28:31], a[112:115], v[96:99], a[28:31]
    ds_read_b64_tr_b16 a[212:213], v6 offset:8192
    v_accvgpr_read_b32 v50, a18
    v_mfma_f32_16x16x32_bf16 a[28:31], a[116:119], v[100:103], a[28:31]
    ds_read_b64_tr_b16 a[214:215], v6 offset:12288
    v_accvgpr_read_b32 v51, a19
    v_mfma_f32_16x16x32_bf16 v[216:219], a[160:163], v[112:115], v[216:219]
    ds_write_b64 v23, v[144:145] offset:2048
    v_accvgpr_read_b32 v52, a20
    v_mfma_f32_16x16x32_bf16 v[216:219], a[164:167], v[116:119], v[216:219]
    ds_read_b64_tr_b16 a[216:217], v8 offset:32768
    v_accvgpr_read_b32 v53, a21
    v_mfma_f32_16x16x32_bf16 v[216:219], a[168:171], v[64:67], v[216:219]
    ds_read_b64_tr_b16 a[218:219], v8 offset:36864
    v_accvgpr_read_b32 v54, a22
    v_mfma_f32_16x16x32_bf16 v[216:219], a[172:175], v[68:71], v[216:219]
    ds_write_b64 v25, v[146:147] offset:2048
    v_accvgpr_read_b32 v55, a23
    v_mfma_f32_16x16x32_bf16 v[216:219], a[176:179], v[88:91], v[216:219]
    ds_read_b64_tr_b16 a[220:221], v8 offset:40960
    v_mul_f32 v48, v48, v24
    v_mfma_f32_16x16x32_bf16 v[216:219], a[180:183], v[92:95], v[216:219]
    ds_read_b64_tr_b16 a[222:223], v8 offset:45056
    v_mul_f32 v49, v49, v24
    v_mfma_f32_16x16x32_bf16 v[220:223], a[96:99], v[112:115], v[220:223]
    ds_write_b64 v26, v[152:153] offset:2048
    v_mul_f32 v50, v50, v24
    v_mfma_f32_16x16x32_bf16 v[220:223], a[100:103], v[116:119], v[220:223]
    ds_read_b64_tr_b16 a[224:225], v8 offset:49152
    v_mul_f32 v51, v51, v24
    v_mfma_f32_16x16x32_bf16 v[220:223], a[104:107], v[64:67], v[220:223]
    ds_read_b64_tr_b16 a[226:227], v8 offset:53248
    v_mul_f32 v52, v52, v24
    v_mfma_f32_16x16x32_bf16 v[220:223], a[108:111], v[68:71], v[220:223]
    ds_write_b64 v27, v[154:155] offset:2048
    v_mul_f32 v53, v53, v24
    v_mfma_f32_16x16x32_bf16 v[220:223], a[112:115], v[88:91], v[220:223]
    ds_read_b64_tr_b16 a[228:229], v8 offset:57344
    v_mul_f32 v54, v54, v24
    v_mfma_f32_16x16x32_bf16 v[220:223], a[116:119], v[92:95], v[220:223]
    s_waitcnt lgkmcnt(5)
    ds_read_b64_tr_b16 a[230:231], v8 offset:61440
    v_mul_f32 v55, v55, v24
    v_mfma_f32_16x16x32_bf16 v[160:163], a[192:195], v[104:107], v[160:163]
    ds_read_b128 a[88:91], v21 offset:2048
    v_cvt_pk_bf16_f32 v48, v48, v49
    v_mfma_f32_16x16x32_bf16 v[160:163], a[196:199], v[108:111], v[160:163]
    ds_read_b64_tr_b16 a[232:233], v9 offset:0
    v_cvt_pk_bf16_f32 v49, v50, v51
    v_mfma_f32_16x16x32_bf16 v[160:163], a[200:203], v[56:59], v[160:163]
    ds_read_b64_tr_b16 a[234:235], v9 offset:4096
    v_cvt_pk_bf16_f32 v50, v52, v53
    v_mfma_f32_16x16x32_bf16 v[160:163], a[204:207], v[60:63], v[160:163]
    ds_read_b128 a[92:95], v21 offset:3072
    v_cvt_pk_bf16_f32 v51, v54, v55
    v_mfma_f32_16x16x32_bf16 v[160:163], a[208:211], v[80:83], v[160:163]
    ds_read_b64_tr_b16 a[236:237], v9 offset:8192
    v_accvgpr_read_b32 v32, a24
    v_mfma_f32_16x16x32_bf16 v[160:163], a[212:215], v[84:87], v[160:163]
    ds_read_b64_tr_b16 a[238:239], v9 offset:12288
    v_accvgpr_read_b32 v33, a25
    v_mfma_f32_16x16x32_bf16 v[164:167], a[216:219], v[104:107], v[164:167]
    s_waitcnt lgkmcnt(5)
    buffer_store_dwordx4 a[88:91], v10, s[24:27], 0 offen offset:128 nt
    v_accvgpr_read_b32 v34, a26
    v_accvgpr_read_b32 v35, a27
    v_accvgpr_read_b32 v36, a28
    v_accvgpr_read_b32 v37, a29
    v_mfma_f32_16x16x32_bf16 v[164:167], a[220:223], v[108:111], v[164:167]
    s_waitcnt lgkmcnt(3)
    ds_read_b64_tr_b16 a[160:161], v5 offset:33024
    v_accvgpr_read_b32 v38, a30
    v_mfma_f32_16x16x32_bf16 v[164:167], a[224:227], v[56:59], v[164:167]
    ds_read_b64_tr_b16 a[162:163], v5 offset:37120
    v_accvgpr_read_b32 v39, a31
    v_mfma_f32_16x16x32_bf16 v[164:167], a[228:231], v[60:63], v[164:167]
    s_waitcnt lgkmcnt(4)
    buffer_store_dwordx4 a[92:95], v11, s[24:27], 0 offen offset:128 nt
    v_mul_f32 v32, v32, v24
    v_mul_f32 v33, v33, v24
    v_mul_f32 v34, v34, v24
    v_mul_f32 v35, v35, v24
    v_mfma_f32_16x16x32_bf16 v[164:167], a[232:235], v[80:83], v[164:167]
    s_waitcnt lgkmcnt(2)
    ds_read_b64_tr_b16 a[164:165], v5 offset:41216
    v_mul_f32 v36, v36, v24
    v_mfma_f32_16x16x32_bf16 v[164:167], a[236:239], v[84:87], v[164:167]
    ds_read_b64_tr_b16 a[166:167], v5 offset:45312
    v_mul_f32 v37, v37, v24
    v_mfma_f32_16x16x32_bf16 a[32:35], a[192:195], v[120:123], a[32:35]
    ds_write_b64 v23, v[48:49] offset:2048
    v_mul_f32 v38, v38, v24
    v_mfma_f32_16x16x32_bf16 a[32:35], a[196:199], v[124:127], a[32:35]
    ds_read_b64_tr_b16 a[168:169], v5 offset:49408
    v_mul_f32 v39, v39, v24
    v_mfma_f32_16x16x32_bf16 a[32:35], a[200:203], v[72:75], a[32:35]
    ds_read_b64_tr_b16 a[170:171], v5 offset:53504
    v_cvt_pk_bf16_f32 v32, v32, v33
    v_mfma_f32_16x16x32_bf16 a[32:35], a[204:207], v[76:79], a[32:35]
    ds_write_b64 v25, v[50:51] offset:2048
    v_cvt_pk_bf16_f32 v33, v34, v35
    v_mfma_f32_16x16x32_bf16 a[32:35], a[208:211], v[96:99], a[32:35]
    ds_read_b64_tr_b16 a[172:173], v5 offset:57600
    v_cvt_pk_bf16_f32 v34, v36, v37
    v_mfma_f32_16x16x32_bf16 a[32:35], a[212:215], v[100:103], a[32:35]
    ds_read_b64_tr_b16 a[174:175], v5 offset:61696
    v_cvt_pk_bf16_f32 v35, v38, v39
    v_mfma_f32_16x16x32_bf16 a[36:39], a[216:219], v[120:123], a[36:39]
    ds_write_b64 v26, v[32:33] offset:2048
    v_mul_f32 v208, v208, v22
    v_mfma_f32_16x16x32_bf16 a[36:39], a[220:223], v[124:127], a[36:39]
    ds_read_b64_tr_b16 a[176:177], v6 offset:256
    v_mul_f32 v209, v209, v22
    v_mfma_f32_16x16x32_bf16 a[36:39], a[224:227], v[72:75], a[36:39]
    ds_read_b64_tr_b16 a[178:179], v6 offset:4352
    v_mul_f32 v210, v210, v22
    v_mfma_f32_16x16x32_bf16 a[36:39], a[228:231], v[76:79], a[36:39]
    ds_write_b64 v27, v[34:35] offset:2048
    v_mul_f32 v211, v211, v22
    v_mfma_f32_16x16x32_bf16 a[36:39], a[232:235], v[96:99], a[36:39]
    ds_read_b64_tr_b16 a[180:181], v6 offset:8448
    v_mul_f32 v212, v212, v22
    v_mfma_f32_16x16x32_bf16 a[36:39], a[236:239], v[100:103], a[36:39]
    ds_read_b64_tr_b16 a[182:183], v6 offset:12544
    v_mul_f32 v213, v213, v22
    v_mfma_f32_16x16x32_bf16 v[224:227], a[192:195], v[112:115], v[224:227]
    ds_read_b128 a[64:67], v21 offset:2048
    v_mul_f32 v214, v214, v22
    v_mfma_f32_16x16x32_bf16 v[224:227], a[196:199], v[116:119], v[224:227]
    ds_read_b64_tr_b16 a[96:97], v8 offset:33024
    v_mul_f32 v215, v215, v22
    v_mfma_f32_16x16x32_bf16 v[224:227], a[200:203], v[64:67], v[224:227]
    ds_read_b64_tr_b16 a[98:99], v8 offset:37120
    v_cvt_pk_bf16_f32 v208, v208, v209
    v_mfma_f32_16x16x32_bf16 v[224:227], a[204:207], v[68:71], v[224:227]
    ds_read_b128 a[68:71], v21 offset:3072
    v_cvt_pk_bf16_f32 v209, v210, v211
    v_mfma_f32_16x16x32_bf16 v[224:227], a[208:211], v[88:91], v[224:227]
    ds_read_b64_tr_b16 a[100:101], v8 offset:41216
    v_cvt_pk_bf16_f32 v210, v212, v213
    v_mfma_f32_16x16x32_bf16 v[224:227], a[212:215], v[92:95], v[224:227]
    ds_read_b64_tr_b16 a[102:103], v8 offset:45312
    v_cvt_pk_bf16_f32 v211, v214, v215
    v_mfma_f32_16x16x32_bf16 v[228:231], a[216:219], v[112:115], v[228:231]
    s_waitcnt lgkmcnt(5)
    buffer_store_dwordx4 a[64:67], v14, s[24:27], 0 offen offset:128 nt
    v_mul_f32 v216, v216, v22
    v_mul_f32 v217, v217, v22
    v_mul_f32 v218, v218, v22
    v_mul_f32 v219, v219, v22
    v_mfma_f32_16x16x32_bf16 v[228:231], a[220:223], v[116:119], v[228:231]
    ds_read_b64_tr_b16 a[104:105], v8 offset:49408
    v_mul_f32 v220, v220, v22
    v_mfma_f32_16x16x32_bf16 v[228:231], a[224:227], v[64:67], v[228:231]
    ds_read_b64_tr_b16 a[106:107], v8 offset:53504
    v_mul_f32 v221, v221, v22
    v_mfma_f32_16x16x32_bf16 v[228:231], a[228:231], v[68:71], v[228:231]
    s_waitcnt lgkmcnt(4)
    buffer_store_dwordx4 a[68:71], v15, s[24:27], 0 offen offset:128 nt
    v_mul_f32 v222, v222, v22
    v_mul_f32 v223, v223, v22
    v_cvt_pk_bf16_f32 v216, v216, v217
    v_cvt_pk_bf16_f32 v217, v218, v219
    v_mfma_f32_16x16x32_bf16 v[228:231], a[232:235], v[88:91], v[228:231]
    ds_read_b64_tr_b16 a[108:109], v8 offset:57600
    v_cvt_pk_bf16_f32 v218, v220, v221
    v_mfma_f32_16x16x32_bf16 v[228:231], a[236:239], v[92:95], v[228:231]
    s_waitcnt lgkmcnt(3)
    ds_read_b64_tr_b16 a[110:111], v8 offset:61696
    v_cvt_pk_bf16_f32 v219, v222, v223
    v_mfma_f32_16x16x32_bf16 v[168:171], a[160:163], v[104:107], v[168:171]
    ds_write_b64 v23, v[208:209] offset:0
    v_mul_f32 v160, v160, v20
    v_mfma_f32_16x16x32_bf16 v[168:171], a[164:167], v[108:111], v[168:171]
    ds_read_b64_tr_b16 a[112:113], v9 offset:256
    v_mul_f32 v161, v161, v20
    v_mfma_f32_16x16x32_bf16 v[168:171], a[168:171], v[56:59], v[168:171]
    ds_read_b64_tr_b16 a[114:115], v9 offset:4352
    v_mul_f32 v162, v162, v20
    v_mfma_f32_16x16x32_bf16 v[168:171], a[172:175], v[60:63], v[168:171]
    ds_write_b64 v25, v[210:211] offset:0
    v_mul_f32 v163, v163, v20
    v_mfma_f32_16x16x32_bf16 v[168:171], a[176:179], v[80:83], v[168:171]
    ds_read_b64_tr_b16 a[116:117], v9 offset:8448
    v_mul_f32 v164, v164, v20
    v_mfma_f32_16x16x32_bf16 v[168:171], a[180:183], v[84:87], v[168:171]
    ds_read_b64_tr_b16 a[118:119], v9 offset:12544
    v_mul_f32 v165, v165, v20
    v_mfma_f32_16x16x32_bf16 v[172:175], a[96:99], v[104:107], v[172:175]
    ds_write_b64 v26, v[216:217] offset:0
    v_mul_f32 v166, v166, v20
    v_mfma_f32_16x16x32_bf16 v[172:175], a[100:103], v[108:111], v[172:175]
    s_waitcnt lgkmcnt(4)
    ds_read_b64_tr_b16 a[192:193], v5 offset:33280
    v_mul_f32 v167, v167, v20
    v_mfma_f32_16x16x32_bf16 v[172:175], a[104:107], v[56:59], v[172:175]
    ds_read_b64_tr_b16 a[194:195], v5 offset:37376
    v_cvt_pk_bf16_f32 v160, v160, v161
    v_mfma_f32_16x16x32_bf16 v[172:175], a[108:111], v[60:63], v[172:175]
    ds_write_b64 v27, v[218:219] offset:0
    v_cvt_pk_bf16_f32 v161, v162, v163
    v_mfma_f32_16x16x32_bf16 v[172:175], a[112:115], v[80:83], v[172:175]
    s_waitcnt lgkmcnt(4)
    ds_read_b64_tr_b16 a[196:197], v5 offset:41472
    v_cvt_pk_bf16_f32 v162, v164, v165
    v_mfma_f32_16x16x32_bf16 v[172:175], a[116:119], v[84:87], v[172:175]
    ds_read_b64_tr_b16 a[198:199], v5 offset:45568
    v_cvt_pk_bf16_f32 v163, v166, v167
    v_mfma_f32_16x16x32_bf16 a[40:43], a[160:163], v[120:123], a[40:43]
    ds_read_b128 a[72:75], v21 offset:0
    v_accvgpr_read_b32 v40, a32
    v_mfma_f32_16x16x32_bf16 a[40:43], a[164:167], v[124:127], a[40:43]
    ds_read_b64_tr_b16 a[200:201], v5 offset:49664
    v_accvgpr_read_b32 v41, a33
    v_mfma_f32_16x16x32_bf16 a[40:43], a[168:171], v[72:75], a[40:43]
    ds_read_b64_tr_b16 a[202:203], v5 offset:53760
    v_accvgpr_read_b32 v42, a34
    v_mfma_f32_16x16x32_bf16 a[40:43], a[172:175], v[76:79], a[40:43]
    ds_read_b128 a[76:79], v21 offset:1024
    v_mul_f32 v168, v168, v20
    v_mfma_f32_16x16x32_bf16 a[40:43], a[176:179], v[96:99], a[40:43]
    ds_read_b64_tr_b16 a[204:205], v5 offset:57856
    v_mul_f32 v169, v169, v20
    v_mfma_f32_16x16x32_bf16 a[40:43], a[180:183], v[100:103], a[40:43]
    ds_read_b64_tr_b16 a[206:207], v5 offset:61952
    v_mul_f32 v170, v170, v20
    v_mfma_f32_16x16x32_bf16 a[44:47], a[96:99], v[120:123], a[44:47]
    s_waitcnt lgkmcnt(5)
    buffer_store_dwordx4 a[72:75], v12, s[24:27], 0 offen offset:128 nt
    v_mul_f32 v171, v171, v20
    v_mul_f32 v172, v172, v20
    v_mul_f32 v173, v173, v20
    v_mul_f32 v174, v174, v20
    v_mfma_f32_16x16x32_bf16 a[44:47], a[100:103], v[124:127], a[44:47]
    ds_read_b64_tr_b16 a[208:209], v6 offset:512
    v_mul_f32 v175, v175, v20
    v_mfma_f32_16x16x32_bf16 a[44:47], a[104:107], v[72:75], a[44:47]
    ds_read_b64_tr_b16 a[210:211], v6 offset:4608
L_pg7:
    s_cbranch_execz L_wr7
    v_cvt_pk_bf16_f32 v168, v168, v169
    v_mfma_f32_16x16x32_bf16 a[44:47], a[108:111], v[76:79], a[44:47]
    s_waitcnt lgkmcnt(4)
    buffer_store_dwordx4 a[76:79], v13, s[24:27], 0 offen offset:128 nt
    v_cvt_pk_bf16_f32 v169, v170, v171
    v_cvt_pk_bf16_f32 v170, v172, v173
    v_cvt_pk_bf16_f32 v171, v174, v175
    v_accvgpr_read_b32 v43, a35
    v_mfma_f32_16x16x32_bf16 a[44:47], a[112:115], v[96:99], a[44:47]
    ds_read_b64_tr_b16 a[212:213], v6 offset:8704
    v_accvgpr_read_b32 v44, a36
    v_mfma_f32_16x16x32_bf16 a[44:47], a[116:119], v[100:103], a[44:47]
    ds_read_b64_tr_b16 a[214:215], v6 offset:12800
    v_accvgpr_read_b32 v45, a37
    v_mfma_f32_16x16x32_bf16 v[232:235], a[160:163], v[112:115], v[232:235]
    ds_write_b64 v23, v[160:161] offset:0
    v_accvgpr_read_b32 v46, a38
    v_mfma_f32_16x16x32_bf16 v[232:235], a[164:167], v[116:119], v[232:235]
    ds_read_b64_tr_b16 a[216:217], v8 offset:33280
    v_accvgpr_read_b32 v47, a39
    v_mfma_f32_16x16x32_bf16 v[232:235], a[168:171], v[64:67], v[232:235]
    ds_read_b64_tr_b16 a[218:219], v8 offset:37376
    v_mul_f32 v40, v40, v24
    v_mfma_f32_16x16x32_bf16 v[232:235], a[172:175], v[68:71], v[232:235]
    ds_write_b64 v25, v[162:163] offset:0
    v_mul_f32 v41, v41, v24
    v_mfma_f32_16x16x32_bf16 v[232:235], a[176:179], v[88:91], v[232:235]
    ds_read_b64_tr_b16 a[220:221], v8 offset:41472
    v_mul_f32 v42, v42, v24
    v_mfma_f32_16x16x32_bf16 v[232:235], a[180:183], v[92:95], v[232:235]
    ds_read_b64_tr_b16 a[222:223], v8 offset:45568
    v_mul_f32 v43, v43, v24
    v_mfma_f32_16x16x32_bf16 v[236:239], a[96:99], v[112:115], v[236:239]
    ds_write_b64 v26, v[168:169] offset:0
    v_mul_f32 v44, v44, v24
    v_mfma_f32_16x16x32_bf16 v[236:239], a[100:103], v[116:119], v[236:239]
    ds_read_b64_tr_b16 a[224:225], v8 offset:49664
    v_mul_f32 v45, v45, v24
    v_mfma_f32_16x16x32_bf16 v[236:239], a[104:107], v[64:67], v[236:239]
    ds_read_b64_tr_b16 a[226:227], v8 offset:53760
    v_mul_f32 v46, v46, v24
    v_mfma_f32_16x16x32_bf16 v[236:239], a[108:111], v[68:71], v[236:239]
    ds_write_b64 v27, v[170:171] offset:0
    v_mul_f32 v47, v47, v24
    v_mfma_f32_16x16x32_bf16 v[236:239], a[112:115], v[88:91], v[236:239]
    ds_read_b64_tr_b16 a[228:229], v8 offset:57856
    v_cvt_pk_bf16_f32 v40, v40, v41
    v_mfma_f32_16x16x32_bf16 v[236:239], a[116:119], v[92:95], v[236:239]
    s_waitcnt lgkmcnt(5)
    ds_read_b64_tr_b16 a[230:231], v8 offset:61952
    v_cvt_pk_bf16_f32 v41, v42, v43
    v_mfma_f32_16x16x32_bf16 v[176:179], a[192:195], v[104:107], v[176:179]
    ds_read_b128 a[80:83], v21 offset:0
    v_cvt_pk_bf16_f32 v42, v44, v45
    v_mfma_f32_16x16x32_bf16 v[176:179], a[196:199], v[108:111], v[176:179]
    ds_read_b64_tr_b16 a[232:233], v9 offset:512
    v_cvt_pk_bf16_f32 v43, v46, v47
    v_mfma_f32_16x16x32_bf16 v[176:179], a[200:203], v[56:59], v[176:179]
    ds_read_b64_tr_b16 a[234:235], v9 offset:4608
    v_accvgpr_read_b32 v48, a40
    v_mfma_f32_16x16x32_bf16 v[176:179], a[204:207], v[60:63], v[176:179]
    ds_read_b128 a[84:87], v21 offset:1024
    v_accvgpr_read_b32 v49, a41
    v_mfma_f32_16x16x32_bf16 v[176:179], a[208:211], v[80:83], v[176:179]
    ds_read_b64_tr_b16 a[236:237], v9 offset:8704
    v_accvgpr_read_b32 v50, a42
    v_mfma_f32_16x16x32_bf16 v[176:179], a[212:215], v[84:87], v[176:179]
    ds_read_b64_tr_b16 a[238:239], v9 offset:12800
    v_accvgpr_read_b32 v51, a43
    v_mfma_f32_16x16x32_bf16 v[180:183], a[216:219], v[104:107], v[180:183]
    s_waitcnt lgkmcnt(5)
    buffer_store_dwordx4 a[80:83], v10, s[24:27], 0 offen offset:256 nt
    v_accvgpr_read_b32 v52, a44
    v_accvgpr_read_b32 v53, a45
    v_accvgpr_read_b32 v54, a46
    v_accvgpr_read_b32 v55, a47
    v_mfma_f32_16x16x32_bf16 v[180:183], a[220:223], v[108:111], v[180:183]
    s_waitcnt lgkmcnt(3)
    ds_read_b64_tr_b16 a[160:161], v5 offset:33536
    v_mul_f32 v48, v48, v24
    v_mfma_f32_16x16x32_bf16 v[180:183], a[224:227], v[56:59], v[180:183]
    ds_read_b64_tr_b16 a[162:163], v5 offset:37632
    v_mul_f32 v49, v49, v24
    v_mfma_f32_16x16x32_bf16 v[180:183], a[228:231], v[60:63], v[180:183]
    s_waitcnt lgkmcnt(4)
    buffer_store_dwordx4 a[84:87], v11, s[24:27], 0 offen offset:256 nt
    v_mul_f32 v50, v50, v24
    v_mul_f32 v51, v51, v24
    v_mul_f32 v52, v52, v24
    v_mul_f32 v53, v53, v24
    v_mfma_f32_16x16x32_bf16 v[180:183], a[232:235], v[80:83], v[180:183]
    s_waitcnt lgkmcnt(2)
    ds_read_b64_tr_b16 a[164:165], v5 offset:41728
    v_mul_f32 v54, v54, v24
    v_mfma_f32_16x16x32_bf16 v[180:183], a[236:239], v[84:87], v[180:183]
    ds_read_b64_tr_b16 a[166:167], v5 offset:45824
    v_mul_f32 v55, v55, v24
    v_mfma_f32_16x16x32_bf16 a[48:51], a[192:195], v[120:123], a[48:51]
    ds_write_b64 v23, v[40:41] offset:0
    v_cvt_pk_bf16_f32 v48, v48, v49
    v_mfma_f32_16x16x32_bf16 a[48:51], a[196:199], v[124:127], a[48:51]
    ds_read_b64_tr_b16 a[168:169], v5 offset:49920
    v_cvt_pk_bf16_f32 v49, v50, v51
    v_mfma_f32_16x16x32_bf16 a[48:51], a[200:203], v[72:75], a[48:51]
    ds_read_b64_tr_b16 a[170:171], v5 offset:54016
    v_cvt_pk_bf16_f32 v50, v52, v53
    v_mfma_f32_16x16x32_bf16 a[48:51], a[204:207], v[76:79], a[48:51]
    ds_write_b64 v25, v[42:43] offset:0
    v_cvt_pk_bf16_f32 v51, v54, v55
    v_mfma_f32_16x16x32_bf16 a[48:51], a[208:211], v[96:99], a[48:51]
    ds_read_b64_tr_b16 a[172:173], v5 offset:58112
    v_mul_f32 v224, v224, v22
    v_mfma_f32_16x16x32_bf16 a[48:51], a[212:215], v[100:103], a[48:51]
    ds_read_b64_tr_b16 a[174:175], v5 offset:62208
    v_mul_f32 v225, v225, v22
    v_mfma_f32_16x16x32_bf16 a[52:55], a[216:219], v[120:123], a[52:55]
    ds_write_b64 v26, v[48:49] offset:0
    v_mul_f32 v226, v226, v22
    v_mfma_f32_16x16x32_bf16 a[52:55], a[220:223], v[124:127], a[52:55]
    ds_read_b64_tr_b16 a[176:177], v6 offset:768
    v_mul_f32 v227, v227, v22
    v_mfma_f32_16x16x32_bf16 a[52:55], a[224:227], v[72:75], a[52:55]
    ds_read_b64_tr_b16 a[178:179], v6 offset:4864
    v_mul_f32 v228, v228, v22
    v_mfma_f32_16x16x32_bf16 a[52:55], a[228:231], v[76:79], a[52:55]
    ds_write_b64 v27, v[50:51] offset:0
    v_mul_f32 v229, v229, v22
    v_mfma_f32_16x16x32_bf16 a[52:55], a[232:235], v[96:99], a[52:55]
    ds_read_b64_tr_b16 a[180:181], v6 offset:8960
    v_mul_f32 v230, v230, v22
    v_mfma_f32_16x16x32_bf16 a[52:55], a[236:239], v[100:103], a[52:55]
    ds_read_b64_tr_b16 a[182:183], v6 offset:13056
    v_mul_f32 v231, v231, v22
    v_mfma_f32_16x16x32_bf16 v[240:243], a[192:195], v[112:115], v[240:243]
    ds_read_b128 a[88:91], v21 offset:0
    v_cvt_pk_bf16_f32 v224, v224, v225
    v_mfma_f32_16x16x32_bf16 v[240:243], a[196:199], v[116:119], v[240:243]
    ds_read_b64_tr_b16 a[96:97], v8 offset:33536
    v_cvt_pk_bf16_f32 v225, v226, v227
    v_mfma_f32_16x16x32_bf16 v[240:243], a[200:203], v[64:67], v[240:243]
    ds_read_b64_tr_b16 a[98:99], v8 offset:37632
    v_cvt_pk_bf16_f32 v226, v228, v229
    v_mfma_f32_16x16x32_bf16 v[240:243], a[204:207], v[68:71], v[240:243]
    ds_read_b128 a[92:95], v21 offset:1024
    v_cvt_pk_bf16_f32 v227, v230, v231
    v_mfma_f32_16x16x32_bf16 v[240:243], a[208:211], v[88:91], v[240:243]
    ds_read_b64_tr_b16 a[100:101], v8 offset:41728
    v_mul_f32 v232, v232, v22
    v_mfma_f32_16x16x32_bf16 v[240:243], a[212:215], v[92:95], v[240:243]
    ds_read_b64_tr_b16 a[102:103], v8 offset:45824
    v_mul_f32 v233, v233, v22
    v_mfma_f32_16x16x32_bf16 v[244:247], a[216:219], v[112:115], v[244:247]
    s_waitcnt lgkmcnt(5)
    buffer_store_dwordx4 a[88:91], v14, s[24:27], 0 offen offset:256 nt
    v_mul_f32 v234, v234, v22
    v_mul_f32 v235, v235, v22
    v_mul_f32 v236, v236, v22
    v_mul_f32 v237, v237, v22
    v_mfma_f32_16x16x32_bf16 v[244:247], a[220:223], v[116:119], v[244:247]
    ds_read_b64_tr_b16 a[104:105], v8 offset:49920
    v_mul_f32 v238, v238, v22
    v_mfma_f32_16x16x32_bf16 v[244:247], a[224:227], v[64:67], v[244:247]
    ds_read_b64_tr_b16 a[106:107], v8 offset:54016
    v_mul_f32 v239, v239, v22
    v_mfma_f32_16x16x32_bf16 v[244:247], a[228:231], v[68:71], v[244:247]
    s_waitcnt lgkmcnt(4)
    buffer_store_dwordx4 a[92:95], v15, s[24:27], 0 offen offset:256 nt
    v_cvt_pk_bf16_f32 v232, v232, v233
    v_cvt_pk_bf16_f32 v233, v234, v235
    v_cvt_pk_bf16_f32 v234, v236, v237
    v_cvt_pk_bf16_f32 v235, v238, v239
    v_mfma_f32_16x16x32_bf16 v[244:247], a[232:235], v[88:91], v[244:247]
    ds_read_b64_tr_b16 a[108:109], v8 offset:58112
    v_mul_f32 v176, v176, v20
    v_mfma_f32_16x16x32_bf16 v[244:247], a[236:239], v[92:95], v[244:247]
    s_waitcnt lgkmcnt(3)
    ds_read_b64_tr_b16 a[110:111], v8 offset:62208
    v_mul_f32 v177, v177, v20
    v_mfma_f32_16x16x32_bf16 v[184:187], a[160:163], v[104:107], v[184:187]
    ds_write_b64 v23, v[224:225] offset:2048
    v_mul_f32 v178, v178, v20
    v_mfma_f32_16x16x32_bf16 v[184:187], a[164:167], v[108:111], v[184:187]
    ds_read_b64_tr_b16 a[112:113], v9 offset:768
    v_mul_f32 v179, v179, v20
    v_mfma_f32_16x16x32_bf16 v[184:187], a[168:171], v[56:59], v[184:187]
    ds_read_b64_tr_b16 a[114:115], v9 offset:4864
    v_mul_f32 v180, v180, v20
    v_mfma_f32_16x16x32_bf16 v[184:187], a[172:175], v[60:63], v[184:187]
    ds_write_b64 v25, v[226:227] offset:2048
    v_mul_f32 v181, v181, v20
    v_mfma_f32_16x16x32_bf16 v[184:187], a[176:179], v[80:83], v[184:187]
    ds_read_b64_tr_b16 a[116:117], v9 offset:8960
    v_mul_f32 v182, v182, v20
    v_mfma_f32_16x16x32_bf16 v[184:187], a[180:183], v[84:87], v[184:187]
    ds_read_b64_tr_b16 a[118:119], v9 offset:13056
    v_mul_f32 v183, v183, v20
    v_mfma_f32_16x16x32_bf16 v[188:191], a[96:99], v[104:107], v[188:191]
    ds_write_b64 v26, v[232:233] offset:2048
    v_cvt_pk_bf16_f32 v176, v176, v177
    v_mfma_f32_16x16x32_bf16 v[188:191], a[100:103], v[108:111], v[188:191]
    s_waitcnt lgkmcnt(4)
    ds_write_b64 v27, v[234:235] offset:2048
    v_cvt_pk_bf16_f32 v177, v178, v179
    v_mfma_f32_16x16x32_bf16 v[188:191], a[104:107], v[56:59], v[188:191]
    ds_read_b128 a[64:67], v21 offset:2048
    v_cvt_pk_bf16_f32 v178, v180, v181
    v_mfma_f32_16x16x32_bf16 v[188:191], a[108:111], v[60:63], v[188:191]
    ds_read_b128 a[68:71], v21 offset:3072
    v_cvt_pk_bf16_f32 v179, v182, v183
    v_mfma_f32_16x16x32_bf16 v[188:191], a[112:115], v[80:83], v[188:191]
    s_waitcnt lgkmcnt(4)
    ds_write_b64 v23, v[176:177] offset:2048
    v_accvgpr_read_b32 v32, a48
    v_mfma_f32_16x16x32_bf16 v[188:191], a[116:119], v[84:87], v[188:191]
    ds_write_b64 v25, v[178:179] offset:2048
    v_accvgpr_read_b32 v33, a49
    v_mfma_f32_16x16x32_bf16 a[56:59], a[160:163], v[120:123], a[56:59]
    v_accvgpr_read_b32 v34, a50
    v_accvgpr_read_b32 v35, a51
    v_mfma_f32_16x16x32_bf16 a[56:59], a[164:167], v[124:127], a[56:59]
    v_accvgpr_read_b32 v36, a52
    v_accvgpr_read_b32 v37, a53
    v_mfma_f32_16x16x32_bf16 a[56:59], a[168:171], v[72:75], a[56:59]
    s_waitcnt lgkmcnt(3)
    buffer_store_dwordx4 a[64:67], v12, s[24:27], 0 offen offset:256 nt
    v_accvgpr_read_b32 v38, a54
    v_accvgpr_read_b32 v39, a55
    v_mul_f32 v32, v32, v24
    v_mul_f32 v33, v33, v24
    v_mfma_f32_16x16x32_bf16 a[56:59], a[172:175], v[76:79], a[56:59]
    s_waitcnt lgkmcnt(2)
    buffer_store_dwordx4 a[68:71], v13, s[24:27], 0 offen offset:256 nt
    v_mul_f32 v184, v184, v20
    v_mul_f32 v185, v185, v20
    v_mul_f32 v186, v186, v20
    v_mul_f32 v187, v187, v20
    v_mfma_f32_16x16x32_bf16 a[56:59], a[176:179], v[96:99], a[56:59]
    v_mul_f32 v188, v188, v20
    v_mul_f32 v189, v189, v20
    v_mfma_f32_16x16x32_bf16 a[56:59], a[180:183], v[100:103], a[56:59]
    v_mul_f32 v190, v190, v20
    v_mul_f32 v191, v191, v20
    v_mfma_f32_16x16x32_bf16 a[60:63], a[96:99], v[120:123], a[60:63]
    v_cvt_pk_bf16_f32 v184, v184, v185
    v_cvt_pk_bf16_f32 v185, v186, v187
    v_mfma_f32_16x16x32_bf16 a[60:63], a[100:103], v[124:127], a[60:63]
    ds_write_b64 v26, v[184:185] offset:2048
    v_cvt_pk_bf16_f32 v186, v188, v189
    v_mfma_f32_16x16x32_bf16 a[60:63], a[104:107], v[72:75], a[60:63]
    v_cvt_pk_bf16_f32 v187, v190, v191
    v_mul_f32 v34, v34, v24
    v_mfma_f32_16x16x32_bf16 a[60:63], a[108:111], v[76:79], a[60:63]
    ds_write_b64 v27, v[186:187] offset:2048
    v_mul_f32 v35, v35, v24
    v_mfma_f32_16x16x32_bf16 a[60:63], a[112:115], v[96:99], a[60:63]
    ds_read_b128 a[72:75], v21 offset:2048
    v_mul_f32 v36, v36, v24
    v_mfma_f32_16x16x32_bf16 a[60:63], a[116:119], v[100:103], a[60:63]
    ds_read_b128 a[76:79], v21 offset:3072
    v_mul_f32 v37, v37, v24
    v_mfma_f32_16x16x32_bf16 v[248:251], a[160:163], v[112:115], v[248:251]
    v_mul_f32 v38, v38, v24
    v_mul_f32 v39, v39, v24
    v_mfma_f32_16x16x32_bf16 v[248:251], a[164:167], v[116:119], v[248:251]
    v_cvt_pk_bf16_f32 v32, v32, v33
    v_cvt_pk_bf16_f32 v33, v34, v35
    v_mfma_f32_16x16x32_bf16 v[248:251], a[168:171], v[64:67], v[248:251]
    ds_write_b64 v23, v[32:33] offset:2048
    v_cvt_pk_bf16_f32 v34, v36, v37
    v_mfma_f32_16x16x32_bf16 v[248:251], a[172:175], v[68:71], v[248:251]
    v_cvt_pk_bf16_f32 v35, v38, v39
    v_accvgpr_read_b32 v40, a56
    v_mfma_f32_16x16x32_bf16 v[248:251], a[176:179], v[88:91], v[248:251]
    s_waitcnt lgkmcnt(2)
    buffer_store_dwordx4 a[72:75], v10, s[24:27], 0 offen offset:384 nt
    v_accvgpr_read_b32 v41, a57
    v_accvgpr_read_b32 v42, a58
    v_accvgpr_read_b32 v43, a59
    v_accvgpr_read_b32 v44, a60
    v_mfma_f32_16x16x32_bf16 v[248:251], a[180:183], v[92:95], v[248:251]
    s_waitcnt lgkmcnt(1)
    buffer_store_dwordx4 a[76:79], v11, s[24:27], 0 offen offset:384 nt
    v_accvgpr_read_b32 v45, a61
    v_accvgpr_read_b32 v46, a62
    v_accvgpr_read_b32 v47, a63
    v_mul_f32 v40, v40, v24
    v_mfma_f32_16x16x32_bf16 v[252:255], a[96:99], v[112:115], v[252:255]
    ds_write_b64 v25, v[34:35] offset:2048
    v_mul_f32 v41, v41, v24
    v_mfma_f32_16x16x32_bf16 v[252:255], a[100:103], v[116:119], v[252:255]
    v_mul_f32 v42, v42, v24
    v_mul_f32 v43, v43, v24
    v_mfma_f32_16x16x32_bf16 v[252:255], a[104:107], v[64:67], v[252:255]
    v_mul_f32 v44, v44, v24
    v_mul_f32 v45, v45, v24
    v_mfma_f32_16x16x32_bf16 v[252:255], a[108:111], v[68:71], v[252:255]
    v_mul_f32 v46, v46, v24
    v_mul_f32 v47, v47, v24
    v_mfma_f32_16x16x32_bf16 v[252:255], a[112:115], v[88:91], v[252:255]
    v_cvt_pk_bf16_f32 v40, v40, v41
    v_cvt_pk_bf16_f32 v41, v42, v43
    v_mfma_f32_16x16x32_bf16 v[252:255], a[116:119], v[92:95], v[252:255]
    ds_write_b64 v26, v[40:41] offset:2048
    v_cvt_pk_bf16_f32 v42, v44, v45
    v_cvt_pk_bf16_f32 v43, v46, v47
    ds_write_b64 v27, v[42:43] offset:2048
    ds_read_b128 a[80:83], v21 offset:2048
    ds_read_b128 a[84:87], v21 offset:3072
    v_mul_f32 v240, v240, v22
    v_mul_f32 v241, v241, v22
    v_mul_f32 v242, v242, v22
    v_mul_f32 v243, v243, v22
    v_mul_f32 v244, v244, v22
    v_mul_f32 v245, v245, v22
    v_mul_f32 v246, v246, v22
    v_mul_f32 v247, v247, v22
    v_cvt_pk_bf16_f32 v240, v240, v241
    v_cvt_pk_bf16_f32 v241, v242, v243
    ds_write_b64 v23, v[240:241] offset:0
    v_cvt_pk_bf16_f32 v242, v244, v245
    v_cvt_pk_bf16_f32 v243, v246, v247
    ds_write_b64 v25, v[242:243] offset:0
    s_waitcnt lgkmcnt(3)
    buffer_store_dwordx4 a[80:83], v14, s[24:27], 0 offen offset:384 nt
    v_pk_mul_f32 v[248:249], v[248:249], v[22:23] op_sel_hi:[1,0]
    v_pk_mul_f32 v[250:251], v[250:251], v[22:23] op_sel_hi:[1,0]
    s_waitcnt lgkmcnt(2)
    buffer_store_dwordx4 a[84:87], v15, s[24:27], 0 offen offset:384 nt
    v_pk_mul_f32 v[252:253], v[252:253], v[22:23] op_sel_hi:[1,0]
    v_pk_mul_f32 v[254:255], v[254:255], v[22:23] op_sel_hi:[1,0]
    v_cvt_pk_bf16_f32 v248, v248, v249
    v_cvt_pk_bf16_f32 v249, v250, v251
    ds_write_b64 v26, v[248:249] offset:0
    v_cvt_pk_bf16_f32 v250, v252, v253
    v_cvt_pk_bf16_f32 v251, v254, v255
    ds_write_b64 v27, v[250:251] offset:0
    ds_read_b128 a[88:91], v21 offset:0
    ds_read_b128 a[92:95], v21 offset:1024
    s_waitcnt lgkmcnt(1)
    buffer_store_dwordx4 a[88:91], v12, s[24:27], 0 offen offset:384 nt
    s_waitcnt lgkmcnt(0)
    buffer_store_dwordx4 a[92:95], v13, s[24:27], 0 offen offset:384 nt
    s_cmp_lg_u64 s[40:41], 0
    s_cbranch_scc1 L_fallback
    s_endpgm
L_mainend:
L_fallback:
    s_waitcnt vmcnt(0) lgkmcnt(0)
    s_barrier
    s_mul_i32 s35, s36, 40960
    v_and_b32 v104, 63, v0
    v_bfe_u32 v106, v104, 2, 2
    v_lshlrev_b32 v106, 9, v106
    v_lshrrev_b32 v109, 4, v104
    v_lshl_add_u32 v106, v109, 6, v106
    v_and_b32 v107, 3, v104
    v_xor_b32 v108, 0, v107
    v_lshl_add_u32 v80, v108, 4, v106
    v_add_u32 v80, 0, v80
    v_xor_b32 v108, 0, v107
    v_lshl_add_u32 v84, v108, 4, v106
    v_add_u32 v84, 0, v84
    v_xor_b32 v108, 2, v107
    v_lshl_add_u32 v81, v108, 4, v106
    v_add_u32 v81, 2048, v81
    v_xor_b32 v108, 2, v107
    v_lshl_add_u32 v85, v108, 4, v106
    v_add_u32 v85, 2048, v85
    v_xor_b32 v108, 3, v107
    v_lshl_add_u32 v82, v108, 4, v106
    v_add_u32 v82, 4096, v82
    v_xor_b32 v108, 0, v107
    v_lshl_add_u32 v86, v108, 4, v106
    v_add_u32 v86, 4096, v86
    v_xor_b32 v108, 1, v107
    v_lshl_add_u32 v83, v108, 4, v106
    v_add_u32 v83, 6144, v83
    v_xor_b32 v108, 2, v107
    v_lshl_add_u32 v87, v108, 4, v106
    v_add_u32 v87, 6144, v87
    v_add_u32 v88, s35, v1
    v_add_u32 v89, s35, v4
    v_add_u32 v90, s35, v7
    v_and_b32 v110, 15, v104
    s_mul_i32 s33, s36, 48
    v_add_u32 v110, s33, v110
    v_lshlrev_b32 v110, 9, v110
    v_and_b32 v111, 1, v109
    v_lshl_add_u32 v110, v111, 5, v110
    v_lshrrev_b32 v111, 1, v109
    v_lshl_add_u32 v91, v111, 4, v110
    v_add_u32 v92, 8192, v91
    v_add_u32 v93, 16384, v91
    s_mul_i32 s34, s36, 24576
    v_add_u32 v112, s34, v80
    v_add_u32 v112, 0, v112
    s_add_u32 m0, s35, 0
    s_nop 0
    buffer_load_dwordx4 v112, s[12:15], 0 offen offset:0 lds
    s_add_u32 m0, s35, 3840
    s_nop 0
    buffer_load_dwordx4 v112, s[12:15], 0 offen offset:256 lds
    v_add_u32 v112, s34, v81
    v_add_u32 v112, 0, v112
    s_add_u32 m0, s35, 1024
    s_nop 0
    buffer_load_dwordx4 v112, s[12:15], 0 offen offset:0 lds
    s_add_u32 m0, s35, 4864
    s_nop 0
    buffer_load_dwordx4 v112, s[12:15], 0 offen offset:256 lds
    v_add_u32 v112, s34, v82
    v_add_u32 v112, 0, v112
    s_add_u32 m0, s35, 2048
    s_nop 0
    buffer_load_dwordx4 v112, s[12:15], 0 offen offset:0 lds
    s_add_u32 m0, s35, 5888
    s_nop 0
    buffer_load_dwordx4 v112, s[12:15], 0 offen offset:256 lds
    v_add_u32 v112, s34, v83
    v_add_u32 v112, 0, v112
    s_add_u32 m0, s35, 3072
    s_nop 0
    buffer_load_dwordx4 v112, s[12:15], 0 offen offset:0 lds
    s_add_u32 m0, s35, 6912
    s_nop 0
    buffer_load_dwordx4 v112, s[12:15], 0 offen offset:256 lds
    s_waitcnt vmcnt(0)
    ds_read_b128 a[64:67], v88 offset:0
    ds_read_b128 a[68:71], v88 offset:256
    ds_read_b128 a[72:75], v88 offset:512
    ds_read_b128 a[76:79], v88 offset:768
    ds_read_b128 a[80:83], v88 offset:4096
    ds_read_b128 a[84:87], v88 offset:4352
    ds_read_b128 a[88:91], v88 offset:4608
    ds_read_b128 a[92:95], v88 offset:4864
    s_waitcnt lgkmcnt(0)
    v_add_u32 v112, s34, v80
    v_add_u32 v112, 8192, v112
    s_add_u32 m0, s35, 0
    s_nop 0
    buffer_load_dwordx4 v112, s[12:15], 0 offen offset:0 lds
    s_add_u32 m0, s35, 3840
    s_nop 0
    buffer_load_dwordx4 v112, s[12:15], 0 offen offset:256 lds
    v_add_u32 v112, s34, v81
    v_add_u32 v112, 8192, v112
    s_add_u32 m0, s35, 1024
    s_nop 0
    buffer_load_dwordx4 v112, s[12:15], 0 offen offset:0 lds
    s_add_u32 m0, s35, 4864
    s_nop 0
    buffer_load_dwordx4 v112, s[12:15], 0 offen offset:256 lds
    v_add_u32 v112, s34, v82
    v_add_u32 v112, 8192, v112
    s_add_u32 m0, s35, 2048
    s_nop 0
    buffer_load_dwordx4 v112, s[12:15], 0 offen offset:0 lds
    s_add_u32 m0, s35, 5888
    s_nop 0
    buffer_load_dwordx4 v112, s[12:15], 0 offen offset:256 lds
    v_add_u32 v112, s34, v83
    v_add_u32 v112, 8192, v112
    s_add_u32 m0, s35, 3072
    s_nop 0
    buffer_load_dwordx4 v112, s[12:15], 0 offen offset:0 lds
    s_add_u32 m0, s35, 6912
    s_nop 0
    buffer_load_dwordx4 v112, s[12:15], 0 offen offset:256 lds
    s_waitcnt vmcnt(0)
    ds_read_b128 a[96:99], v88 offset:0
    ds_read_b128 a[100:103], v88 offset:256
    ds_read_b128 a[104:107], v88 offset:512
    ds_read_b128 a[108:111], v88 offset:768
    ds_read_b128 a[112:115], v88 offset:4096
    ds_read_b128 a[116:119], v88 offset:4352
    ds_read_b128 a[120:123], v88 offset:4608
    ds_read_b128 a[124:127], v88 offset:4864
    s_waitcnt lgkmcnt(0)
    v_add_u32 v112, s34, v80
    v_add_u32 v112, 16384, v112
    s_add_u32 m0, s35, 0
    s_nop 0
    buffer_load_dwordx4 v112, s[12:15], 0 offen offset:0 lds
    s_add_u32 m0, s35, 3840
    s_nop 0
    buffer_load_dwordx4 v112, s[12:15], 0 offen offset:256 lds
    v_add_u32 v112, s34, v81
    v_add_u32 v112, 16384, v112
    s_add_u32 m0, s35, 1024
    s_nop 0
    buffer_load_dwordx4 v112, s[12:15], 0 offen offset:0 lds
    s_add_u32 m0, s35, 4864
    s_nop 0
    buffer_load_dwordx4 v112, s[12:15], 0 offen offset:256 lds
    v_add_u32 v112, s34, v82
    v_add_u32 v112, 16384, v112
    s_add_u32 m0, s35, 2048
    s_nop 0
    buffer_load_dwordx4 v112, s[12:15], 0 offen offset:0 lds
    s_add_u32 m0, s35, 5888
    s_nop 0
    buffer_load_dwordx4 v112, s[12:15], 0 offen offset:256 lds
    v_add_u32 v112, s34, v83
    v_add_u32 v112, 16384, v112
    s_add_u32 m0, s35, 3072
    s_nop 0
    buffer_load_dwordx4 v112, s[12:15], 0 offen offset:0 lds
    s_add_u32 m0, s35, 6912
    s_nop 0
    buffer_load_dwordx4 v112, s[12:15], 0 offen offset:256 lds
    s_waitcnt vmcnt(0)
    ds_read_b128 a[128:131], v88 offset:0
    ds_read_b128 a[132:135], v88 offset:256
    ds_read_b128 a[136:139], v88 offset:512
    ds_read_b128 a[140:143], v88 offset:768
    ds_read_b128 a[144:147], v88 offset:4096
    ds_read_b128 a[148:151], v88 offset:4352
    ds_read_b128 a[152:155], v88 offset:4608
    ds_read_b128 a[156:159], v88 offset:4864
    s_waitcnt lgkmcnt(0)
    v_mov_b32 v20, 0xff800000
    v_mov_b32 v22, 0xff800000
    v_mov_b32 v24, 0xff800000
    s_mov_b32 s32, 0
L_fb1:
    s_add_u32 s33, s32, 0
    s_add_u32 m0, s35, 0
    s_nop 0
    buffer_load_dwordx4 v80, s[16:19], s33 offen offset:0 lds
    s_add_u32 m0, s35, 1024
    s_nop 0
    buffer_load_dwordx4 v81, s[16:19], s33 offen offset:0 lds
    s_add_u32 m0, s35, 2048
    s_nop 0
    buffer_load_dwordx4 v82, s[16:19], s33 offen offset:0 lds
    s_add_u32 m0, s35, 3072
    s_nop 0
    buffer_load_dwordx4 v83, s[16:19], s33 offen offset:0 lds
    s_add_u32 m0, s35, 3840
    s_nop 0
    buffer_load_dwordx4 v80, s[16:19], s33 offen offset:256 lds
    s_add_u32 m0, s35, 4864
    s_nop 0
    buffer_load_dwordx4 v81, s[16:19], s33 offen offset:256 lds
    s_add_u32 m0, s35, 5888
    s_nop 0
    buffer_load_dwordx4 v82, s[16:19], s33 offen offset:256 lds
    s_add_u32 m0, s35, 6912
    s_nop 0
    buffer_load_dwordx4 v83, s[16:19], s33 offen offset:256 lds
    s_add_u32 s33, s32, 8192
    s_add_u32 m0, s35, 8192
    s_nop 0
    buffer_load_dwordx4 v80, s[16:19], s33 offen offset:0 lds
    s_add_u32 m0, s35, 9216
    s_nop 0
    buffer_load_dwordx4 v81, s[16:19], s33 offen offset:0 lds
    s_add_u32 m0, s35, 10240
    s_nop 0
    buffer_load_dwordx4 v82, s[16:19], s33 offen offset:0 lds
    s_add_u32 m0, s35, 11264
    s_nop 0
    buffer_load_dwordx4 v83, s[16:19], s33 offen offset:0 lds
    s_add_u32 m0, s35, 12032
    s_nop 0
    buffer_load_dwordx4 v80, s[16:19], s33 offen offset:256 lds
    s_add_u32 m0, s35, 13056
    s_nop 0
    buffer_load_dwordx4 v81, s[16:19], s33 offen offset:256 lds
    s_add_u32 m0, s35, 14080
    s_nop 0
    buffer_load_dwordx4 v82, s[16:19], s33 offen offset:256 lds
    s_add_u32 m0, s35, 15104
    s_nop 0
    buffer_load_dwordx4 v83, s[16:19], s33 offen offset:256 lds
    s_waitcnt vmcnt(0)
    ds_read_b128 a[160:163], v88 offset:0
    ds_read_b128 a[164:167], v88 offset:256
    ds_read_b128 a[168:171], v88 offset:512
    ds_read_b128 a[172:175], v88 offset:768
    ds_read_b128 a[176:179], v88 offset:4096
    ds_read_b128 a[180:183], v88 offset:4352
    ds_read_b128 a[184:187], v88 offset:4608
    ds_read_b128 a[188:191], v88 offset:4864
    s_waitcnt lgkmcnt(0)
    v_mfma_f32_16x16x32_bf16 v[32:35], a[160:163], a[64:67], 0
    v_mfma_f32_16x16x32_bf16 v[32:35], a[164:167], a[68:71], v[32:35]
    v_mfma_f32_16x16x32_bf16 v[32:35], a[168:171], a[72:75], v[32:35]
    v_mfma_f32_16x16x32_bf16 v[32:35], a[172:175], a[76:79], v[32:35]
    v_mfma_f32_16x16x32_bf16 v[32:35], a[176:179], a[80:83], v[32:35]
    v_mfma_f32_16x16x32_bf16 v[32:35], a[180:183], a[84:87], v[32:35]
    v_mfma_f32_16x16x32_bf16 v[32:35], a[184:187], a[88:91], v[32:35]
    v_mfma_f32_16x16x32_bf16 v[32:35], a[188:191], a[92:95], v[32:35]
    v_mfma_f32_16x16x32_bf16 v[36:39], a[160:163], a[96:99], 0
    v_mfma_f32_16x16x32_bf16 v[36:39], a[164:167], a[100:103], v[36:39]
    v_mfma_f32_16x16x32_bf16 v[36:39], a[168:171], a[104:107], v[36:39]
    v_mfma_f32_16x16x32_bf16 v[36:39], a[172:175], a[108:111], v[36:39]
    v_mfma_f32_16x16x32_bf16 v[36:39], a[176:179], a[112:115], v[36:39]
    v_mfma_f32_16x16x32_bf16 v[36:39], a[180:183], a[116:119], v[36:39]
    v_mfma_f32_16x16x32_bf16 v[36:39], a[184:187], a[120:123], v[36:39]
    v_mfma_f32_16x16x32_bf16 v[36:39], a[188:191], a[124:127], v[36:39]
    v_mfma_f32_16x16x32_bf16 v[40:43], a[160:163], a[128:131], 0
    v_mfma_f32_16x16x32_bf16 v[40:43], a[164:167], a[132:135], v[40:43]
    v_mfma_f32_16x16x32_bf16 v[40:43], a[168:171], a[136:139], v[40:43]
    v_mfma_f32_16x16x32_bf16 v[40:43], a[172:175], a[140:143], v[40:43]
    v_mfma_f32_16x16x32_bf16 v[40:43], a[176:179], a[144:147], v[40:43]
    v_mfma_f32_16x16x32_bf16 v[40:43], a[180:183], a[148:151], v[40:43]
    v_mfma_f32_16x16x32_bf16 v[40:43], a[184:187], a[152:155], v[40:43]
    v_mfma_f32_16x16x32_bf16 v[40:43], a[188:191], a[156:159], v[40:43]
    s_nop 15
    v_max3_f32 v20, v20, v32, v33
    v_max3_f32 v20, v20, v34, v35
    v_max3_f32 v22, v22, v36, v37
    v_max3_f32 v22, v22, v38, v39
    v_max3_f32 v24, v24, v40, v41
    v_max3_f32 v24, v24, v42, v43
    ds_read_b128 a[160:163], v88 offset:8192
    ds_read_b128 a[164:167], v88 offset:8448
    ds_read_b128 a[168:171], v88 offset:8704
    ds_read_b128 a[172:175], v88 offset:8960
    ds_read_b128 a[176:179], v88 offset:12288
    ds_read_b128 a[180:183], v88 offset:12544
    ds_read_b128 a[184:187], v88 offset:12800
    ds_read_b128 a[188:191], v88 offset:13056
    s_waitcnt lgkmcnt(0)
    v_mfma_f32_16x16x32_bf16 v[32:35], a[160:163], a[64:67], 0
    v_mfma_f32_16x16x32_bf16 v[32:35], a[164:167], a[68:71], v[32:35]
    v_mfma_f32_16x16x32_bf16 v[32:35], a[168:171], a[72:75], v[32:35]
    v_mfma_f32_16x16x32_bf16 v[32:35], a[172:175], a[76:79], v[32:35]
    v_mfma_f32_16x16x32_bf16 v[32:35], a[176:179], a[80:83], v[32:35]
    v_mfma_f32_16x16x32_bf16 v[32:35], a[180:183], a[84:87], v[32:35]
    v_mfma_f32_16x16x32_bf16 v[32:35], a[184:187], a[88:91], v[32:35]
    v_mfma_f32_16x16x32_bf16 v[32:35], a[188:191], a[92:95], v[32:35]
    v_mfma_f32_16x16x32_bf16 v[36:39], a[160:163], a[96:99], 0
    v_mfma_f32_16x16x32_bf16 v[36:39], a[164:167], a[100:103], v[36:39]
    v_mfma_f32_16x16x32_bf16 v[36:39], a[168:171], a[104:107], v[36:39]
    v_mfma_f32_16x16x32_bf16 v[36:39], a[172:175], a[108:111], v[36:39]
    v_mfma_f32_16x16x32_bf16 v[36:39], a[176:179], a[112:115], v[36:39]
    v_mfma_f32_16x16x32_bf16 v[36:39], a[180:183], a[116:119], v[36:39]
    v_mfma_f32_16x16x32_bf16 v[36:39], a[184:187], a[120:123], v[36:39]
    v_mfma_f32_16x16x32_bf16 v[36:39], a[188:191], a[124:127], v[36:39]
    v_mfma_f32_16x16x32_bf16 v[40:43], a[160:163], a[128:131], 0
    v_mfma_f32_16x16x32_bf16 v[40:43], a[164:167], a[132:135], v[40:43]
    v_mfma_f32_16x16x32_bf16 v[40:43], a[168:171], a[136:139], v[40:43]
    v_mfma_f32_16x16x32_bf16 v[40:43], a[172:175], a[140:143], v[40:43]
    v_mfma_f32_16x16x32_bf16 v[40:43], a[176:179], a[144:147], v[40:43]
    v_mfma_f32_16x16x32_bf16 v[40:43], a[180:183], a[148:151], v[40:43]
    v_mfma_f32_16x16x32_bf16 v[40:43], a[184:187], a[152:155], v[40:43]
    v_mfma_f32_16x16x32_bf16 v[40:43], a[188:191], a[156:159], v[40:43]
    s_nop 15
    v_max3_f32 v20, v20, v32, v33
    v_max3_f32 v20, v20, v34, v35
    v_max3_f32 v22, v22, v36, v37
    v_max3_f32 v22, v22, v38, v39
    v_max3_f32 v24, v24, v40, v41
    v_max3_f32 v24, v24, v42, v43
    s_add_u32 s32, s32, 16384
    s_cmp_lt_u32 s32, 262144
    s_cbranch_scc1 L_fb1
    s_nop 1
    v_mov_b32 v108, v20
    s_nop 1
    v_permlane32_swap_b32 v20, v108
    s_nop 1
    v_max_f32 v20, v20, v108
    s_nop 1
    v_mov_b32 v108, v20
    s_nop 1
    v_permlane16_swap_b32 v20, v108
    s_nop 1
    v_max_f32 v20, v20, v108
    v_mul_f32 v20, 0xbdb8aa3b, v20
    v_mov_b32 v16, 0
    s_nop 1
    v_mov_b32 v108, v22
    s_nop 1
    v_permlane32_swap_b32 v22, v108
    s_nop 1
    v_max_f32 v22, v22, v108
    s_nop 1
    v_mov_b32 v108, v22
    s_nop 1
    v_permlane16_swap_b32 v22, v108
    s_nop 1
    v_max_f32 v22, v22, v108
    v_mul_f32 v22, 0xbdb8aa3b, v22
    v_mov_b32 v17, 0
    s_nop 1
    v_mov_b32 v108, v24
    s_nop 1
    v_permlane32_swap_b32 v24, v108
    s_nop 1
    v_max_f32 v24, v24, v108
    s_nop 1
    v_mov_b32 v108, v24
    s_nop 1
    v_permlane16_swap_b32 v24, v108
    s_nop 1
    v_max_f32 v24, v24, v108
    v_mul_f32 v24, 0xbdb8aa3b, v24
    v_mov_b32 v18, 0
    v_mov_b32 v128, 0
    v_mov_b32 v129, 0
    v_mov_b32 v130, 0
    v_mov_b32 v131, 0
    v_mov_b32 v132, 0
    v_mov_b32 v133, 0
    v_mov_b32 v134, 0
    v_mov_b32 v135, 0
    v_mov_b32 v136, 0
    v_mov_b32 v137, 0
    v_mov_b32 v138, 0
    v_mov_b32 v139, 0
    v_mov_b32 v140, 0
    v_mov_b32 v141, 0
    v_mov_b32 v142, 0
    v_mov_b32 v143, 0
    v_mov_b32 v144, 0
    v_mov_b32 v145, 0
    v_mov_b32 v146, 0
    v_mov_b32 v147, 0
    v_mov_b32 v148, 0
    v_mov_b32 v149, 0
    v_mov_b32 v150, 0
    v_mov_b32 v151, 0
    v_mov_b32 v152, 0
    v_mov_b32 v153, 0
    v_mov_b32 v154, 0
    v_mov_b32 v155, 0
    v_mov_b32 v156, 0
    v_mov_b32 v157, 0
    v_mov_b32 v158, 0
    v_mov_b32 v159, 0
    v_mov_b32 v160, 0
    v_mov_b32 v161, 0
    v_mov_b32 v162, 0
    v_mov_b32 v163, 0
    v_mov_b32 v164, 0
    v_mov_b32 v165, 0
    v_mov_b32 v166, 0
    v_mov_b32 v167, 0
    v_mov_b32 v168, 0
    v_mov_b32 v169, 0
    v_mov_b32 v170, 0
    v_mov_b32 v171, 0
    v_mov_b32 v172, 0
    v_mov_b32 v173, 0
    v_mov_b32 v174, 0
    v_mov_b32 v175, 0
    v_mov_b32 v176, 0
    v_mov_b32 v177, 0
    v_mov_b32 v178, 0
    v_mov_b32 v179, 0
    v_mov_b32 v180, 0
    v_mov_b32 v181, 0
    v_mov_b32 v182, 0
    v_mov_b32 v183, 0
    v_mov_b32 v184, 0
    v_mov_b32 v185, 0
    v_mov_b32 v186, 0
    v_mov_b32 v187, 0
    v_mov_b32 v188, 0
    v_mov_b32 v189, 0
    v_mov_b32 v190, 0
    v_mov_b32 v191, 0
    v_mov_b32 v192, 0
    v_mov_b32 v193, 0
    v_mov_b32 v194, 0
    v_mov_b32 v195, 0
    v_mov_b32 v196, 0
    v_mov_b32 v197, 0
    v_mov_b32 v198, 0
    v_mov_b32 v199, 0
    v_mov_b32 v200, 0
    v_mov_b32 v201, 0
    v_mov_b32 v202, 0
    v_mov_b32 v203, 0
    v_mov_b32 v204, 0
    v_mov_b32 v205, 0
    v_mov_b32 v206, 0
    v_mov_b32 v207, 0
    v_mov_b32 v208, 0
    v_mov_b32 v209, 0
    v_mov_b32 v210, 0
    v_mov_b32 v211, 0
    v_mov_b32 v212, 0
    v_mov_b32 v213, 0
    v_mov_b32 v214, 0
    v_mov_b32 v215, 0
    v_mov_b32 v216, 0
    v_mov_b32 v217, 0
    v_mov_b32 v218, 0
    v_mov_b32 v219, 0
    v_mov_b32 v220, 0
    v_mov_b32 v221, 0
    v_mov_b32 v222, 0
    v_mov_b32 v223, 0
    v_mov_b32 v224, 0
    v_mov_b32 v225, 0
    v_mov_b32 v226, 0
    v_mov_b32 v227, 0
    v_mov_b32 v228, 0
    v_mov_b32 v229, 0
    v_mov_b32 v230, 0
    v_mov_b32 v231, 0
    v_mov_b32 v232, 0
    v_mov_b32 v233, 0
    v_mov_b32 v234, 0
    v_mov_b32 v235, 0
    v_mov_b32 v236, 0
    v_mov_b32 v237, 0
    v_mov_b32 v238, 0
    v_mov_b32 v239, 0
    v_mov_b32 v240, 0
    v_mov_b32 v241, 0
    v_mov_b32 v242, 0
    v_mov_b32 v243, 0
    v_mov_b32 v244, 0
    v_mov_b32 v245, 0
    v_mov_b32 v246, 0
    v_mov_b32 v247, 0
    v_mov_b32 v248, 0
    v_mov_b32 v249, 0
    v_mov_b32 v250, 0
    v_mov_b32 v251, 0
    v_mov_b32 v252, 0
    v_mov_b32 v253, 0
    v_mov_b32 v254, 0
    v_mov_b32 v255, 0
    v_accvgpr_write_b32 a0, 0
    v_accvgpr_write_b32 a1, 0
    v_accvgpr_write_b32 a2, 0
    v_accvgpr_write_b32 a3, 0
    v_accvgpr_write_b32 a4, 0
    v_accvgpr_write_b32 a5, 0
    v_accvgpr_write_b32 a6, 0
    v_accvgpr_write_b32 a7, 0
    v_accvgpr_write_b32 a8, 0
    v_accvgpr_write_b32 a9, 0
    v_accvgpr_write_b32 a10, 0
    v_accvgpr_write_b32 a11, 0
    v_accvgpr_write_b32 a12, 0
    v_accvgpr_write_b32 a13, 0
    v_accvgpr_write_b32 a14, 0
    v_accvgpr_write_b32 a15, 0
    v_accvgpr_write_b32 a16, 0
    v_accvgpr_write_b32 a17, 0
    v_accvgpr_write_b32 a18, 0
    v_accvgpr_write_b32 a19, 0
    v_accvgpr_write_b32 a20, 0
    v_accvgpr_write_b32 a21, 0
    v_accvgpr_write_b32 a22, 0
    v_accvgpr_write_b32 a23, 0
    v_accvgpr_write_b32 a24, 0
    v_accvgpr_write_b32 a25, 0
    v_accvgpr_write_b32 a26, 0
    v_accvgpr_write_b32 a27, 0
    v_accvgpr_write_b32 a28, 0
    v_accvgpr_write_b32 a29, 0
    v_accvgpr_write_b32 a30, 0
    v_accvgpr_write_b32 a31, 0
    v_accvgpr_write_b32 a32, 0
    v_accvgpr_write_b32 a33, 0
    v_accvgpr_write_b32 a34, 0
    v_accvgpr_write_b32 a35, 0
    v_accvgpr_write_b32 a36, 0
    v_accvgpr_write_b32 a37, 0
    v_accvgpr_write_b32 a38, 0
    v_accvgpr_write_b32 a39, 0
    v_accvgpr_write_b32 a40, 0
    v_accvgpr_write_b32 a41, 0
    v_accvgpr_write_b32 a42, 0
    v_accvgpr_write_b32 a43, 0
    v_accvgpr_write_b32 a44, 0
    v_accvgpr_write_b32 a45, 0
    v_accvgpr_write_b32 a46, 0
    v_accvgpr_write_b32 a47, 0
    v_accvgpr_write_b32 a48, 0
    v_accvgpr_write_b32 a49, 0
    v_accvgpr_write_b32 a50, 0
    v_accvgpr_write_b32 a51, 0
    v_accvgpr_write_b32 a52, 0
    v_accvgpr_write_b32 a53, 0
    v_accvgpr_write_b32 a54, 0
    v_accvgpr_write_b32 a55, 0
    v_accvgpr_write_b32 a56, 0
    v_accvgpr_write_b32 a57, 0
    v_accvgpr_write_b32 a58, 0
    v_accvgpr_write_b32 a59, 0
    v_accvgpr_write_b32 a60, 0
    v_accvgpr_write_b32 a61, 0
    v_accvgpr_write_b32 a62, 0
    v_accvgpr_write_b32 a63, 0
    s_mov_b32 s32, 0
L_fb2:
    s_add_u32 s33, s32, 0
    s_add_u32 m0, s35, 0
    s_nop 0
    buffer_load_dwordx4 v80, s[16:19], s33 offen offset:0 lds
    s_add_u32 m0, s35, 1024
    s_nop 0
    buffer_load_dwordx4 v81, s[16:19], s33 offen offset:0 lds
    s_add_u32 m0, s35, 2048
    s_nop 0
    buffer_load_dwordx4 v82, s[16:19], s33 offen offset:0 lds
    s_add_u32 m0, s35, 3072
    s_nop 0
    buffer_load_dwordx4 v83, s[16:19], s33 offen offset:0 lds
    s_add_u32 m0, s35, 3840
    s_nop 0
    buffer_load_dwordx4 v80, s[16:19], s33 offen offset:256 lds
    s_add_u32 m0, s35, 4864
    s_nop 0
    buffer_load_dwordx4 v81, s[16:19], s33 offen offset:256 lds
    s_add_u32 m0, s35, 5888
    s_nop 0
    buffer_load_dwordx4 v82, s[16:19], s33 offen offset:256 lds
    s_add_u32 m0, s35, 6912
    s_nop 0
    buffer_load_dwordx4 v83, s[16:19], s33 offen offset:256 lds
    s_add_u32 s33, s32, 8192
    s_add_u32 m0, s35, 8192
    s_nop 0
    buffer_load_dwordx4 v80, s[16:19], s33 offen offset:0 lds
    s_add_u32 m0, s35, 9216
    s_nop 0
    buffer_load_dwordx4 v81, s[16:19], s33 offen offset:0 lds
    s_add_u32 m0, s35, 10240
    s_nop 0
    buffer_load_dwordx4 v82, s[16:19], s33 offen offset:0 lds
    s_add_u32 m0, s35, 11264
    s_nop 0
    buffer_load_dwordx4 v83, s[16:19], s33 offen offset:0 lds
    s_add_u32 m0, s35, 12032
    s_nop 0
    buffer_load_dwordx4 v80, s[16:19], s33 offen offset:256 lds
    s_add_u32 m0, s35, 13056
    s_nop 0
    buffer_load_dwordx4 v81, s[16:19], s33 offen offset:256 lds
    s_add_u32 m0, s35, 14080
    s_nop 0
    buffer_load_dwordx4 v82, s[16:19], s33 offen offset:256 lds
    s_add_u32 m0, s35, 15104
    s_nop 0
    buffer_load_dwordx4 v83, s[16:19], s33 offen offset:256 lds
    s_add_u32 s33, s32, 0
    s_add_u32 m0, s35, 16384
    s_nop 0
    buffer_load_dwordx4 v84, s[20:23], s33 offen lds
    s_add_u32 m0, s35, 17408
    s_nop 0
    buffer_load_dwordx4 v85, s[20:23], s33 offen lds
    s_add_u32 m0, s35, 18432
    s_nop 0
    buffer_load_dwordx4 v86, s[20:23], s33 offen lds
    s_add_u32 m0, s35, 19456
    s_nop 0
    buffer_load_dwordx4 v87, s[20:23], s33 offen lds
    s_add_u32 s33, s32, 8192
    s_add_u32 m0, s35, 20480
    s_nop 0
    buffer_load_dwordx4 v84, s[20:23], s33 offen lds
    s_add_u32 m0, s35, 21504
    s_nop 0
    buffer_load_dwordx4 v85, s[20:23], s33 offen lds
    s_add_u32 m0, s35, 22528
    s_nop 0
    buffer_load_dwordx4 v86, s[20:23], s33 offen lds
    s_add_u32 m0, s35, 23552
    s_nop 0
    buffer_load_dwordx4 v87, s[20:23], s33 offen lds
    s_add_u32 s33, s32, 256
    s_add_u32 m0, s35, 24576
    s_nop 0
    buffer_load_dwordx4 v84, s[20:23], s33 offen lds
    s_add_u32 m0, s35, 25600
    s_nop 0
    buffer_load_dwordx4 v85, s[20:23], s33 offen lds
    s_add_u32 m0, s35, 26624
    s_nop 0
    buffer_load_dwordx4 v86, s[20:23], s33 offen lds
    s_add_u32 m0, s35, 27648
    s_nop 0
    buffer_load_dwordx4 v87, s[20:23], s33 offen lds
    s_add_u32 s33, s32, 8448
    s_add_u32 m0, s35, 28672
    s_nop 0
    buffer_load_dwordx4 v84, s[20:23], s33 offen lds
    s_add_u32 m0, s35, 29696
    s_nop 0
    buffer_load_dwordx4 v85, s[20:23], s33 offen lds
    s_add_u32 m0, s35, 30720
    s_nop 0
    buffer_load_dwordx4 v86, s[20:23], s33 offen lds
    s_add_u32 m0, s35, 31744
    s_nop 0
    buffer_load_dwordx4 v87, s[20:23], s33 offen lds
    s_waitcnt vmcnt(0)
    ds_read_b128 a[160:163], v88 offset:0
    ds_read_b128 a[164:167], v88 offset:256
    ds_read_b128 a[168:171], v88 offset:512
    ds_read_b128 a[172:175], v88 offset:768
    ds_read_b128 a[176:179], v88 offset:4096
    ds_read_b128 a[180:183], v88 offset:4352
    ds_read_b128 a[184:187], v88 offset:4608
    ds_read_b128 a[188:191], v88 offset:4864
    s_waitcnt lgkmcnt(0)
    v_mfma_f32_16x16x32_bf16 v[32:35], a[160:163], a[64:67], 0
    v_mfma_f32_16x16x32_bf16 v[32:35], a[164:167], a[68:71], v[32:35]
    v_mfma_f32_16x16x32_bf16 v[32:35], a[168:171], a[72:75], v[32:35]
    v_mfma_f32_16x16x32_bf16 v[32:35], a[172:175], a[76:79], v[32:35]
    v_mfma_f32_16x16x32_bf16 v[32:35], a[176:179], a[80:83], v[32:35]
    v_mfma_f32_16x16x32_bf16 v[32:35], a[180:183], a[84:87], v[32:35]
    v_mfma_f32_16x16x32_bf16 v[32:35], a[184:187], a[88:91], v[32:35]
    v_mfma_f32_16x16x32_bf16 v[32:35], a[188:191], a[92:95], v[32:35]
    v_mfma_f32_16x16x32_bf16 v[36:39], a[160:163], a[96:99], 0
    v_mfma_f32_16x16x32_bf16 v[36:39], a[164:167], a[100:103], v[36:39]
    v_mfma_f32_16x16x32_bf16 v[36:39], a[168:171], a[104:107], v[36:39]
    v_mfma_f32_16x16x32_bf16 v[36:39], a[172:175], a[108:111], v[36:39]
    v_mfma_f32_16x16x32_bf16 v[36:39], a[176:179], a[112:115], v[36:39]
    v_mfma_f32_16x16x32_bf16 v[36:39], a[180:183], a[116:119], v[36:39]
    v_mfma_f32_16x16x32_bf16 v[36:39], a[184:187], a[120:123], v[36:39]
    v_mfma_f32_16x16x32_bf16 v[36:39], a[188:191], a[124:127], v[36:39]
    v_mfma_f32_16x16x32_bf16 v[40:43], a[160:163], a[128:131], 0
    v_mfma_f32_16x16x32_bf16 v[40:43], a[164:167], a[132:135], v[40:43]
    v_mfma_f32_16x16x32_bf16 v[40:43], a[168:171], a[136:139], v[40:43]
    v_mfma_f32_16x16x32_bf16 v[40:43], a[172:175], a[140:143], v[40:43]
    v_mfma_f32_16x16x32_bf16 v[40:43], a[176:179], a[144:147], v[40:43]
    v_mfma_f32_16x16x32_bf16 v[40:43], a[180:183], a[148:151], v[40:43]
    v_mfma_f32_16x16x32_bf16 v[40:43], a[184:187], a[152:155], v[40:43]
    v_mfma_f32_16x16x32_bf16 v[40:43], a[188:191], a[156:159], v[40:43]
    s_nop 15
    v_fma_f32 v32, v32, s29, v20
    v_fma_f32 v33, v33, s29, v20
    v_fma_f32 v34, v34, s29, v20
    v_fma_f32 v35, v35, s29, v20
    v_exp_f32 v32, v32
    v_exp_f32 v33, v33
    v_exp_f32 v34, v34
    v_exp_f32 v35, v35
    s_nop 1
    v_add_f32 v16, v16, v32
    v_add_f32 v16, v16, v33
    v_add_f32 v16, v16, v34
    v_add_f32 v16, v16, v35
    v_cvt_pk_bf16_f32 v56, v32, v33
    v_cvt_pk_bf16_f32 v57, v34, v35
    v_fma_f32 v36, v36, s29, v22
    v_fma_f32 v37, v37, s29, v22
    v_fma_f32 v38, v38, s29, v22
    v_fma_f32 v39, v39, s29, v22
    v_exp_f32 v36, v36
    v_exp_f32 v37, v37
    v_exp_f32 v38, v38
    v_exp_f32 v39, v39
    s_nop 1
    v_add_f32 v17, v17, v36
    v_add_f32 v17, v17, v37
    v_add_f32 v17, v17, v38
    v_add_f32 v17, v17, v39
    v_cvt_pk_bf16_f32 v64, v36, v37
    v_cvt_pk_bf16_f32 v65, v38, v39
    v_fma_f32 v40, v40, s29, v24
    v_fma_f32 v41, v41, s29, v24
    v_fma_f32 v42, v42, s29, v24
    v_fma_f32 v43, v43, s29, v24
    v_exp_f32 v40, v40
    v_exp_f32 v41, v41
    v_exp_f32 v42, v42
    v_exp_f32 v43, v43
    s_nop 1
    v_add_f32 v18, v18, v40
    v_add_f32 v18, v18, v41
    v_add_f32 v18, v18, v42
    v_add_f32 v18, v18, v43
    v_cvt_pk_bf16_f32 v72, v40, v41
    v_cvt_pk_bf16_f32 v73, v42, v43
    ds_read_b128 a[160:163], v88 offset:8192
    ds_read_b128 a[164:167], v88 offset:8448
    ds_read_b128 a[168:171], v88 offset:8704
    ds_read_b128 a[172:175], v88 offset:8960
    ds_read_b128 a[176:179], v88 offset:12288
    ds_read_b128 a[180:183], v88 offset:12544
    ds_read_b128 a[184:187], v88 offset:12800
    ds_read_b128 a[188:191], v88 offset:13056
    s_waitcnt lgkmcnt(0)
    v_mfma_f32_16x16x32_bf16 v[32:35], a[160:163], a[64:67], 0
    v_mfma_f32_16x16x32_bf16 v[32:35], a[164:167], a[68:71], v[32:35]
    v_mfma_f32_16x16x32_bf16 v[32:35], a[168:171], a[72:75], v[32:35]
    v_mfma_f32_16x16x32_bf16 v[32:35], a[172:175], a[76:79], v[32:35]
    v_mfma_f32_16x16x32_bf16 v[32:35], a[176:179], a[80:83], v[32:35]
    v_mfma_f32_16x16x32_bf16 v[32:35], a[180:183], a[84:87], v[32:35]
    v_mfma_f32_16x16x32_bf16 v[32:35], a[184:187], a[88:91], v[32:35]
    v_mfma_f32_16x16x32_bf16 v[32:35], a[188:191], a[92:95], v[32:35]
    v_mfma_f32_16x16x32_bf16 v[36:39], a[160:163], a[96:99], 0
    v_mfma_f32_16x16x32_bf16 v[36:39], a[164:167], a[100:103], v[36:39]
    v_mfma_f32_16x16x32_bf16 v[36:39], a[168:171], a[104:107], v[36:39]
    v_mfma_f32_16x16x32_bf16 v[36:39], a[172:175], a[108:111], v[36:39]
    v_mfma_f32_16x16x32_bf16 v[36:39], a[176:179], a[112:115], v[36:39]
    v_mfma_f32_16x16x32_bf16 v[36:39], a[180:183], a[116:119], v[36:39]
    v_mfma_f32_16x16x32_bf16 v[36:39], a[184:187], a[120:123], v[36:39]
    v_mfma_f32_16x16x32_bf16 v[36:39], a[188:191], a[124:127], v[36:39]
    v_mfma_f32_16x16x32_bf16 v[40:43], a[160:163], a[128:131], 0
    v_mfma_f32_16x16x32_bf16 v[40:43], a[164:167], a[132:135], v[40:43]
    v_mfma_f32_16x16x32_bf16 v[40:43], a[168:171], a[136:139], v[40:43]
    v_mfma_f32_16x16x32_bf16 v[40:43], a[172:175], a[140:143], v[40:43]
    v_mfma_f32_16x16x32_bf16 v[40:43], a[176:179], a[144:147], v[40:43]
    v_mfma_f32_16x16x32_bf16 v[40:43], a[180:183], a[148:151], v[40:43]
    v_mfma_f32_16x16x32_bf16 v[40:43], a[184:187], a[152:155], v[40:43]
    v_mfma_f32_16x16x32_bf16 v[40:43], a[188:191], a[156:159], v[40:43]
    s_nop 15
    v_fma_f32 v32, v32, s29, v20
    v_fma_f32 v33, v33, s29, v20
    v_fma_f32 v34, v34, s29, v20
    v_fma_f32 v35, v35, s29, v20
    v_exp_f32 v32, v32
    v_exp_f32 v33, v33
    v_exp_f32 v34, v34
    v_exp_f32 v35, v35
    s_nop 1
    v_add_f32 v16, v16, v32
    v_add_f32 v16, v16, v33
    v_add_f32 v16, v16, v34
    v_add_f32 v16, v16, v35
    v_cvt_pk_bf16_f32 v58, v32, v33
    v_cvt_pk_bf16_f32 v59, v34, v35
    v_fma_f32 v36, v36, s29, v22
    v_fma_f32 v37, v37, s29, v22
    v_fma_f32 v38, v38, s29, v22
    v_fma_f32 v39, v39, s29, v22
    v_exp_f32 v36, v36
    v_exp_f32 v37, v37
    v_exp_f32 v38, v38
    v_exp_f32 v39, v39
    s_nop 1
    v_add_f32 v17, v17, v36
    v_add_f32 v17, v17, v37
    v_add_f32 v17, v17, v38
    v_add_f32 v17, v17, v39
    v_cvt_pk_bf16_f32 v66, v36, v37
    v_cvt_pk_bf16_f32 v67, v38, v39
    v_fma_f32 v40, v40, s29, v24
    v_fma_f32 v41, v41, s29, v24
    v_fma_f32 v42, v42, s29, v24
    v_fma_f32 v43, v43, s29, v24
    v_exp_f32 v40, v40
    v_exp_f32 v41, v41
    v_exp_f32 v42, v42
    v_exp_f32 v43, v43
    s_nop 1
    v_add_f32 v18, v18, v40
    v_add_f32 v18, v18, v41
    v_add_f32 v18, v18, v42
    v_add_f32 v18, v18, v43
    v_cvt_pk_bf16_f32 v74, v40, v41
    v_cvt_pk_bf16_f32 v75, v42, v43
    s_nop 3
    ds_read_b64_tr_b16 a[192:193], v89 offset:16384
    ds_read_b64_tr_b16 a[194:195], v89 offset:20480
    s_waitcnt lgkmcnt(0)
    v_mfma_f32_16x16x32_bf16 v[128:131], a[192:195], v[56:59], v[128:131]
    v_mfma_f32_16x16x32_bf16 v[192:195], a[192:195], v[64:67], v[192:195]
    v_mfma_f32_16x16x32_bf16 a[0:3], a[192:195], v[72:75], a[0:3]
    ds_read_b64_tr_b16 a[200:201], v90 offset:16384
    ds_read_b64_tr_b16 a[202:203], v90 offset:20480
    s_waitcnt lgkmcnt(0)
    v_mfma_f32_16x16x32_bf16 v[132:135], a[200:203], v[56:59], v[132:135]
    v_mfma_f32_16x16x32_bf16 v[196:199], a[200:203], v[64:67], v[196:199]
    v_mfma_f32_16x16x32_bf16 a[4:7], a[200:203], v[72:75], a[4:7]
    ds_read_b64_tr_b16 a[192:193], v89 offset:16640
    ds_read_b64_tr_b16 a[194:195], v89 offset:20736
    s_waitcnt lgkmcnt(0)
    v_mfma_f32_16x16x32_bf16 v[136:139], a[192:195], v[56:59], v[136:139]
    v_mfma_f32_16x16x32_bf16 v[200:203], a[192:195], v[64:67], v[200:203]
    v_mfma_f32_16x16x32_bf16 a[8:11], a[192:195], v[72:75], a[8:11]
    ds_read_b64_tr_b16 a[200:201], v90 offset:16640
    ds_read_b64_tr_b16 a[202:203], v90 offset:20736
    s_waitcnt lgkmcnt(0)
    v_mfma_f32_16x16x32_bf16 v[140:143], a[200:203], v[56:59], v[140:143]
    v_mfma_f32_16x16x32_bf16 v[204:207], a[200:203], v[64:67], v[204:207]
    v_mfma_f32_16x16x32_bf16 a[12:15], a[200:203], v[72:75], a[12:15]
    ds_read_b64_tr_b16 a[192:193], v89 offset:16896
    ds_read_b64_tr_b16 a[194:195], v89 offset:20992
    s_waitcnt lgkmcnt(0)
    v_mfma_f32_16x16x32_bf16 v[144:147], a[192:195], v[56:59], v[144:147]
    v_mfma_f32_16x16x32_bf16 v[208:211], a[192:195], v[64:67], v[208:211]
    v_mfma_f32_16x16x32_bf16 a[16:19], a[192:195], v[72:75], a[16:19]
    ds_read_b64_tr_b16 a[200:201], v90 offset:16896
    ds_read_b64_tr_b16 a[202:203], v90 offset:20992
    s_waitcnt lgkmcnt(0)
    v_mfma_f32_16x16x32_bf16 v[148:151], a[200:203], v[56:59], v[148:151]
    v_mfma_f32_16x16x32_bf16 v[212:215], a[200:203], v[64:67], v[212:215]
    v_mfma_f32_16x16x32_bf16 a[20:23], a[200:203], v[72:75], a[20:23]
    ds_read_b64_tr_b16 a[192:193], v89 offset:17152
    ds_read_b64_tr_b16 a[194:195], v89 offset:21248
    s_waitcnt lgkmcnt(0)
    v_mfma_f32_16x16x32_bf16 v[152:155], a[192:195], v[56:59], v[152:155]
    v_mfma_f32_16x16x32_bf16 v[216:219], a[192:195], v[64:67], v[216:219]
    v_mfma_f32_16x16x32_bf16 a[24:27], a[192:195], v[72:75], a[24:27]
    ds_read_b64_tr_b16 a[200:201], v90 offset:17152
    ds_read_b64_tr_b16 a[202:203], v90 offset:21248
    s_waitcnt lgkmcnt(0)
    v_mfma_f32_16x16x32_bf16 v[156:159], a[200:203], v[56:59], v[156:159]
    v_mfma_f32_16x16x32_bf16 v[220:223], a[200:203], v[64:67], v[220:223]
    v_mfma_f32_16x16x32_bf16 a[28:31], a[200:203], v[72:75], a[28:31]
    ds_read_b64_tr_b16 a[192:193], v89 offset:24576
    ds_read_b64_tr_b16 a[194:195], v89 offset:28672
    s_waitcnt lgkmcnt(0)
    v_mfma_f32_16x16x32_bf16 v[160:163], a[192:195], v[56:59], v[160:163]
    v_mfma_f32_16x16x32_bf16 v[224:227], a[192:195], v[64:67], v[224:227]
    v_mfma_f32_16x16x32_bf16 a[32:35], a[192:195], v[72:75], a[32:35]
    ds_read_b64_tr_b16 a[200:201], v90 offset:24576
    ds_read_b64_tr_b16 a[202:203], v90 offset:28672
    s_waitcnt lgkmcnt(0)
    v_mfma_f32_16x16x32_bf16 v[164:167], a[200:203], v[56:59], v[164:167]
    v_mfma_f32_16x16x32_bf16 v[228:231], a[200:203], v[64:67], v[228:231]
    v_mfma_f32_16x16x32_bf16 a[36:39], a[200:203], v[72:75], a[36:39]
    ds_read_b64_tr_b16 a[192:193], v89 offset:24832
    ds_read_b64_tr_b16 a[194:195], v89 offset:28928
    s_waitcnt lgkmcnt(0)
    v_mfma_f32_16x16x32_bf16 v[168:171], a[192:195], v[56:59], v[168:171]
    v_mfma_f32_16x16x32_bf16 v[232:235], a[192:195], v[64:67], v[232:235]
    v_mfma_f32_16x16x32_bf16 a[40:43], a[192:195], v[72:75], a[40:43]
    ds_read_b64_tr_b16 a[200:201], v90 offset:24832
    ds_read_b64_tr_b16 a[202:203], v90 offset:28928
    s_waitcnt lgkmcnt(0)
    v_mfma_f32_16x16x32_bf16 v[172:175], a[200:203], v[56:59], v[172:175]
    v_mfma_f32_16x16x32_bf16 v[236:239], a[200:203], v[64:67], v[236:239]
    v_mfma_f32_16x16x32_bf16 a[44:47], a[200:203], v[72:75], a[44:47]
    ds_read_b64_tr_b16 a[192:193], v89 offset:25088
    ds_read_b64_tr_b16 a[194:195], v89 offset:29184
    s_waitcnt lgkmcnt(0)
    v_mfma_f32_16x16x32_bf16 v[176:179], a[192:195], v[56:59], v[176:179]
    v_mfma_f32_16x16x32_bf16 v[240:243], a[192:195], v[64:67], v[240:243]
    v_mfma_f32_16x16x32_bf16 a[48:51], a[192:195], v[72:75], a[48:51]
    ds_read_b64_tr_b16 a[200:201], v90 offset:25088
    ds_read_b64_tr_b16 a[202:203], v90 offset:29184
    s_waitcnt lgkmcnt(0)
    v_mfma_f32_16x16x32_bf16 v[180:183], a[200:203], v[56:59], v[180:183]
    v_mfma_f32_16x16x32_bf16 v[244:247], a[200:203], v[64:67], v[244:247]
    v_mfma_f32_16x16x32_bf16 a[52:55], a[200:203], v[72:75], a[52:55]
    ds_read_b64_tr_b16 a[192:193], v89 offset:25344
    ds_read_b64_tr_b16 a[194:195], v89 offset:29440
    s_waitcnt lgkmcnt(0)
    v_mfma_f32_16x16x32_bf16 v[184:187], a[192:195], v[56:59], v[184:187]
    v_mfma_f32_16x16x32_bf16 v[248:251], a[192:195], v[64:67], v[248:251]
    v_mfma_f32_16x16x32_bf16 a[56:59], a[192:195], v[72:75], a[56:59]
    ds_read_b64_tr_b16 a[200:201], v90 offset:25344
    ds_read_b64_tr_b16 a[202:203], v90 offset:29440
    s_waitcnt lgkmcnt(0)
    v_mfma_f32_16x16x32_bf16 v[188:191], a[200:203], v[56:59], v[188:191]
    v_mfma_f32_16x16x32_bf16 v[252:255], a[200:203], v[64:67], v[252:255]
    v_mfma_f32_16x16x32_bf16 a[60:63], a[200:203], v[72:75], a[60:63]
    s_nop 15
    s_add_u32 s32, s32, 16384
    s_cmp_lt_u32 s32, 262144
    s_cbranch_scc1 L_fb2
    s_nop 1
    v_mov_b32 v108, v16
    s_nop 1
    v_permlane32_swap_b32 v16, v108
    s_nop 1
    v_add_f32 v16, v16, v108
    s_nop 1
    v_mov_b32 v108, v16
    s_nop 1
    v_permlane16_swap_b32 v16, v108
    s_nop 1
    v_add_f32 v16, v16, v108
    v_rcp_f32 v20, v16
    s_nop 1
    v_mov_b32 v108, v17
    s_nop 1
    v_permlane32_swap_b32 v17, v108
    s_nop 1
    v_add_f32 v17, v17, v108
    s_nop 1
    v_mov_b32 v108, v17
    s_nop 1
    v_permlane16_swap_b32 v17, v108
    s_nop 1
    v_add_f32 v17, v17, v108
    v_rcp_f32 v22, v17
    s_nop 1
    v_mov_b32 v108, v18
    s_nop 1
    v_permlane32_swap_b32 v18, v108
    s_nop 1
    v_add_f32 v18, v18, v108
    s_nop 1
    v_mov_b32 v108, v18
    s_nop 1
    v_permlane16_swap_b32 v18, v108
    s_nop 1
    v_add_f32 v18, v18, v108
    v_rcp_f32 v24, v18
    s_nop 3
    v_mul_f32 v128, v128, v20
    v_mul_f32 v129, v129, v20
    v_mul_f32 v130, v130, v20
    v_mul_f32 v131, v131, v20
    v_mul_f32 v132, v132, v20
    v_mul_f32 v133, v133, v20
    v_mul_f32 v134, v134, v20
    v_mul_f32 v135, v135, v20
    v_cvt_pk_bf16_f32 v32, v128, v129
    v_cvt_pk_bf16_f32 v33, v130, v131
    v_cvt_pk_bf16_f32 v34, v132, v133
    v_cvt_pk_bf16_f32 v35, v134, v135
    s_nop 1
    v_permlane16_swap_b32 v32, v34
    v_permlane16_swap_b32 v33, v35
    buffer_store_dwordx4 v[32:35], v91, s[24:27], 0 offen offset:0
    v_mul_f32 v192, v192, v22
    v_mul_f32 v193, v193, v22
    v_mul_f32 v194, v194, v22
    v_mul_f32 v195, v195, v22
    v_mul_f32 v196, v196, v22
    v_mul_f32 v197, v197, v22
    v_mul_f32 v198, v198, v22
    v_mul_f32 v199, v199, v22
    v_cvt_pk_bf16_f32 v36, v192, v193
    v_cvt_pk_bf16_f32 v37, v194, v195
    v_cvt_pk_bf16_f32 v38, v196, v197
    v_cvt_pk_bf16_f32 v39, v198, v199
    s_nop 1
    v_permlane16_swap_b32 v36, v38
    v_permlane16_swap_b32 v37, v39
    buffer_store_dwordx4 v[36:39], v92, s[24:27], 0 offen offset:0
    v_accvgpr_read_b32 v96, a0
    v_accvgpr_read_b32 v97, a1
    v_accvgpr_read_b32 v98, a2
    v_accvgpr_read_b32 v99, a3
    v_accvgpr_read_b32 v100, a4
    v_accvgpr_read_b32 v101, a5
    v_accvgpr_read_b32 v102, a6
    v_accvgpr_read_b32 v103, a7
    v_mul_f32 v96, v96, v24
    v_mul_f32 v97, v97, v24
    v_mul_f32 v98, v98, v24
    v_mul_f32 v99, v99, v24
    v_mul_f32 v100, v100, v24
    v_mul_f32 v101, v101, v24
    v_mul_f32 v102, v102, v24
    v_mul_f32 v103, v103, v24
    v_cvt_pk_bf16_f32 v40, v96, v97
    v_cvt_pk_bf16_f32 v41, v98, v99
    v_cvt_pk_bf16_f32 v42, v100, v101
    v_cvt_pk_bf16_f32 v43, v102, v103
    s_nop 1
    v_permlane16_swap_b32 v40, v42
    v_permlane16_swap_b32 v41, v43
    buffer_store_dwordx4 v[40:43], v93, s[24:27], 0 offen offset:0
    v_mul_f32 v136, v136, v20
    v_mul_f32 v137, v137, v20
    v_mul_f32 v138, v138, v20
    v_mul_f32 v139, v139, v20
    v_mul_f32 v140, v140, v20
    v_mul_f32 v141, v141, v20
    v_mul_f32 v142, v142, v20
    v_mul_f32 v143, v143, v20
    v_cvt_pk_bf16_f32 v44, v136, v137
    v_cvt_pk_bf16_f32 v45, v138, v139
    v_cvt_pk_bf16_f32 v46, v140, v141
    v_cvt_pk_bf16_f32 v47, v142, v143
    s_nop 1
    v_permlane16_swap_b32 v44, v46
    v_permlane16_swap_b32 v45, v47
    buffer_store_dwordx4 v[44:47], v91, s[24:27], 0 offen offset:64
    v_mul_f32 v200, v200, v22
    v_mul_f32 v201, v201, v22
    v_mul_f32 v202, v202, v22
    v_mul_f32 v203, v203, v22
    v_mul_f32 v204, v204, v22
    v_mul_f32 v205, v205, v22
    v_mul_f32 v206, v206, v22
    v_mul_f32 v207, v207, v22
    v_cvt_pk_bf16_f32 v48, v200, v201
    v_cvt_pk_bf16_f32 v49, v202, v203
    v_cvt_pk_bf16_f32 v50, v204, v205
    v_cvt_pk_bf16_f32 v51, v206, v207
    s_nop 1
    v_permlane16_swap_b32 v48, v50
    v_permlane16_swap_b32 v49, v51
    buffer_store_dwordx4 v[48:51], v92, s[24:27], 0 offen offset:64
    v_accvgpr_read_b32 v96, a8
    v_accvgpr_read_b32 v97, a9
    v_accvgpr_read_b32 v98, a10
    v_accvgpr_read_b32 v99, a11
    v_accvgpr_read_b32 v100, a12
    v_accvgpr_read_b32 v101, a13
    v_accvgpr_read_b32 v102, a14
    v_accvgpr_read_b32 v103, a15
    v_mul_f32 v96, v96, v24
    v_mul_f32 v97, v97, v24
    v_mul_f32 v98, v98, v24
    v_mul_f32 v99, v99, v24
    v_mul_f32 v100, v100, v24
    v_mul_f32 v101, v101, v24
    v_mul_f32 v102, v102, v24
    v_mul_f32 v103, v103, v24
    v_cvt_pk_bf16_f32 v52, v96, v97
    v_cvt_pk_bf16_f32 v53, v98, v99
    v_cvt_pk_bf16_f32 v54, v100, v101
    v_cvt_pk_bf16_f32 v55, v102, v103
    s_nop 1
    v_permlane16_swap_b32 v52, v54
    v_permlane16_swap_b32 v53, v55
    buffer_store_dwordx4 v[52:55], v93, s[24:27], 0 offen offset:64
    v_mul_f32 v144, v144, v20
    v_mul_f32 v145, v145, v20
    v_mul_f32 v146, v146, v20
    v_mul_f32 v147, v147, v20
    v_mul_f32 v148, v148, v20
    v_mul_f32 v149, v149, v20
    v_mul_f32 v150, v150, v20
    v_mul_f32 v151, v151, v20
    v_cvt_pk_bf16_f32 v32, v144, v145
    v_cvt_pk_bf16_f32 v33, v146, v147
    v_cvt_pk_bf16_f32 v34, v148, v149
    v_cvt_pk_bf16_f32 v35, v150, v151
    s_nop 1
    v_permlane16_swap_b32 v32, v34
    v_permlane16_swap_b32 v33, v35
    buffer_store_dwordx4 v[32:35], v91, s[24:27], 0 offen offset:128
    v_mul_f32 v208, v208, v22
    v_mul_f32 v209, v209, v22
    v_mul_f32 v210, v210, v22
    v_mul_f32 v211, v211, v22
    v_mul_f32 v212, v212, v22
    v_mul_f32 v213, v213, v22
    v_mul_f32 v214, v214, v22
    v_mul_f32 v215, v215, v22
    v_cvt_pk_bf16_f32 v36, v208, v209
    v_cvt_pk_bf16_f32 v37, v210, v211
    v_cvt_pk_bf16_f32 v38, v212, v213
    v_cvt_pk_bf16_f32 v39, v214, v215
    s_nop 1
    v_permlane16_swap_b32 v36, v38
    v_permlane16_swap_b32 v37, v39
    buffer_store_dwordx4 v[36:39], v92, s[24:27], 0 offen offset:128
    v_accvgpr_read_b32 v96, a16
    v_accvgpr_read_b32 v97, a17
    v_accvgpr_read_b32 v98, a18
    v_accvgpr_read_b32 v99, a19
    v_accvgpr_read_b32 v100, a20
    v_accvgpr_read_b32 v101, a21
    v_accvgpr_read_b32 v102, a22
    v_accvgpr_read_b32 v103, a23
    v_mul_f32 v96, v96, v24
    v_mul_f32 v97, v97, v24
    v_mul_f32 v98, v98, v24
    v_mul_f32 v99, v99, v24
    v_mul_f32 v100, v100, v24
    v_mul_f32 v101, v101, v24
    v_mul_f32 v102, v102, v24
    v_mul_f32 v103, v103, v24
    v_cvt_pk_bf16_f32 v40, v96, v97
    v_cvt_pk_bf16_f32 v41, v98, v99
    v_cvt_pk_bf16_f32 v42, v100, v101
    v_cvt_pk_bf16_f32 v43, v102, v103
    s_nop 1
    v_permlane16_swap_b32 v40, v42
    v_permlane16_swap_b32 v41, v43
    buffer_store_dwordx4 v[40:43], v93, s[24:27], 0 offen offset:128
    v_mul_f32 v152, v152, v20
    v_mul_f32 v153, v153, v20
    v_mul_f32 v154, v154, v20
    v_mul_f32 v155, v155, v20
    v_mul_f32 v156, v156, v20
    v_mul_f32 v157, v157, v20
    v_mul_f32 v158, v158, v20
    v_mul_f32 v159, v159, v20
    v_cvt_pk_bf16_f32 v44, v152, v153
    v_cvt_pk_bf16_f32 v45, v154, v155
    v_cvt_pk_bf16_f32 v46, v156, v157
    v_cvt_pk_bf16_f32 v47, v158, v159
    s_nop 1
    v_permlane16_swap_b32 v44, v46
    v_permlane16_swap_b32 v45, v47
    buffer_store_dwordx4 v[44:47], v91, s[24:27], 0 offen offset:192
    v_mul_f32 v216, v216, v22
    v_mul_f32 v217, v217, v22
    v_mul_f32 v218, v218, v22
    v_mul_f32 v219, v219, v22
    v_mul_f32 v220, v220, v22
    v_mul_f32 v221, v221, v22
    v_mul_f32 v222, v222, v22
    v_mul_f32 v223, v223, v22
    v_cvt_pk_bf16_f32 v48, v216, v217
    v_cvt_pk_bf16_f32 v49, v218, v219
    v_cvt_pk_bf16_f32 v50, v220, v221
    v_cvt_pk_bf16_f32 v51, v222, v223
    s_nop 1
    v_permlane16_swap_b32 v48, v50
    v_permlane16_swap_b32 v49, v51
    buffer_store_dwordx4 v[48:51], v92, s[24:27], 0 offen offset:192
    v_accvgpr_read_b32 v96, a24
    v_accvgpr_read_b32 v97, a25
    v_accvgpr_read_b32 v98, a26
    v_accvgpr_read_b32 v99, a27
    v_accvgpr_read_b32 v100, a28
    v_accvgpr_read_b32 v101, a29
    v_accvgpr_read_b32 v102, a30
    v_accvgpr_read_b32 v103, a31
    v_mul_f32 v96, v96, v24
    v_mul_f32 v97, v97, v24
    v_mul_f32 v98, v98, v24
    v_mul_f32 v99, v99, v24
    v_mul_f32 v100, v100, v24
    v_mul_f32 v101, v101, v24
    v_mul_f32 v102, v102, v24
    v_mul_f32 v103, v103, v24
    v_cvt_pk_bf16_f32 v52, v96, v97
    v_cvt_pk_bf16_f32 v53, v98, v99
    v_cvt_pk_bf16_f32 v54, v100, v101
    v_cvt_pk_bf16_f32 v55, v102, v103
    s_nop 1
    v_permlane16_swap_b32 v52, v54
    v_permlane16_swap_b32 v53, v55
    buffer_store_dwordx4 v[52:55], v93, s[24:27], 0 offen offset:192
    v_mul_f32 v160, v160, v20
    v_mul_f32 v161, v161, v20
    v_mul_f32 v162, v162, v20
    v_mul_f32 v163, v163, v20
    v_mul_f32 v164, v164, v20
    v_mul_f32 v165, v165, v20
    v_mul_f32 v166, v166, v20
    v_mul_f32 v167, v167, v20
    v_cvt_pk_bf16_f32 v32, v160, v161
    v_cvt_pk_bf16_f32 v33, v162, v163
    v_cvt_pk_bf16_f32 v34, v164, v165
    v_cvt_pk_bf16_f32 v35, v166, v167
    s_nop 1
    v_permlane16_swap_b32 v32, v34
    v_permlane16_swap_b32 v33, v35
    buffer_store_dwordx4 v[32:35], v91, s[24:27], 0 offen offset:256
    v_mul_f32 v224, v224, v22
    v_mul_f32 v225, v225, v22
    v_mul_f32 v226, v226, v22
    v_mul_f32 v227, v227, v22
    v_mul_f32 v228, v228, v22
    v_mul_f32 v229, v229, v22
    v_mul_f32 v230, v230, v22
    v_mul_f32 v231, v231, v22
    v_cvt_pk_bf16_f32 v36, v224, v225
    v_cvt_pk_bf16_f32 v37, v226, v227
    v_cvt_pk_bf16_f32 v38, v228, v229
    v_cvt_pk_bf16_f32 v39, v230, v231
    s_nop 1
    v_permlane16_swap_b32 v36, v38
    v_permlane16_swap_b32 v37, v39
    buffer_store_dwordx4 v[36:39], v92, s[24:27], 0 offen offset:256
    v_accvgpr_read_b32 v96, a32
    v_accvgpr_read_b32 v97, a33
    v_accvgpr_read_b32 v98, a34
    v_accvgpr_read_b32 v99, a35
    v_accvgpr_read_b32 v100, a36
    v_accvgpr_read_b32 v101, a37
    v_accvgpr_read_b32 v102, a38
    v_accvgpr_read_b32 v103, a39
    v_mul_f32 v96, v96, v24
    v_mul_f32 v97, v97, v24
    v_mul_f32 v98, v98, v24
    v_mul_f32 v99, v99, v24
    v_mul_f32 v100, v100, v24
    v_mul_f32 v101, v101, v24
    v_mul_f32 v102, v102, v24
    v_mul_f32 v103, v103, v24
    v_cvt_pk_bf16_f32 v40, v96, v97
    v_cvt_pk_bf16_f32 v41, v98, v99
    v_cvt_pk_bf16_f32 v42, v100, v101
    v_cvt_pk_bf16_f32 v43, v102, v103
    s_nop 1
    v_permlane16_swap_b32 v40, v42
    v_permlane16_swap_b32 v41, v43
    buffer_store_dwordx4 v[40:43], v93, s[24:27], 0 offen offset:256
    v_mul_f32 v168, v168, v20
    v_mul_f32 v169, v169, v20
    v_mul_f32 v170, v170, v20
    v_mul_f32 v171, v171, v20
    v_mul_f32 v172, v172, v20
    v_mul_f32 v173, v173, v20
    v_mul_f32 v174, v174, v20
    v_mul_f32 v175, v175, v20
    v_cvt_pk_bf16_f32 v44, v168, v169
    v_cvt_pk_bf16_f32 v45, v170, v171
    v_cvt_pk_bf16_f32 v46, v172, v173
    v_cvt_pk_bf16_f32 v47, v174, v175
    s_nop 1
    v_permlane16_swap_b32 v44, v46
    v_permlane16_swap_b32 v45, v47
    buffer_store_dwordx4 v[44:47], v91, s[24:27], 0 offen offset:320
    v_mul_f32 v232, v232, v22
    v_mul_f32 v233, v233, v22
    v_mul_f32 v234, v234, v22
    v_mul_f32 v235, v235, v22
    v_mul_f32 v236, v236, v22
    v_mul_f32 v237, v237, v22
    v_mul_f32 v238, v238, v22
    v_mul_f32 v239, v239, v22
    v_cvt_pk_bf16_f32 v48, v232, v233
    v_cvt_pk_bf16_f32 v49, v234, v235
    v_cvt_pk_bf16_f32 v50, v236, v237
    v_cvt_pk_bf16_f32 v51, v238, v239
    s_nop 1
    v_permlane16_swap_b32 v48, v50
    v_permlane16_swap_b32 v49, v51
    buffer_store_dwordx4 v[48:51], v92, s[24:27], 0 offen offset:320
    v_accvgpr_read_b32 v96, a40
    v_accvgpr_read_b32 v97, a41
    v_accvgpr_read_b32 v98, a42
    v_accvgpr_read_b32 v99, a43
    v_accvgpr_read_b32 v100, a44
    v_accvgpr_read_b32 v101, a45
    v_accvgpr_read_b32 v102, a46
    v_accvgpr_read_b32 v103, a47
    v_mul_f32 v96, v96, v24
    v_mul_f32 v97, v97, v24
    v_mul_f32 v98, v98, v24
    v_mul_f32 v99, v99, v24
    v_mul_f32 v100, v100, v24
    v_mul_f32 v101, v101, v24
    v_mul_f32 v102, v102, v24
    v_mul_f32 v103, v103, v24
    v_cvt_pk_bf16_f32 v52, v96, v97
    v_cvt_pk_bf16_f32 v53, v98, v99
    v_cvt_pk_bf16_f32 v54, v100, v101
    v_cvt_pk_bf16_f32 v55, v102, v103
    s_nop 1
    v_permlane16_swap_b32 v52, v54
    v_permlane16_swap_b32 v53, v55
    buffer_store_dwordx4 v[52:55], v93, s[24:27], 0 offen offset:320
    v_mul_f32 v176, v176, v20
    v_mul_f32 v177, v177, v20
    v_mul_f32 v178, v178, v20
    v_mul_f32 v179, v179, v20
    v_mul_f32 v180, v180, v20
    v_mul_f32 v181, v181, v20
    v_mul_f32 v182, v182, v20
    v_mul_f32 v183, v183, v20
    v_cvt_pk_bf16_f32 v32, v176, v177
    v_cvt_pk_bf16_f32 v33, v178, v179
    v_cvt_pk_bf16_f32 v34, v180, v181
    v_cvt_pk_bf16_f32 v35, v182, v183
    s_nop 1
    v_permlane16_swap_b32 v32, v34
    v_permlane16_swap_b32 v33, v35
    buffer_store_dwordx4 v[32:35], v91, s[24:27], 0 offen offset:384
    v_mul_f32 v240, v240, v22
    v_mul_f32 v241, v241, v22
    v_mul_f32 v242, v242, v22
    v_mul_f32 v243, v243, v22
    v_mul_f32 v244, v244, v22
    v_mul_f32 v245, v245, v22
    v_mul_f32 v246, v246, v22
    v_mul_f32 v247, v247, v22
    v_cvt_pk_bf16_f32 v36, v240, v241
    v_cvt_pk_bf16_f32 v37, v242, v243
    v_cvt_pk_bf16_f32 v38, v244, v245
    v_cvt_pk_bf16_f32 v39, v246, v247
    s_nop 1
    v_permlane16_swap_b32 v36, v38
    v_permlane16_swap_b32 v37, v39
    buffer_store_dwordx4 v[36:39], v92, s[24:27], 0 offen offset:384
    v_accvgpr_read_b32 v96, a48
    v_accvgpr_read_b32 v97, a49
    v_accvgpr_read_b32 v98, a50
    v_accvgpr_read_b32 v99, a51
    v_accvgpr_read_b32 v100, a52
    v_accvgpr_read_b32 v101, a53
    v_accvgpr_read_b32 v102, a54
    v_accvgpr_read_b32 v103, a55
    v_mul_f32 v96, v96, v24
    v_mul_f32 v97, v97, v24
    v_mul_f32 v98, v98, v24
    v_mul_f32 v99, v99, v24
    v_mul_f32 v100, v100, v24
    v_mul_f32 v101, v101, v24
    v_mul_f32 v102, v102, v24
    v_mul_f32 v103, v103, v24
    v_cvt_pk_bf16_f32 v40, v96, v97
    v_cvt_pk_bf16_f32 v41, v98, v99
    v_cvt_pk_bf16_f32 v42, v100, v101
    v_cvt_pk_bf16_f32 v43, v102, v103
    s_nop 1
    v_permlane16_swap_b32 v40, v42
    v_permlane16_swap_b32 v41, v43
    buffer_store_dwordx4 v[40:43], v93, s[24:27], 0 offen offset:384
    v_mul_f32 v184, v184, v20
    v_mul_f32 v185, v185, v20
    v_mul_f32 v186, v186, v20
    v_mul_f32 v187, v187, v20
    v_mul_f32 v188, v188, v20
    v_mul_f32 v189, v189, v20
    v_mul_f32 v190, v190, v20
    v_mul_f32 v191, v191, v20
    v_cvt_pk_bf16_f32 v44, v184, v185
    v_cvt_pk_bf16_f32 v45, v186, v187
    v_cvt_pk_bf16_f32 v46, v188, v189
    v_cvt_pk_bf16_f32 v47, v190, v191
    s_nop 1
    v_permlane16_swap_b32 v44, v46
    v_permlane16_swap_b32 v45, v47
    buffer_store_dwordx4 v[44:47], v91, s[24:27], 0 offen offset:448
    v_mul_f32 v248, v248, v22
    v_mul_f32 v249, v249, v22
    v_mul_f32 v250, v250, v22
    v_mul_f32 v251, v251, v22
    v_mul_f32 v252, v252, v22
    v_mul_f32 v253, v253, v22
    v_mul_f32 v254, v254, v22
    v_mul_f32 v255, v255, v22
    v_cvt_pk_bf16_f32 v48, v248, v249
    v_cvt_pk_bf16_f32 v49, v250, v251
    v_cvt_pk_bf16_f32 v50, v252, v253
    v_cvt_pk_bf16_f32 v51, v254, v255
    s_nop 1
    v_permlane16_swap_b32 v48, v50
    v_permlane16_swap_b32 v49, v51
    buffer_store_dwordx4 v[48:51], v92, s[24:27], 0 offen offset:448
    v_accvgpr_read_b32 v96, a56
    v_accvgpr_read_b32 v97, a57
    v_accvgpr_read_b32 v98, a58
    v_accvgpr_read_b32 v99, a59
    v_accvgpr_read_b32 v100, a60
    v_accvgpr_read_b32 v101, a61
    v_accvgpr_read_b32 v102, a62
    v_accvgpr_read_b32 v103, a63
    v_mul_f32 v96, v96, v24
    v_mul_f32 v97, v97, v24
    v_mul_f32 v98, v98, v24
    v_mul_f32 v99, v99, v24
    v_mul_f32 v100, v100, v24
    v_mul_f32 v101, v101, v24
    v_mul_f32 v102, v102, v24
    v_mul_f32 v103, v103, v24
    v_cvt_pk_bf16_f32 v52, v96, v97
    v_cvt_pk_bf16_f32 v53, v98, v99
    v_cvt_pk_bf16_f32 v54, v100, v101
    v_cvt_pk_bf16_f32 v55, v102, v103
    s_nop 1
    v_permlane16_swap_b32 v52, v54
    v_permlane16_swap_b32 v53, v55
    buffer_store_dwordx4 v[52:55], v93, s[24:27], 0 offen offset:448
    s_waitcnt vmcnt(0)
L_end:
    s_endpgm
.section .rodata,"a"
.p2align 6
.amdhsa_kernel standalone__gqa_softmax__near_ridge_kernel
  .amdhsa_next_free_vgpr 512
  .amdhsa_next_free_sgpr 102
  .amdhsa_accum_offset 256
  .amdhsa_group_segment_fixed_size 0
  .amdhsa_kernarg_size 48
  .amdhsa_user_sgpr_count 2
  .amdhsa_user_sgpr_kernarg_segment_ptr 1
  .amdhsa_system_sgpr_workgroup_id_x 1
.end_amdhsa_kernel
```
